```python
import torch

def _softmax(x, axis=-1):
    return torch.softmax(x, dim=axis)
def _gelu(x):
    return torch.nn.functional.gelu(x, approximate="tanh")
def _silu(x):
    return torch.nn.functional.silu(x)
def _sigmoid(x):
    return torch.sigmoid(x)
def _layernorm(x, axis=-1, eps=1e-5):
    m = x.mean(dim=axis, keepdim=True)
    v = x.var(dim=axis, keepdim=True, unbiased=False)
    return (x - m) / torch.sqrt(v + eps)
def _scatter_add(tgt, idx, src, axis=0):
    return tgt.clone().index_add_(axis, idx, src)
def _segment_sum(src, seg, n):
    out = torch.zeros((n,) + src.shape[1:], dtype=src.dtype)
    return out.index_add_(0, seg, src)
def _pad(x, pw):
    flat = tuple(v for pair in reversed(pw) for v in pair)
    return torch.nn.functional.pad(x, flat)

kernel_name = 'interleave_layers__linear_kernel_hedgehog__glu_gated_reglu__prompt'

def setup_inputs():

    _w = (lambda a: (lambda t: t.to(torch.bfloat16) if t.is_floating_point() else t)(torch.as_tensor(a)))
    def _A_setup():
        B, S, D, H = 1, 2048, 512, 32
        Dh = D // H
        return {
            "x": _w((lambda *s: torch.randn(*s, dtype=torch.bfloat16) * 0.05)(B, S, D)),
            "wqkv": _w((lambda *s: torch.randn(*s, dtype=torch.bfloat16) * 0.4)(D, 3 * D)),
            "w_phi": _w((lambda *s: torch.randn(*s, dtype=torch.bfloat16) * 0.4)(H, Dh, Dh) * (Dh ** -0.5)),
            "wo": _w((lambda *s: torch.randn(*s, dtype=torch.bfloat16) * 0.05)(D, D)),
        }
    _A_in = _A_setup()

    def _B_setup():
        B, S, D, F = 1, 2048, 512, 1376
        return {
            "x": _w((lambda *s: torch.randn(*s, dtype=torch.bfloat16) * 0.05)(B, S, D)),
            "W_gate": _w((lambda *s: torch.randn(*s, dtype=torch.bfloat16) * 0.8)(D, F) * (2.0 / D) ** 0.5),
            "W_up": _w((lambda *s: torch.randn(*s, dtype=torch.bfloat16) * 0.8)(D, F) * (2.0 / D) ** 0.5),
            "W_down": _w((lambda *s: torch.randn(*s, dtype=torch.bfloat16) * 0.8)(F, D) * (1.0 / F) ** 0.5),
        }
    _B_in = _B_setup()

    return {
        "A_x": _A_in["x"],
        "A_wqkv": _A_in["wqkv"],
        "A_w_phi": _A_in["w_phi"],
        "A_wo": _A_in["wo"],
        "B_x": _B_in["x"],
        "B_W_gate": _B_in["W_gate"],
        "B_W_up": _B_in["W_up"],
        "B_W_down": _B_in["W_down"],
    }

def reference(A_x, A_wqkv, A_w_phi, A_wo, B_x, B_W_gate, B_W_up, B_W_down):
    def _A_ref(x, wqkv, w_phi, wo):
        B, S, D = x.shape
        H = 32; Dh = D // H
        qkv = (lambda x, *d: x.permute(*d))((x @ wqkv).reshape(B, S, 3, H, Dh), 2, 0, 3, 1, 4)
        q, k, v = qkv[0], qkv[1], qkv[2]
        pq = torch.einsum("bhsd,hdf->bhsf", q, w_phi)
        pk = torch.einsum("bhsd,hdf->bhsf", k, w_phi)
        phi_q = torch.concatenate([_softmax(pq, axis=-1), _softmax(-pq, axis=-1)], axis=-1)
        phi_k = torch.concatenate([_softmax(pk, axis=-1), _softmax(-pk, axis=-1)], axis=-1)
        kv = torch.einsum("bhsf,bhsd->bhfd", phi_k, v)
        z  = torch.einsum("bhsf->bhf", phi_k)
        num = torch.einsum("bhqf,bhfd->bhqd", phi_q, kv)
        den = torch.einsum("bhqf,bhf->bhq", phi_q, z)[..., None] + 1e-6
        o = num / den
        return (lambda x, *d: x.permute(*d))(o, 0, 2, 1, 3).reshape(B, S, D) @ wo

    def _B_ref(x, W_gate, W_up, W_down):
        gate = torch.einsum("bsd,df->bsf", x, W_gate)
        up = torch.einsum("bsd,df->bsf", x, W_up)
        gate = gate * (lambda x, dt: x.to(dt))(gate > 0, gate.dtype)
        h = gate * up
        return torch.einsum("bsf,fd->bsd", h, W_down)

    x = A_x
    x = x + _A_ref(_layernorm(x, axis=-1), A_wqkv, A_w_phi, A_wo)
    x = x + _B_ref(_layernorm(x, axis=-1), B_W_gate, B_W_up, B_W_down)
    x = x + _A_ref(_layernorm(x, axis=-1), A_wqkv, A_w_phi, A_wo)
    x = x + _B_ref(_layernorm(x, axis=-1), B_W_gate, B_W_up, B_W_down)
    return x
```

```asm
; @launch grid=(256,1,1) block=(256,1,1) lds=163840
.amdgcn_target "amdgcn-amd-amdhsa--gfx950"
.text
.globl interleave_layers__linear_kernel_hedgehog__glu_gated_reglu__prompt_kernel
.p2align 8
.type interleave_layers__linear_kernel_hedgehog__glu_gated_reglu__prompt_kernel,@function
interleave_layers__linear_kernel_hedgehog__glu_gated_reglu__prompt_kernel:
K1_start:
    s_cmp_ge_u32 s2, 256
    s_cbranch_scc1 K1_end
    s_load_dwordx2 s[8:9], s[0:1], 0
    s_load_dwordx2 s[4:5], s[0:1], 80
    s_load_dwordx2 s[64:65], s[0:1], 8
    s_load_dwordx2 s[88:89], s[0:1], 16
    s_load_dwordx2 s[12:13], s[0:1], 64
    s_load_dwordx2 s[84:85], s[0:1], 24
    s_getpc_b64 s[96:97]
    v_lshrrev_b32 v1, 6, v0
    v_and_b32 v8, 63, v0
    v_readfirstlane_b32 s3, v1
    s_and_b32 s18, s2, 7
    s_lshr_b32 s19, s2, 3
    s_lshl_b32 s30, s19, 2
    s_add_u32 s48, s30, s3
    s_mul_i32 s30, s48, 4
    v_add_u32 v23, s30, v8
    v_lshlrev_b32 v23, 7, v23
    v_min_u32 v23, K1_fail-K1_start-128, v23
    s_mov_b64 exec, 15
    global_load_dword v24, v23, s[96:97]
    s_mov_b64 exec, -1
    v_lshlrev_b32 v0, 4, v8
    s_and_b32 s21, s19, 15
    s_lshr_b32 s20, s19, 4
    v_and_b32 v12, 3, v8
    v_lshrrev_b32 v22, 2, v8
    v_mul_u32_u24 v227, 3072, v22
    v_lshl_add_u32 v227, v12, 4, v227
    s_mov_b32 s10, 2097152
    s_mov_b32 s11, 0x20000
    s_mov_b32 s66, 1572864
    s_mov_b32 s67, 0x20000
    s_lshl_b32 s44, s3, 13
    s_lshl_b32 s42, s18, 18
    s_lshl_b32 s31, s48, 11
    s_add_u32 s42, s42, s31
    s_lshl_b32 s54, s21, 6
    s_mul_i32 s31, s3, 393216
    s_add_u32 s54, s54, s31
    s_add_u32 s72, s54, 1024
    s_add_u32 s74, s54, 2048
    s_and_b32 s55, s21, 1
    s_lshl_b32 s31, s20, 1
    s_add_u32 s55, s55, s31
    s_lshl_b32 s55, s55, 1
    s_add_u32 s73, s44, 98304
    s_add_u32 s75, s44, 131072
    s_add_u32 s56, s44, 65536
    s_mov_b64 s[30:31], s[72:73]
    s_bitcmp1_b32 s18, 0
    s_cselect_b64 s[72:73], s[74:75], s[72:73]
    s_cselect_b64 s[74:75], s[30:31], s[74:75]
    s_waitcnt lgkmcnt(0)
    buffer_load_dwordx4 v[40:43], v0, s[8:11], s42 offen
    buffer_load_dwordx4 v[44:47], v0, s[8:11], s42 offen offset:1024
    s_add_u32 s30, s55, 0
    s_and_b32 s30, s30, 7
    s_lshl_b32 s31, s30, 10
    s_add_u32 m0, s73, s31
    s_mul_i32 s30, s30, 49152
    s_add_u32 s30, s30, s72
    buffer_load_dwordx4 v227, s[64:67], s30 offen lds
    s_add_u32 s30, s55, 1
    s_and_b32 s30, s30, 7
    s_lshl_b32 s31, s30, 10
    s_add_u32 m0, s73, s31
    s_mul_i32 s30, s30, 49152
    s_add_u32 s30, s30, s72
    buffer_load_dwordx4 v227, s[64:67], s30 offen lds
    v_and_b32 v3, 31, v8
    s_mov_b32 s14, 2097152
    s_mov_b32 s15, 0x20000
    s_mov_b32 s6, 268435456
    s_mov_b32 s7, 0x20000
    s_mov_b32 s90, 16384
    s_mov_b32 s91, 0x20000
    s_lshl_b32 s28, s3, 10
    v_mov_b32 v32, -1
    v_mov_b32 v33, -1
    v_mov_b32 v34, -1
    v_mov_b32 v35, -1
    s_lshl_b32 s30, s21, 2
    s_add_u32 s30, s30, s3
    s_lshl_b32 s98, s30, 13
    s_add_u32 s98, s98, 6815744
    s_lshl_b32 s31, s18, 1
    s_add_u32 s31, s31, s20
    s_lshl_b32 s99, s31, 9
    s_add_u32 s99, s99, s98
    s_lshl_b32 s101, s21, 12
    s_add_u32 s101, s101, 7340032
    s_lshl_b32 s31, s31, 8
    s_add_u32 s57, s101, s31
    s_lshl_b32 s30, s3, 6
    s_add_u32 s101, s101, s30
    s_add_u32 s82, s57, s30
    s_mul_i32 s30, s3, 655360
    s_add_u32 s57, s57, s30
    v_lshrrev_b32 v27, 9, v0
    v_mul_u32_u24 v27, 654848, v27
    v_add_u32 v27, v27, v0
    s_lshl_b32 s45, s18, 18
    s_lshr_b32 s31, s19, 2
    s_lshl_b32 s31, s31, 15
    s_add_u32 s45, s45, s31
    s_and_b32 s31, s19, 3
    s_lshl_b32 s31, s31, 7
    s_add_u32 s45, s45, s31
    s_add_u32 s45, s45, s44
    v_lshlrev_b32 v25, 5, v0
    s_lshl_b32 s30, s18, 14
    s_lshl_b32 s31, s48, 7
    s_add_u32 s49, s30, s31
    s_lshl_b32 s52, s18, 7
    s_add_u32 s52, s52, 16531456
    v_mov_b32 v38, 16646144
    v_writelane_b32 v38, s52, 1
    s_lshl_b32 s30, s18, 10
    s_and_b32 s31, s31, 0x380
    s_add_u32 s50, s30, s31
    s_add_u32 s50, s50, 16515072
    v_writelane_b32 v38, s50, 2
    s_lshl_b32 s51, s2, 7
    s_add_u32 s51, s51, 16547840
    s_lshl_b32 s53, s21, 10
    s_add_u32 m0, s28, 47104
    s_mov_b64 exec, 7
    buffer_load_dword v39, v38, s[4:7], 0 offen sc1
    s_mov_b64 exec, 0xffff
    buffer_load_dword v24, v25, s[12:15], s45 offen
    s_mov_b64 exec, -1
    buffer_load_dwordx4 v0, s[88:91], s53 offen lds
    s_mov_b32 s86, 524288
    s_mov_b32 s87, 0x20000
    s_lshl_b32 s30, s2, 2
    s_add_u32 s30, s30, s3
    s_lshl_b32 s30, s30, 9
    v_lshlrev_b32 v26, 3, v0
    s_mov_b64 exec, 15
    buffer_load_dword v24, v26, s[84:87], s30 offen
    s_mov_b64 exec, -1
    buffer_store_dwordx4 v[32:35], v27, s[4:7], s99 offen sc1
    s_cmp_lt_u32 s3, 2
    s_cselect_b64 exec, 0xffff, 0
    buffer_store_dwordx4 v[32:35], v0, s[4:7], s57 offen sc1
    s_mov_b64 exec, -1
    v_mov_b32 v7, 0
    s_load_dwordx2 s[16:17], s[0:1], 72
    s_load_dwordx2 s[88:89], s[0:1], 24
    s_mul_i32 s30, s3, 2080
    s_add_u32 s30, s30, 36864
    v_add_u32 v18, s30, v0
    v_and_b32 v20, 7, v8
    v_lshrrev_b32 v23, 3, v8
    v_lshlrev_b32 v21, 4, v20
    v_lshl_add_u32 v21, v23, 9, v21
    v_mul_u32_u24 v20, 1040, v20
    v_lshl_add_u32 v20, v23, 4, v20
    s_lshl_b32 s30, s3, 8
    s_add_u32 s30, s30, 36864
    v_add_u32 v20, s30, v20
    v_mov_b32 v36, 0
    v_lshlrev_b32 v37, 1, v8
    s_mov_b32 s59, 0x3f803f80
    v_lshrrev_b32 v9, 5, v8
    v_lshrrev_b32 v14, 4, v3
    v_mov_b32 v17, v0
    s_mov_b32 s81, 0
    s_mov_b32 s83, 0
    s_mov_b32 s39, 0xbb000000
    s_mov_b32 s94, 268435456
    s_cmp_ge_u32 s19, 16
    s_cbranch_scc1 U_GU
    s_lshl_b32 s30, s18, 1
    s_sub_u32 s30, s19, s30
    s_and_b32 s30, s30, 15
    s_add_u32 s31, s30, 4
    s_and_b32 s31, s31, 15
    s_cmp_ge_u32 s31, 6
    s_cbranch_scc1 U_B
    s_load_dwordx2 s[84:85], s[0:1], 8
    s_and_b32 s83, s30, 1
    s_lshr_b32 s37, s31, 1
    s_sub_u32 s38, 2, s37
    s_lshl_b32 s38, s38, 10
    s_lshl_b32 s32, s21, 6
    s_add_u32 s32, s32, s38
    s_mul_i32 s31, s3, 393216
    s_add_u32 s32, s32, s31
    s_mov_b32 s33, 98304
    s_mov_b32 s34, 3072
    s_mov_b32 s86, 1572864
    s_cmp_eq_u32 s37, 0
    s_cselect_b32 s81, 2, 1
    s_xor_b32 s38, s37, 1
    s_cmp_eq_u32 s37, 2
    s_cselect_b32 s38, 2, s38
    s_lshl_b32 s38, s38, 15
    s_mul_i32 s35, s21, 98304
    s_add_u32 s35, s35, s38
    s_lshl_b32 s31, s3, 13
    s_add_u32 s35, s35, s31
    s_mov_b32 s36, 4096
    s_mov_b32 s37, 2048
    s_mov_b32 s38, 1024
    s_branch U_gen
U_GU:
    s_mul_i32 s36, s18, 11
    s_add_u32 s36, s36, s19
    s_sub_u32 s36, s36, 16
    s_cmp_ge_u32 s19, 27
    s_cselect_b32 s36, 86, s36
    s_cmp_ge_u32 s36, 43
    s_cbranch_scc1 U_up
    s_load_dwordx2 s[84:85], s[0:1], 40
    s_mov_b32 s38, 0
    s_branch U_GU2
U_up:
    s_load_dwordx2 s[84:85], s[0:1], 48
    s_movk_i32 s38, 256
    s_sub_u32 s36, s36, 43
U_GU2:
    s_cmp_ge_u32 s36, 43
    s_cselect_b32 s86, 0, 1409024
    s_cselect_b32 s94, 0, s94
    s_lshl_b32 s32, s36, 6
    s_mul_i32 s31, s3, 352256
    s_add_u32 s32, s32, s31
    s_mov_b32 s33, 88064
    s_mov_b32 s34, 2752
    s_lshl_b32 s36, s36, 1
    v_add_u32 v17, s36, v14
    v_mul_u32_u24 v19, 21846, v17
    v_lshrrev_b32 v19, 16, v19
    v_mul_u32_u24 v19, 95232, v19
    v_lshl_add_u32 v17, v17, 10, v19
    v_lshl_add_u32 v17, v9, 9, v17
    v_and_b32 v19, 0xf0, v0
    v_add3_u32 v17, v17, v19, s38
    s_mul_i32 s35, s3, 24576
    s_add_u32 s35, s35, 2097152
    s_mov_b32 s36, 12288
    s_mov_b32 s37, 6144
    s_mov_b32 s38, 3072
    s_branch U_gen
U_B:
    s_sub_u32 s30, s30, 2
    s_lshl_b32 s30, s30, 3
    s_add_u32 s30, s30, s18
    s_load_dwordx2 s[84:85], s[0:1], 56
    s_mov_b32 s36, 180224
    s_mov_b32 s35, 5242880
    s_cmp_ge_u32 s30, 43
    s_cselect_b32 s86, 0, 1409024
    s_cselect_b32 s94, 0, s94
    s_cselect_b32 s30, 0, s30
    s_mov_b32 s39, 0
    s_mov_b32 s33, 64
    s_mov_b32 s34, 1024
    s_mov_b32 s37, 2048
    s_mov_b32 s38, 1024
    s_lshl_b32 s32, s30, 15
    s_lshl_b32 s31, s3, 8
    s_add_u32 s32, s32, s31
    s_lshl_b32 s31, s30, 12
    s_add_u32 s35, s35, s31
    s_mul_i32 s31, s3, s36
    s_lshl_b32 s31, s31, 1
    s_add_u32 s35, s35, s31
U_gen:
    v_mul_lo_u32 v226, v22, s34
    v_lshrrev_b32 v23, 4, v8
    v_xor_b32 v23, v23, v12
    v_lshl_add_u32 v226, v23, 4, v226
    v_accvgpr_write_b32 a224, v17
    s_lshl_b32 s34, s34, 4
    s_lshl_b32 s30, s33, 1
    s_mul_i32 s31, s30, s83
    s_add_u32 s40, s32, s31
    s_sub_u32 s31, s30, s31
    s_add_u32 s46, s32, s31
    s_lshl_b32 s31, s83, 12
    s_add_u32 s41, s44, s31
    s_xor_b32 s47, s41, 4096
    s_mov_b32 s87, 0x20000
    s_branch IT_base
.p2align 12
IT_base:
    s_waitcnt vmcnt(7)
    v_dot2_f32_bf16 v48, v40, s59, 0
    v_dot2_f32_bf16 v50, v40, v40, 0
    v_dot2_f32_bf16 v49, v44, s59, 0
    v_dot2_f32_bf16 v51, v44, v44, 0
    v_dot2_f32_bf16 v48, v41, s59, v48
    v_dot2_f32_bf16 v50, v41, v41, v50
    v_dot2_f32_bf16 v49, v45, s59, v49
    v_dot2_f32_bf16 v51, v45, v45, v51
    v_dot2_f32_bf16 v48, v42, s59, v48
    v_dot2_f32_bf16 v50, v42, v42, v50
    v_dot2_f32_bf16 v49, v46, s59, v49
    v_dot2_f32_bf16 v51, v46, v46, v51
    v_dot2_f32_bf16 v48, v43, s59, v48
    v_dot2_f32_bf16 v50, v43, v43, v50
    v_dot2_f32_bf16 v49, v47, s59, v49
    v_dot2_f32_bf16 v51, v47, v47, v51
    v_lshlrev_b32 v56, 16, v40
    v_and_b32 v57, 0xffff0000, v40
    v_lshlrev_b32 v58, 16, v41
    v_permlane32_swap_b32 v48, v50
    v_permlane32_swap_b32 v49, v51
    v_add_f32 v48, v48, v50
    v_add_f32 v49, v49, v51
    v_and_b32 v59, 0xffff0000, v41
    v_lshlrev_b32 v60, 16, v42
    v_permlane16_swap_b32 v48, v49
    v_add_f32 v48, v48, v49
    v_and_b32 v61, 0xffff0000, v42
    v_lshlrev_b32 v62, 16, v43
    v_add_f32 v48, v48, v48 row_ror:8 row_mask:0xf bank_mask:0xf
    v_and_b32 v63, 0xffff0000, v43
    v_lshlrev_b32 v64, 16, v44
    v_add_f32 v48, v48, v48 row_ror:4 row_mask:0xf bank_mask:0xf
    v_and_b32 v65, 0xffff0000, v44
    v_lshlrev_b32 v66, 16, v45
    v_add_f32 v48, v48, v48 row_ror:2 row_mask:0xf bank_mask:0xf
    v_and_b32 v67, 0xffff0000, v45
    v_lshlrev_b32 v68, 16, v46
    v_add_f32 v48, v48, v48 row_ror:1 row_mask:0xf bank_mask:0xf
    v_and_b32 v69, 0xffff0000, v46
    v_lshlrev_b32 v70, 16, v47
    v_mul_f32 v48, 0x3b000000, v48
    v_mov_b32 v49, v48
    v_and_b32 v71, 0xffff0000, v47
    s_nop 0
    v_permlane32_swap_b32 v48, v49
    v_fma_f32 v49, -v48, v48, v49
    v_max_f32 v49, 0, v49
    v_add_f32 v49, 0x3727c5ac, v49
    v_rsq_f32 v49, v49
    s_nop 0
    v_mul_f32 v48, v48, v49
    v_readlane_b32 s68, v49, 0
    v_readlane_b32 s70, v49, 16
    v_readlane_b32 s69, v48, 0
    v_readlane_b32 s71, v48, 16
    s_nop 0
    v_pk_fma_f32 v[56:57], v[56:57], s[68:69], s[68:69] op_sel:[0,0,1] op_sel_hi:[1,0,1] neg_lo:[0,0,1] neg_hi:[0,0,1]
    v_pk_fma_f32 v[58:59], v[58:59], s[68:69], s[68:69] op_sel:[0,0,1] op_sel_hi:[1,0,1] neg_lo:[0,0,1] neg_hi:[0,0,1]
    v_pk_fma_f32 v[60:61], v[60:61], s[68:69], s[68:69] op_sel:[0,0,1] op_sel_hi:[1,0,1] neg_lo:[0,0,1] neg_hi:[0,0,1]
    v_pk_fma_f32 v[62:63], v[62:63], s[68:69], s[68:69] op_sel:[0,0,1] op_sel_hi:[1,0,1] neg_lo:[0,0,1] neg_hi:[0,0,1]
    v_cvt_pk_bf16_f32 v56, v56, v57
    v_cvt_pk_bf16_f32 v57, v58, v59
    v_cvt_pk_bf16_f32 v58, v60, v61
    v_cvt_pk_bf16_f32 v59, v62, v63
    ds_write_b128 v18, v[56:59] offset:0
    v_pk_fma_f32 v[64:65], v[64:65], s[70:71], s[70:71] op_sel:[0,0,1] op_sel_hi:[1,0,1] neg_lo:[0,0,1] neg_hi:[0,0,1]
    v_pk_fma_f32 v[66:67], v[66:67], s[70:71], s[70:71] op_sel:[0,0,1] op_sel_hi:[1,0,1] neg_lo:[0,0,1] neg_hi:[0,0,1]
    v_pk_fma_f32 v[68:69], v[68:69], s[70:71], s[70:71] op_sel:[0,0,1] op_sel_hi:[1,0,1] neg_lo:[0,0,1] neg_hi:[0,0,1]
    v_pk_fma_f32 v[70:71], v[70:71], s[70:71], s[70:71] op_sel:[0,0,1] op_sel_hi:[1,0,1] neg_lo:[0,0,1] neg_hi:[0,0,1]
    v_cvt_pk_bf16_f32 v64, v64, v65
    v_cvt_pk_bf16_f32 v65, v66, v67
    v_cvt_pk_bf16_f32 v66, v68, v69
    v_cvt_pk_bf16_f32 v67, v70, v71
    ds_write_b128 v18, v[64:67] offset:1040
    s_cmp_lt_u32 s48, 8
    s_cselect_b64 exec, -1, 0
    buffer_store_short v36, v37, s[4:7], s50 offen
    s_mov_b64 exec, -1
    s_waitcnt lgkmcnt(0)
    s_barrier
    ds_read_b128 v[48:51], v20
    ds_read_b128 v[52:55], v20 offset:128
    s_add_u32 s31, s45, 4096
    s_mov_b32 s90, 524288
    s_waitcnt lgkmcnt(0)
    buffer_store_dwordx4 v[48:51], v21, s[12:15], s45 offen
    buffer_store_dwordx4 v[52:55], v21, s[12:15], s31 offen
    s_add_u32 s30, s55, 2
    s_and_b32 s30, s30, 7
    s_lshl_b32 s31, s30, 10
    s_add_u32 m0, s73, s31
    s_mul_i32 s30, s30, 49152
    s_add_u32 s30, s30, s72
    buffer_load_dwordx4 v227, s[64:67], s30 offen lds
    s_add_u32 s30, s55, 3
    s_and_b32 s30, s30, 7
    s_lshl_b32 s31, s30, 10
    s_add_u32 m0, s73, s31
    s_mul_i32 s30, s30, 49152
    s_add_u32 s30, s30, s72
    buffer_load_dwordx4 v227, s[64:67], s30 offen lds
    s_add_u32 s30, s55, 4
    s_and_b32 s30, s30, 7
    s_lshl_b32 s31, s30, 10
    s_add_u32 m0, s73, s31
    s_mul_i32 s30, s30, 49152
    s_add_u32 s30, s30, s72
    buffer_load_dwordx4 v227, s[64:67], s30 offen lds
    s_add_u32 s30, s55, 5
    s_and_b32 s30, s30, 7
    s_lshl_b32 s31, s30, 10
    s_add_u32 m0, s73, s31
    s_mul_i32 s30, s30, 49152
    s_add_u32 s30, s30, s72
    buffer_load_dwordx4 v227, s[64:67], s30 offen lds
    s_add_u32 s30, s55, 6
    s_and_b32 s30, s30, 7
    s_lshl_b32 s31, s30, 10
    s_add_u32 m0, s73, s31
    s_mul_i32 s30, s30, 49152
    s_add_u32 s30, s30, s72
    buffer_load_dwordx4 v227, s[64:67], s30 offen lds
    s_add_u32 s30, s55, 7
    s_and_b32 s30, s30, 7
    s_lshl_b32 s31, s30, 10
    s_add_u32 m0, s73, s31
    s_mul_i32 s30, s30, 49152
    s_add_u32 s30, s30, s72
    buffer_load_dwordx4 v227, s[64:67], s30 offen lds
    s_add_u32 s30, s55, 0
    s_and_b32 s30, s30, 7
    s_lshl_b32 s31, s30, 10
    s_add_u32 m0, s75, s31
    s_mul_i32 s30, s30, 49152
    s_add_u32 s30, s30, s74
    buffer_load_dwordx4 v227, s[64:67], s30 offen lds
    s_add_u32 s30, s55, 1
    s_and_b32 s30, s30, 7
    s_lshl_b32 s31, s30, 10
    s_add_u32 m0, s75, s31
    s_mul_i32 s30, s30, 49152
    s_add_u32 s30, s30, s74
    buffer_load_dwordx4 v227, s[64:67], s30 offen lds
    s_lshr_b32 s22, s19, 3
    s_and_b32 s23, s19, 7
    s_lshl_b32 s27, s18, 3
    s_add_u32 s26, s27, s22
    s_add_u32 s27, s27, s3
    s_lshl_b32 s31, s20, 1
    s_add_u32 s25, s27, s31
    s_and_b32 s31, s3, 2
    s_add_u32 s25, s25, s31
    v_lshrrev_b32 v5, 8, v0
    v_and_b32 v23, 0xf0, v0
    v_lshl_add_u32 v5, v5, 9, v23
    s_mov_b32 s24, 1
    s_mov_b32 s60, 262144
    s_getreg_b32 s29, hwreg(HW_REG_XCC_ID)
    s_and_b32 s29, s29, 15
    s_lshl_b32 s31, s19, 2
    s_add_u32 s53, s52, s31
    v_lshlrev_b32 v6, 2, v3
    v_bfe_u32 v22, v8, 2, 2
    v_lshl_add_u32 v22, v9, 3, v22
    v_and_b32 v27, 1, v8
    v_bfe_u32 v28, v8, 1, 1
    v_lshlrev_b32 v26, 5, v22
    v_lshl_add_u32 v26, v28, 3, v26
    v_lshl_add_u32 v26, v14, 4, v26
    v_lshl_add_u32 v26, v27, 9, v26
    s_add_u32 s30, s28, 47104
    v_add_u32 v26, s30, v26
    v_lshlrev_b32 v22, 6, v22
    v_add_u32 v22, 65536, v22
    v_lshl_add_u32 v22, v28, 3, v22
    v_lshl_add_u32 v1, v14, 5, v22
    v_lshl_add_u32 v1, v27, 4, v1
    v_lshl_add_u32 v2, v27, 5, v22
    v_lshl_add_u32 v2, v14, 4, v2
    v_add_u32 v2, 65536, v2
    s_waitcnt vmcnt(8)
    v_readlane_b32 s80, v39, 0
    ds_read_b64_tr_b16 v[28:29], v26
    ds_read_b64_tr_b16 v[30:31], v26 offset:128
    s_and_b32 s80, s80, 0xfffffff0
    s_add_u32 s80, s80, 0x9e3779b0
    s_or_b32 s29, s80, s29
    v_mov_b32 v213, s29
    s_barrier
    s_cmp_eq_u32 s3, 0
    s_cselect_b64 exec, 1, 0
    buffer_store_dword v213, off, s[4:7], s53
    buffer_store_dword v213, off, s[4:7], s51 sc1
    s_mov_b64 exec, -1
    s_add_u32 s30, s55, 2
    s_and_b32 s30, s30, 7
    s_lshl_b32 s31, s30, 10
    s_add_u32 m0, s75, s31
    s_mul_i32 s30, s30, 49152
    s_add_u32 s30, s30, s74
    buffer_load_dwordx4 v227, s[64:67], s30 offen lds
    s_add_u32 s30, s55, 3
    s_and_b32 s30, s30, 7
    s_lshl_b32 s31, s30, 10
    s_add_u32 m0, s75, s31
    s_mul_i32 s30, s30, 49152
    s_add_u32 s30, s30, s74
    buffer_load_dwordx4 v227, s[64:67], s30 offen lds
    s_add_u32 s30, s55, 4
    s_and_b32 s30, s30, 7
    s_lshl_b32 s31, s30, 10
    s_add_u32 m0, s75, s31
    s_mul_i32 s30, s30, 49152
    s_add_u32 s30, s30, s74
    buffer_load_dwordx4 v227, s[64:67], s30 offen lds
    s_add_u32 s30, s55, 5
    s_and_b32 s30, s30, 7
    s_lshl_b32 s31, s30, 10
    s_add_u32 m0, s75, s31
    s_mul_i32 s30, s30, 49152
    s_add_u32 s30, s30, s74
    buffer_load_dwordx4 v227, s[64:67], s30 offen lds
    s_mov_b32 s92, s4
    s_mov_b32 s93, s5
    s_mov_b32 s95, 0x20000
    v_lshrrev_b32 v10, 3, v3
    v_bfe_u32 v11, v3, 2, 1
    v_and_b32 v13, 1, v10
    v_lshl_add_u32 v13, v13, 2, v12
    v_lshl_add_u32 v15, v11, 3, v13
    v_lshl_add_u32 v15, v14, 4, v15
    v_bfe_u32 v22, v15, 2, 2
    v_xor_b32 v22, v22, v9
    v_lshlrev_b32 v22, 4, v22
    v_lshl_add_u32 v22, v15, 6, v22
    v_add_u32 v22, s44, v22
    v_accvgpr_write_b32 a225, v22
    v_mov_b32 v228, 1.0
    v_mov_b32 v229, 1069066811
    v_and_b32 v104, 1, v13
    v_lshlrev_b32 v104, 4, v104
    v_mov_b32 v105, 0x3f80
    v_lshlrev_b32 v104, v104, v105
    v_lshrrev_b32 v105, 1, v13
    s_cmp_eq_u32 s81, 0
    s_cselect_b64 vcc, -1, 0
    v_cndmask_b32 v106, v11, v14, vcc
    v_cndmask_b32 v107, v14, v11, vcc
    v_cmp_eq_u32 vcc, v107, v9
    s_add_u32 s30, s55, 6
    s_and_b32 s30, s30, 7
    s_lshl_b32 s31, s30, 10
    s_add_u32 m0, s75, s31
    s_mul_i32 s30, s30, 49152
    s_add_u32 s30, s30, s74
    buffer_load_dwordx4 v227, s[64:67], s30 offen lds
    s_add_u32 s30, s55, 7
    s_and_b32 s30, s30, 7
    s_lshl_b32 s31, s30, 10
    s_add_u32 m0, s75, s31
    s_mul_i32 s30, s30, 49152
    s_add_u32 s30, s30, s74
    buffer_load_dwordx4 v227, s[64:67], s30 offen lds
    v_cmp_eq_u32 s[68:69], 0, v105
    v_cmp_eq_u32 s[70:71], 1, v105
    v_cmp_eq_u32 s[72:73], 2, v105
    v_cmp_eq_u32 s[74:75], 3, v105
    v_cndmask_b32 v104, 0, v104, vcc
    v_cndmask_b32 v108, 0, v104, s[68:69]
    v_cndmask_b32 v109, 0, v104, s[70:71]
    v_cndmask_b32 v110, 0, v104, s[72:73]
    v_cndmask_b32 v111, 0, v104, s[74:75]
    buffer_load_dword v4, v6, s[4:7], s52 offen sc1
    s_cmp_eq_u32 s81, 1
    s_cselect_b64 s[70:71], -1, 0
    v_cmp_eq_u32 vcc, 0, v106
    v_cmp_eq_u32 s[68:69], 0, v11
    s_waitcnt lgkmcnt(0)
    v_cndmask_b32 v108, v108, v28, s[70:71]
    v_cndmask_b32 v109, v109, v29, s[70:71]
    v_cndmask_b32 v110, v110, v30, s[70:71]
    v_cndmask_b32 v111, v111, v31, s[70:71]
    v_cndmask_b32 v112, 0, v108, vcc
    v_cndmask_b32 v113, v108, 0, vcc
    v_cndmask_b32 v114, 0, v28, s[68:69]
    v_cndmask_b32 v115, v28, 0, s[68:69]
    v_accvgpr_write_b32 a216, v112
    v_accvgpr_write_b32 a220, v113
    v_accvgpr_write_b32 a232, v114
    v_accvgpr_write_b32 a236, v115
    v_cndmask_b32 v112, 0, v109, vcc
    v_cndmask_b32 v113, v109, 0, vcc
    v_cndmask_b32 v114, 0, v29, s[68:69]
    v_cndmask_b32 v115, v29, 0, s[68:69]
    v_accvgpr_write_b32 a217, v112
    v_accvgpr_write_b32 a221, v113
    v_accvgpr_write_b32 a233, v114
    v_accvgpr_write_b32 a237, v115
    v_cndmask_b32 v112, 0, v110, vcc
    v_cndmask_b32 v113, v110, 0, vcc
    v_cndmask_b32 v114, 0, v30, s[68:69]
    v_cndmask_b32 v115, v30, 0, s[68:69]
    v_accvgpr_write_b32 a218, v112
    v_accvgpr_write_b32 a222, v113
    v_accvgpr_write_b32 a234, v114
    v_accvgpr_write_b32 a238, v115
    v_cndmask_b32 v112, 0, v111, vcc
    v_cndmask_b32 v113, v111, 0, vcc
    v_cndmask_b32 v114, 0, v31, s[68:69]
    v_cndmask_b32 v115, v31, 0, s[68:69]
    v_accvgpr_write_b32 a219, v112
    v_accvgpr_write_b32 a223, v113
    v_accvgpr_write_b32 a235, v114
    v_accvgpr_write_b32 a239, v115
    s_lshl_b32 s42, s25, 15
    s_mov_b64 exec, 0
    s_cmp_eq_u32 s3, 0
    s_cbranch_scc1 IT_1
    s_cmp_eq_u32 s3, 1
    s_cbranch_scc1 IT_2
    s_cmp_eq_u32 s3, 2
    s_cbranch_scc1 IT_3
    s_branch IT_4
IT_ret:
    s_mov_b64 exec, -1
    s_waitcnt vmcnt(0)
    v_cmp_ne_u32 vcc, s29, v4
    s_nop 0
    s_cbranch_vccnz HS_spin
HS_ok:
    buffer_load_dwordx4 v[8:11], v0, s[12:15], s42 offen offset:0 sc1
    buffer_load_dwordx4 v[12:15], v0, s[12:15], s42 offen offset:1024 sc1
    buffer_load_dwordx4 v[16:19], v0, s[12:15], s42 offen offset:2048 sc1
    buffer_load_dwordx4 v[20:23], v0, s[12:15], s42 offen offset:3072 sc1
    s_add_u32 s42, s42, 4096
    buffer_load_dwordx4 v[24:27], v0, s[12:15], s42 offen offset:0 sc1
    buffer_load_dwordx4 v[28:31], v0, s[12:15], s42 offen offset:1024 sc1
    buffer_load_dwordx4 v[32:35], v0, s[12:15], s42 offen offset:2048 sc1
    buffer_load_dwordx4 v[36:39], v0, s[12:15], s42 offen offset:3072 sc1
    s_add_u32 s42, s42, 4096
    buffer_load_dwordx4 v[40:43], v0, s[12:15], s42 offen offset:0 sc1
    s_waitcnt lgkmcnt(0)
    s_barrier
    ds_read_b64_tr_b16 v[232:233], v1 offset:32768
    ds_read_b64_tr_b16 v[234:235], v1 offset:33024
    ds_read_b64_tr_b16 v[236:237], v2 offset:0
    ds_read_b64_tr_b16 v[238:239], v2 offset:256
    ds_read_b64_tr_b16 v[240:241], v1 offset:33792
    ds_read_b64_tr_b16 v[242:243], v1 offset:34048
    ds_read_b64_tr_b16 v[244:245], v2 offset:1024
    ds_read_b64_tr_b16 v[246:247], v2 offset:1280
    ds_read_b64_tr_b16 v[248:249], v1 offset:34816
    ds_read_b64_tr_b16 v[250:251], v1 offset:35072
    ds_read_b64_tr_b16 v[252:253], v2 offset:2048
    ds_read_b64_tr_b16 v[254:255], v2 offset:2304
    s_waitcnt vmcnt(8) lgkmcnt(10)
    v_mfma_f32_32x32x16_bf16 v[168:183], v[232:235], v[8:11], 0
    buffer_load_dwordx4 v[44:47], v0, s[12:15], s42 offen offset:1024 sc1
    ds_read_b64_tr_b16 v[232:233], v1 offset:35840
    ds_read_b64_tr_b16 v[234:235], v1 offset:36096
    s_waitcnt lgkmcnt(10)
    v_mfma_f32_32x32x16_bf16 v[152:167], v[236:239], v[8:11], 0
    ds_read_b64_tr_b16 v[236:237], v2 offset:3072
    ds_read_b64_tr_b16 v[238:239], v2 offset:3328
    s_waitcnt vmcnt(8) lgkmcnt(10)
    v_mfma_f32_32x32x16_bf16 v[168:183], v[240:243], v[12:15], v[168:183]
    buffer_load_dwordx4 v[48:51], v0, s[12:15], s42 offen offset:2048 sc1
    ds_read_b64_tr_b16 v[240:241], v1 offset:36864
    ds_read_b64_tr_b16 v[242:243], v1 offset:37120
    s_waitcnt lgkmcnt(10)
    v_mfma_f32_32x32x16_bf16 v[152:167], v[244:247], v[12:15], v[152:167]
    ds_read_b64_tr_b16 v[244:245], v2 offset:4096
    ds_read_b64_tr_b16 v[246:247], v2 offset:4352
    s_waitcnt vmcnt(8) lgkmcnt(10)
    v_mfma_f32_32x32x16_bf16 v[168:183], v[248:251], v[16:19], v[168:183]
    buffer_load_dwordx4 v[52:55], v0, s[12:15], s42 offen offset:3072 sc1
    ds_read_b64_tr_b16 v[248:249], v1 offset:37888
    ds_read_b64_tr_b16 v[250:251], v1 offset:38144
    s_waitcnt lgkmcnt(10)
    v_mfma_f32_32x32x16_bf16 v[152:167], v[252:255], v[16:19], v[152:167]
    ds_read_b64_tr_b16 v[252:253], v2 offset:5120
    ds_read_b64_tr_b16 v[254:255], v2 offset:5376
    s_waitcnt vmcnt(8) lgkmcnt(10)
    v_mfma_f32_32x32x16_bf16 v[168:183], v[232:235], v[20:23], v[168:183]
    s_add_u32 s42, s42, 4096
    buffer_load_dwordx4 v[56:59], v0, s[12:15], s42 offen offset:0 sc1
    ds_read_b64_tr_b16 v[232:233], v1 offset:38912
    ds_read_b64_tr_b16 v[234:235], v1 offset:39168
    s_waitcnt lgkmcnt(10)
    v_mfma_f32_32x32x16_bf16 v[152:167], v[236:239], v[20:23], v[152:167]
    ds_read_b64_tr_b16 v[236:237], v2 offset:6144
    ds_read_b64_tr_b16 v[238:239], v2 offset:6400
    s_waitcnt vmcnt(8) lgkmcnt(10)
    v_mfma_f32_32x32x16_bf16 v[168:183], v[240:243], v[24:27], v[168:183]
    buffer_load_dwordx4 v[60:63], v0, s[12:15], s42 offen offset:1024 sc1
    ds_read_b64_tr_b16 v[240:241], v1 offset:39936
    ds_read_b64_tr_b16 v[242:243], v1 offset:40192
    s_waitcnt lgkmcnt(10)
    v_mfma_f32_32x32x16_bf16 v[152:167], v[244:247], v[24:27], v[152:167]
    ds_read_b64_tr_b16 v[244:245], v2 offset:7168
    ds_read_b64_tr_b16 v[246:247], v2 offset:7424
    s_waitcnt vmcnt(8) lgkmcnt(10)
    v_mfma_f32_32x32x16_bf16 v[168:183], v[248:251], v[28:31], v[168:183]
    buffer_load_dwordx4 v[64:67], v0, s[12:15], s42 offen offset:2048 sc1
    ds_read_b64_tr_b16 v[248:249], v1 offset:40960
    ds_read_b64_tr_b16 v[250:251], v1 offset:41216
    s_waitcnt lgkmcnt(10)
    v_mfma_f32_32x32x16_bf16 v[152:167], v[252:255], v[28:31], v[152:167]
    ds_read_b64_tr_b16 v[252:253], v2 offset:8192
    ds_read_b64_tr_b16 v[254:255], v2 offset:8448
    s_waitcnt vmcnt(8) lgkmcnt(10)
    v_mfma_f32_32x32x16_bf16 v[168:183], v[232:235], v[32:35], v[168:183]
    buffer_load_dwordx4 v[68:71], v0, s[12:15], s42 offen offset:3072 sc1
    ds_read_b64_tr_b16 v[232:233], v1 offset:41984
    ds_read_b64_tr_b16 v[234:235], v1 offset:42240
    s_waitcnt lgkmcnt(10)
    v_mfma_f32_32x32x16_bf16 v[152:167], v[236:239], v[32:35], v[152:167]
    ds_read_b64_tr_b16 v[236:237], v2 offset:9216
    ds_read_b64_tr_b16 v[238:239], v2 offset:9472
    s_waitcnt vmcnt(8) lgkmcnt(10)
    v_mfma_f32_32x32x16_bf16 v[168:183], v[240:243], v[36:39], v[168:183]
    s_add_u32 s42, s42, 4096
    buffer_load_dwordx4 v[72:75], v0, s[12:15], s42 offen offset:0 sc1
    ds_read_b64_tr_b16 v[240:241], v1 offset:43008
    ds_read_b64_tr_b16 v[242:243], v1 offset:43264
    s_waitcnt lgkmcnt(10)
    v_mfma_f32_32x32x16_bf16 v[152:167], v[244:247], v[36:39], v[152:167]
    ds_read_b64_tr_b16 v[244:245], v2 offset:10240
    ds_read_b64_tr_b16 v[246:247], v2 offset:10496
    s_waitcnt vmcnt(8) lgkmcnt(10)
    v_mfma_f32_32x32x16_bf16 v[168:183], v[248:251], v[40:43], v[168:183]
    buffer_load_dwordx4 v[76:79], v0, s[12:15], s42 offen offset:1024 sc1
    ds_read_b64_tr_b16 v[248:249], v1 offset:44032
    ds_read_b64_tr_b16 v[250:251], v1 offset:44288
    s_waitcnt lgkmcnt(10)
    v_mfma_f32_32x32x16_bf16 v[152:167], v[252:255], v[40:43], v[152:167]
    ds_read_b64_tr_b16 v[252:253], v2 offset:11264
    ds_read_b64_tr_b16 v[254:255], v2 offset:11520
    s_waitcnt vmcnt(8) lgkmcnt(10)
    v_mfma_f32_32x32x16_bf16 v[168:183], v[232:235], v[44:47], v[168:183]
    buffer_load_dwordx4 v[80:83], v0, s[12:15], s42 offen offset:2048 sc1
    ds_read_b64_tr_b16 v[232:233], v1 offset:45056
    ds_read_b64_tr_b16 v[234:235], v1 offset:45312
    s_waitcnt lgkmcnt(10)
    v_mfma_f32_32x32x16_bf16 v[152:167], v[236:239], v[44:47], v[152:167]
    ds_read_b64_tr_b16 v[236:237], v2 offset:12288
    ds_read_b64_tr_b16 v[238:239], v2 offset:12544
    s_waitcnt vmcnt(8) lgkmcnt(10)
    v_mfma_f32_32x32x16_bf16 v[168:183], v[240:243], v[48:51], v[168:183]
    buffer_load_dwordx4 v[84:87], v0, s[12:15], s42 offen offset:3072 sc1
    ds_read_b64_tr_b16 v[240:241], v1 offset:46080
    ds_read_b64_tr_b16 v[242:243], v1 offset:46336
    s_waitcnt lgkmcnt(10)
    v_mfma_f32_32x32x16_bf16 v[152:167], v[244:247], v[48:51], v[152:167]
    ds_read_b64_tr_b16 v[244:245], v2 offset:13312
    ds_read_b64_tr_b16 v[246:247], v2 offset:13568
    s_waitcnt vmcnt(8) lgkmcnt(10)
    v_mfma_f32_32x32x16_bf16 v[168:183], v[248:251], v[52:55], v[168:183]
    s_add_u32 s42, s42, 4096
    buffer_load_dwordx4 v[88:91], v0, s[12:15], s42 offen offset:0 sc1
    ds_read_b64_tr_b16 v[248:249], v1 offset:47104
    ds_read_b64_tr_b16 v[250:251], v1 offset:47360
    s_waitcnt lgkmcnt(10)
    v_mfma_f32_32x32x16_bf16 v[152:167], v[252:255], v[52:55], v[152:167]
    ds_read_b64_tr_b16 v[252:253], v2 offset:14336
    ds_read_b64_tr_b16 v[254:255], v2 offset:14592
    s_waitcnt vmcnt(8) lgkmcnt(10)
    v_mfma_f32_32x32x16_bf16 v[168:183], v[232:235], v[56:59], v[168:183]
    buffer_load_dwordx4 v[92:95], v0, s[12:15], s42 offen offset:1024 sc1
    ds_read_b64_tr_b16 v[232:233], v1 offset:48128
    ds_read_b64_tr_b16 v[234:235], v1 offset:48384
    s_waitcnt lgkmcnt(10)
    v_mfma_f32_32x32x16_bf16 v[152:167], v[236:239], v[56:59], v[152:167]
    ds_read_b64_tr_b16 v[236:237], v2 offset:15360
    ds_read_b64_tr_b16 v[238:239], v2 offset:15616
    s_waitcnt vmcnt(8) lgkmcnt(10)
    v_mfma_f32_32x32x16_bf16 v[168:183], v[240:243], v[60:63], v[168:183]
    buffer_load_dwordx4 v[96:99], v0, s[12:15], s42 offen offset:2048 sc1
    ds_read_b64_tr_b16 v[240:241], v1 offset:49152
    ds_read_b64_tr_b16 v[242:243], v1 offset:49408
    s_waitcnt lgkmcnt(10)
    v_mfma_f32_32x32x16_bf16 v[152:167], v[244:247], v[60:63], v[152:167]
    ds_read_b64_tr_b16 v[244:245], v2 offset:16384
    ds_read_b64_tr_b16 v[246:247], v2 offset:16640
    s_waitcnt vmcnt(8) lgkmcnt(10)
    v_mfma_f32_32x32x16_bf16 v[168:183], v[248:251], v[64:67], v[168:183]
    buffer_load_dwordx4 v[100:103], v0, s[12:15], s42 offen offset:3072 sc1
    ds_read_b64_tr_b16 v[248:249], v1 offset:50176
    ds_read_b64_tr_b16 v[250:251], v1 offset:50432
    s_waitcnt lgkmcnt(10)
    v_mfma_f32_32x32x16_bf16 v[152:167], v[252:255], v[64:67], v[152:167]
    ds_read_b64_tr_b16 v[252:253], v2 offset:17408
    ds_read_b64_tr_b16 v[254:255], v2 offset:17664
    s_waitcnt vmcnt(8) lgkmcnt(10)
    v_mfma_f32_32x32x16_bf16 v[168:183], v[232:235], v[68:71], v[168:183]
    s_add_u32 s42, s42, 4096
    buffer_load_dwordx4 v[104:107], v0, s[12:15], s42 offen offset:0 sc1
    ds_read_b64_tr_b16 v[232:233], v1 offset:51200
    ds_read_b64_tr_b16 v[234:235], v1 offset:51456
    s_waitcnt lgkmcnt(10)
    v_mfma_f32_32x32x16_bf16 v[152:167], v[236:239], v[68:71], v[152:167]
    ds_read_b64_tr_b16 v[236:237], v2 offset:18432
    ds_read_b64_tr_b16 v[238:239], v2 offset:18688
    s_waitcnt vmcnt(8) lgkmcnt(10)
    v_mfma_f32_32x32x16_bf16 v[168:183], v[240:243], v[72:75], v[168:183]
    buffer_load_dwordx4 v[108:111], v0, s[12:15], s42 offen offset:1024 sc1
    ds_read_b64_tr_b16 v[240:241], v1 offset:52224
    ds_read_b64_tr_b16 v[242:243], v1 offset:52480
    s_waitcnt lgkmcnt(10)
    v_mfma_f32_32x32x16_bf16 v[152:167], v[244:247], v[72:75], v[152:167]
    ds_read_b64_tr_b16 v[244:245], v2 offset:19456
    ds_read_b64_tr_b16 v[246:247], v2 offset:19712
    s_waitcnt vmcnt(8) lgkmcnt(10)
    v_mfma_f32_32x32x16_bf16 v[168:183], v[248:251], v[76:79], v[168:183]
    buffer_load_dwordx4 v[112:115], v0, s[12:15], s42 offen offset:2048 sc1
    ds_read_b64_tr_b16 v[248:249], v1 offset:53248
    ds_read_b64_tr_b16 v[250:251], v1 offset:53504
    s_waitcnt lgkmcnt(10)
    v_mfma_f32_32x32x16_bf16 v[152:167], v[252:255], v[76:79], v[152:167]
    ds_read_b64_tr_b16 v[252:253], v2 offset:20480
    ds_read_b64_tr_b16 v[254:255], v2 offset:20736
    s_waitcnt vmcnt(8) lgkmcnt(10)
    v_mfma_f32_32x32x16_bf16 v[168:183], v[232:235], v[80:83], v[168:183]
    buffer_load_dwordx4 v[116:119], v0, s[12:15], s42 offen offset:3072 sc1
    ds_read_b64_tr_b16 v[232:233], v1 offset:54272
    ds_read_b64_tr_b16 v[234:235], v1 offset:54528
    s_waitcnt lgkmcnt(10)
    v_mfma_f32_32x32x16_bf16 v[152:167], v[236:239], v[80:83], v[152:167]
    ds_read_b64_tr_b16 v[236:237], v2 offset:21504
    ds_read_b64_tr_b16 v[238:239], v2 offset:21760
    s_waitcnt vmcnt(8) lgkmcnt(10)
    v_mfma_f32_32x32x16_bf16 v[168:183], v[240:243], v[84:87], v[168:183]
    s_add_u32 s42, s42, 4096
    buffer_load_dwordx4 v[120:123], v0, s[12:15], s42 offen offset:0 sc1
    ds_read_b64_tr_b16 v[240:241], v1 offset:55296
    ds_read_b64_tr_b16 v[242:243], v1 offset:55552
    s_waitcnt lgkmcnt(10)
    v_mfma_f32_32x32x16_bf16 v[152:167], v[244:247], v[84:87], v[152:167]
    ds_read_b64_tr_b16 v[244:245], v2 offset:22528
    ds_read_b64_tr_b16 v[246:247], v2 offset:22784
    s_waitcnt vmcnt(8) lgkmcnt(10)
    v_mfma_f32_32x32x16_bf16 v[168:183], v[248:251], v[88:91], v[168:183]
    buffer_load_dwordx4 v[124:127], v0, s[12:15], s42 offen offset:1024 sc1
    v_and_b32 v218, 0x1f0, v0
    v_lshlrev_b32 v218, 1, v218
    ds_read_b64_tr_b16 v[248:249], v1 offset:56320
    ds_read_b64_tr_b16 v[250:251], v1 offset:56576
    s_waitcnt lgkmcnt(10)
    v_mfma_f32_32x32x16_bf16 v[152:167], v[252:255], v[88:91], v[152:167]
    v_bfe_u32 v6, v0, 6, 1
    v_lshl_add_u32 v218, v6, 4, v218
    ds_read_b64_tr_b16 v[252:253], v2 offset:23552
    ds_read_b64_tr_b16 v[254:255], v2 offset:23808
    s_waitcnt vmcnt(8) lgkmcnt(10)
    v_mfma_f32_32x32x16_bf16 v[168:183], v[232:235], v[92:95], v[168:183]
    buffer_load_dwordx4 v[128:131], v0, s[12:15], s42 offen offset:2048 sc1
    v_lshrrev_b32 v6, 9, v0
    v_lshl_add_u32 v218, v6, 12, v218
    ds_read_b64_tr_b16 v[232:233], v1 offset:57344
    ds_read_b64_tr_b16 v[234:235], v1 offset:57600
    s_waitcnt lgkmcnt(10)
    v_mfma_f32_32x32x16_bf16 v[152:167], v[236:239], v[92:95], v[152:167]
    s_add_u32 s68, s28, 131072
    v_add_u32 v218, s68, v218
    ds_read_b64_tr_b16 v[236:237], v2 offset:24576
    ds_read_b64_tr_b16 v[238:239], v2 offset:24832
    s_waitcnt vmcnt(8) lgkmcnt(10)
    v_mfma_f32_32x32x16_bf16 v[168:183], v[240:243], v[96:99], v[168:183]
    buffer_load_dwordx4 v[132:135], v0, s[12:15], s42 offen offset:3072 sc1
    v_xor_b32 v219, 16, v218
    v_lshrrev_b32 v6, 1, v0
    ds_read_b64_tr_b16 v[240:241], v1 offset:58368
    ds_read_b64_tr_b16 v[242:243], v1 offset:58624
    s_waitcnt lgkmcnt(10)
    v_mfma_f32_32x32x16_bf16 v[152:167], v[244:247], v[96:99], v[152:167]
    v_bfe_u32 v216, v0, 8, 1
    v_lshlrev_b32 v216, 4, v216
    ds_read_b64_tr_b16 v[244:245], v2 offset:25600
    ds_read_b64_tr_b16 v[246:247], v2 offset:25856
    s_waitcnt vmcnt(8) lgkmcnt(10)
    v_mfma_f32_32x32x16_bf16 v[168:183], v[248:251], v[100:103], v[168:183]
    s_lshl_b32 s59, s21, 10
    s_add_u32 s59, s59, 16547840
    v_and_b32 v209, 0x70, v0
    v_lshlrev_b32 v209, 3, v209
    v_bfe_u32 v208, v0, 7, 1
    v_lshl_add_u32 v209, v208, 14, v209
    buffer_load_dword v208, v209, s[4:7], s59 offen sc1
    v_xor_b32 v6, v6, v216
    s_lshr_b32 s68, s3, 1
    ds_read_b64_tr_b16 v[248:249], v1 offset:59392
    ds_read_b64_tr_b16 v[250:251], v1 offset:59648
    s_waitcnt lgkmcnt(10)
    v_mfma_f32_32x32x16_bf16 v[152:167], v[252:255], v[100:103], v[152:167]
    s_and_b32 s69, s3, 1
    s_lshl_b32 s68, s68, 12
    ds_read_b64_tr_b16 v[252:253], v2 offset:26624
    ds_read_b64_tr_b16 v[254:255], v2 offset:26880
    s_waitcnt vmcnt(8) lgkmcnt(10)
    v_mfma_f32_32x32x16_bf16 v[168:183], v[232:235], v[104:107], v[168:183]
    s_add_u32 m0, s41, 0
    s_nop 0
    buffer_load_dwordx4 v226, s[84:87], s40 offen lds
    s_lshl_b32 s69, s69, 13
    s_add_u32 s68, s68, 131072
    ds_read_b64_tr_b16 v[232:233], v1 offset:60416
    ds_read_b64_tr_b16 v[234:235], v1 offset:60672
    s_waitcnt lgkmcnt(10)
    v_mfma_f32_32x32x16_bf16 v[152:167], v[236:239], v[104:107], v[152:167]
    s_add_u32 s69, s69, s68
    s_add_u32 s68, s68, 16384
    ds_read_b64_tr_b16 v[236:237], v2 offset:27648
    ds_read_b64_tr_b16 v[238:239], v2 offset:27904
    s_waitcnt vmcnt(8) lgkmcnt(10)
    v_mfma_f32_32x32x16_bf16 v[168:183], v[240:243], v[108:111], v[168:183]
    v_add_u32 v216, s69, v6
    v_add_u32 v217, s68, v6
    ds_read_b64_tr_b16 v[240:241], v1 offset:61440
    ds_read_b64_tr_b16 v[242:243], v1 offset:61696
    s_waitcnt lgkmcnt(10)
    v_mfma_f32_32x32x16_bf16 v[152:167], v[244:247], v[108:111], v[152:167]
    ds_read_b64_tr_b16 v[244:245], v2 offset:28672
    ds_read_b64_tr_b16 v[246:247], v2 offset:28928
    s_waitcnt vmcnt(7) lgkmcnt(10)
    v_mfma_f32_32x32x16_bf16 v[168:183], v[248:251], v[112:115], v[168:183]
    s_add_u32 m0, s41, 1024
    s_add_u32 s31, s40, s34
    buffer_load_dwordx4 v226, s[84:87], s31 offen lds
    ds_read_b64_tr_b16 v[248:249], v1 offset:62464
    ds_read_b64_tr_b16 v[250:251], v1 offset:62720
    s_waitcnt lgkmcnt(10)
    v_mfma_f32_32x32x16_bf16 v[152:167], v[252:255], v[112:115], v[152:167]
    ds_read_b64_tr_b16 v[252:253], v2 offset:29696
IT_1:
    s_cbranch_execz IT_5
    ds_read_b64_tr_b16 v[254:255], v2 offset:29952
    s_waitcnt vmcnt(7) lgkmcnt(10)
    v_mfma_f32_32x32x16_bf16 v[168:183], v[232:235], v[116:119], v[168:183]
    ds_read_b64_tr_b16 v[232:233], v1 offset:63488
    ds_read_b64_tr_b16 v[234:235], v1 offset:63744
    s_waitcnt lgkmcnt(10)
    v_mfma_f32_32x32x16_bf16 v[152:167], v[236:239], v[116:119], v[152:167]
    ds_read_b64_tr_b16 v[236:237], v2 offset:30720
    ds_read_b64_tr_b16 v[238:239], v2 offset:30976
    s_waitcnt vmcnt(6) lgkmcnt(10)
    v_mfma_f32_32x32x16_bf16 v[168:183], v[240:243], v[120:123], v[168:183]
    s_add_u32 m0, s41, 2048
    s_add_u32 s40, s40, s33
    buffer_load_dwordx4 v226, s[84:87], s40 offen lds
    ds_read_b64_tr_b16 v[240:241], v1 offset:64512
    ds_read_b64_tr_b16 v[242:243], v1 offset:64768
    s_waitcnt lgkmcnt(10)
    v_mfma_f32_32x32x16_bf16 v[152:167], v[244:247], v[120:123], v[152:167]
    ds_read_b64_tr_b16 v[244:245], v2 offset:31744
    ds_read_b64_tr_b16 v[246:247], v2 offset:32000
    s_waitcnt vmcnt(6) lgkmcnt(10)
    v_mfma_f32_32x32x16_bf16 v[168:183], v[248:251], v[124:127], v[168:183]
    s_waitcnt lgkmcnt(8)
    v_mfma_f32_32x32x16_bf16 v[152:167], v[252:255], v[124:127], v[152:167]
    s_waitcnt vmcnt(5) lgkmcnt(6)
    v_mfma_f32_32x32x16_bf16 v[168:183], v[232:235], v[128:131], v[168:183]
    s_add_u32 m0, s41, 3072
    s_add_u32 s31, s40, s34
    buffer_load_dwordx4 v226, s[84:87], s31 offen lds
    s_waitcnt lgkmcnt(4)
    v_mfma_f32_32x32x16_bf16 v[152:167], v[236:239], v[128:131], v[152:167]
    s_waitcnt vmcnt(5) lgkmcnt(2)
    v_mfma_f32_32x32x16_bf16 v[168:183], v[240:243], v[132:135], v[168:183]
    s_waitcnt lgkmcnt(0)
    v_mfma_f32_32x32x16_bf16 v[152:167], v[244:247], v[132:135], v[152:167]
    s_waitcnt vmcnt(4)
    v_xor_b32 v208, s80, v208
    v_cmp_lt_u32 vcc, 15, v208
    s_nop 0
    s_cbranch_vccnz Lspin_1
Lspin_1_r:
    s_nop 4
    v_cvt_pk_bf16_f32 v168, v168, v169
    v_cvt_pk_bf16_f32 v169, v170, v171
    v_cvt_pk_bf16_f32 v170, v172, v173
    v_cvt_pk_bf16_f32 v171, v174, v175
    v_cvt_pk_bf16_f32 v172, v176, v177
    v_cvt_pk_bf16_f32 v173, v178, v179
    v_cvt_pk_bf16_f32 v174, v180, v181
    v_cvt_pk_bf16_f32 v175, v182, v183
    v_mfma_f32_32x32x16_bf16 v[136:151], a[232:235], v[168:171], 0
    s_nop 0
    v_mfma_f32_32x32x16_bf16 v[136:151], a[236:239], v[172:175], v[136:151]
    s_add_u32 m0, s47, 0
    s_nop 0
    buffer_load_dwordx4 v226, s[84:87], s46 offen lds
    s_nop 8
    v_max3_f32 v230, v136, v137, v138
    v_min3_f32 v231, v136, v137, v138
    v_max3_f32 v230, v230, v139, v140
    v_min3_f32 v231, v231, v139, v140
    v_max3_f32 v230, v230, v141, v142
    v_min3_f32 v231, v231, v141, v142
    v_max3_f32 v230, v230, v143, v144
    v_min3_f32 v231, v231, v143, v144
    v_max3_f32 v230, v230, v145, v146
    v_min3_f32 v231, v231, v145, v146
    v_max3_f32 v230, v230, v147, v148
    v_min3_f32 v231, v231, v147, v148
    v_max3_f32 v230, v230, v149, v150
    v_min3_f32 v231, v231, v149, v150
    v_max_f32 v230, v230, v151
    v_min_f32 v231, v231, v151
    v_pk_mul_f32 v[230:231], v[230:231], v[228:229] op_sel:[0,1] op_sel_hi:[1,1]
    v_pk_fma_f32 v[184:185], v[136:137], v[228:229], v[230:231] op_sel:[0,1,0] op_sel_hi:[1,1,0] neg_lo:[0,0,1] neg_hi:[0,0,1]
    v_pk_fma_f32 v[186:187], v[138:139], v[228:229], v[230:231] op_sel:[0,1,0] op_sel_hi:[1,1,0] neg_lo:[0,0,1] neg_hi:[0,0,1]
    v_pk_fma_f32 v[188:189], v[140:141], v[228:229], v[230:231] op_sel:[0,1,0] op_sel_hi:[1,1,0] neg_lo:[0,0,1] neg_hi:[0,0,1]
    v_pk_fma_f32 v[190:191], v[142:143], v[228:229], v[230:231] op_sel:[0,1,0] op_sel_hi:[1,1,0] neg_lo:[0,0,1] neg_hi:[0,0,1]
    v_pk_fma_f32 v[192:193], v[144:145], v[228:229], v[230:231] op_sel:[0,1,0] op_sel_hi:[1,1,0] neg_lo:[0,0,1] neg_hi:[0,0,1]
    v_pk_fma_f32 v[194:195], v[146:147], v[228:229], v[230:231] op_sel:[0,1,0] op_sel_hi:[1,1,0] neg_lo:[0,0,1] neg_hi:[0,0,1]
    v_pk_fma_f32 v[196:197], v[148:149], v[228:229], v[230:231] op_sel:[0,1,0] op_sel_hi:[1,1,0] neg_lo:[0,0,1] neg_hi:[0,0,1]
    v_pk_fma_f32 v[198:199], v[150:151], v[228:229], v[230:231] op_sel:[0,1,0] op_sel_hi:[1,1,0] neg_lo:[0,0,1] neg_hi:[0,0,1]
    s_barrier
    s_add_u32 m0, s47, 1024
    s_add_u32 s31, s46, s34
    buffer_load_dwordx4 v226, s[84:87], s31 offen lds
    v_exp_f32 v184, v184
    v_exp_f32 v185, v185
    v_exp_f32 v186, v186
    v_exp_f32 v187, v187
    v_cvt_pk_bf16_f32 v152, v152, v153
    v_cvt_pk_bf16_f32 v153, v154, v155
    v_cvt_pk_bf16_f32 v154, v156, v157
    v_cvt_pk_bf16_f32 v155, v158, v159
    ds_write_b128 v218, v[152:155] offset:16384
    v_exp_f32 v188, v188
    v_exp_f32 v189, v189
    v_exp_f32 v190, v190
    v_exp_f32 v191, v191
    s_add_u32 m0, s47, 2048
    s_add_u32 s46, s46, s33
    buffer_load_dwordx4 v226, s[84:87], s46 offen lds
    v_exp_f32 v192, v192
    v_exp_f32 v193, v193
    v_exp_f32 v194, v194
    v_exp_f32 v195, v195
    v_cvt_pk_bf16_f32 v156, v160, v161
    v_cvt_pk_bf16_f32 v157, v162, v163
    v_cvt_pk_bf16_f32 v158, v164, v165
    v_cvt_pk_bf16_f32 v159, v166, v167
    ds_write_b128 v219, v[156:159] offset:16384
    v_exp_f32 v196, v196
    v_exp_f32 v197, v197
    v_exp_f32 v198, v198
    v_exp_f32 v199, v199
    s_add_u32 m0, s47, 3072
    s_add_u32 s31, s46, s34
    buffer_load_dwordx4 v226, s[84:87], s31 offen lds
    v_pk_fma_f32 v[200:201], v[136:137], v[228:229], v[230:231] op_sel:[0,1,1] op_sel_hi:[1,1,1] neg_lo:[1,0,0] neg_hi:[1,0,0]
    v_pk_fma_f32 v[202:203], v[138:139], v[228:229], v[230:231] op_sel:[0,1,1] op_sel_hi:[1,1,1] neg_lo:[1,0,0] neg_hi:[1,0,0]
    v_pk_fma_f32 v[204:205], v[140:141], v[228:229], v[230:231] op_sel:[0,1,1] op_sel_hi:[1,1,1] neg_lo:[1,0,0] neg_hi:[1,0,0]
    v_pk_fma_f32 v[206:207], v[142:143], v[228:229], v[230:231] op_sel:[0,1,1] op_sel_hi:[1,1,1] neg_lo:[1,0,0] neg_hi:[1,0,0]
    v_pk_fma_f32 v[208:209], v[144:145], v[228:229], v[230:231] op_sel:[0,1,1] op_sel_hi:[1,1,1] neg_lo:[1,0,0] neg_hi:[1,0,0]
    v_pk_fma_f32 v[210:211], v[146:147], v[228:229], v[230:231] op_sel:[0,1,1] op_sel_hi:[1,1,1] neg_lo:[1,0,0] neg_hi:[1,0,0]
    v_pk_fma_f32 v[212:213], v[148:149], v[228:229], v[230:231] op_sel:[0,1,1] op_sel_hi:[1,1,1] neg_lo:[1,0,0] neg_hi:[1,0,0]
    v_pk_fma_f32 v[214:215], v[150:151], v[228:229], v[230:231] op_sel:[0,1,1] op_sel_hi:[1,1,1] neg_lo:[1,0,0] neg_hi:[1,0,0]
    v_pk_add_f32 v[220:221], v[184:185], v[186:187]
    v_pk_add_f32 v[222:223], v[188:189], v[190:191]
    v_pk_add_f32 v[220:221], v[220:221], v[192:193]
    v_pk_add_f32 v[222:223], v[222:223], v[194:195]
    v_pk_add_f32 v[220:221], v[220:221], v[196:197]
    v_pk_add_f32 v[222:223], v[222:223], v[198:199]
    v_pk_add_f32 v[220:221], v[220:221], v[222:223]
    v_add_f32 v220, v220, v221
    v_rcp_f32 v224, v220
    s_add_u32 s30, s55, 0
    s_and_b32 s30, s30, 7
    s_lshl_b32 s31, s30, 10
    s_add_u32 m0, s56, s31
    s_mul_i32 s30, s30, 49152
    s_add_u32 s30, s30, s54
    buffer_load_dwordx4 v227, s[64:67], s30 offen lds
    v_exp_f32 v200, v200
    v_exp_f32 v201, v201
    v_exp_f32 v202, v202
    v_exp_f32 v203, v203
    v_pk_mul_f32 v[184:185], v[184:185], v[224:225] op_sel:[0,0] op_sel_hi:[1,0]
    v_pk_mul_f32 v[186:187], v[186:187], v[224:225] op_sel:[0,0] op_sel_hi:[1,0]
    v_pk_mul_f32 v[188:189], v[188:189], v[224:225] op_sel:[0,0] op_sel_hi:[1,0]
    v_pk_mul_f32 v[190:191], v[190:191], v[224:225] op_sel:[0,0] op_sel_hi:[1,0]
    v_cvt_pk_bf16_f32 v184, v184, v185
    v_cvt_pk_bf16_f32 v185, v186, v187
    v_cvt_pk_bf16_f32 v186, v188, v189
    v_cvt_pk_bf16_f32 v187, v190, v191
    ds_write_b128 v218, v[184:187] offset:0
    v_exp_f32 v204, v204
    v_exp_f32 v205, v205
    v_exp_f32 v206, v206
    v_exp_f32 v207, v207
    s_add_u32 s30, s55, 1
    s_and_b32 s30, s30, 7
    s_lshl_b32 s31, s30, 10
    s_add_u32 m0, s56, s31
    s_mul_i32 s30, s30, 49152
    s_add_u32 s30, s30, s54
    buffer_load_dwordx4 v227, s[64:67], s30 offen lds
    v_exp_f32 v208, v208
    v_exp_f32 v209, v209
    v_exp_f32 v210, v210
    v_exp_f32 v211, v211
    v_pk_mul_f32 v[192:193], v[192:193], v[224:225] op_sel:[0,0] op_sel_hi:[1,0]
    v_pk_mul_f32 v[194:195], v[194:195], v[224:225] op_sel:[0,0] op_sel_hi:[1,0]
    v_pk_mul_f32 v[196:197], v[196:197], v[224:225] op_sel:[0,0] op_sel_hi:[1,0]
    v_pk_mul_f32 v[198:199], v[198:199], v[224:225] op_sel:[0,0] op_sel_hi:[1,0]
    v_cvt_pk_bf16_f32 v188, v192, v193
    v_cvt_pk_bf16_f32 v189, v194, v195
    v_cvt_pk_bf16_f32 v190, v196, v197
    v_cvt_pk_bf16_f32 v191, v198, v199
    ds_write_b128 v219, v[188:191] offset:0
    v_exp_f32 v212, v212
    v_exp_f32 v213, v213
    v_exp_f32 v214, v214
    v_exp_f32 v215, v215
    v_pk_add_f32 v[220:221], v[200:201], v[202:203]
    v_pk_add_f32 v[222:223], v[204:205], v[206:207]
    v_pk_add_f32 v[220:221], v[220:221], v[208:209]
    v_pk_add_f32 v[222:223], v[222:223], v[210:211]
    v_pk_add_f32 v[220:221], v[220:221], v[212:213]
    v_pk_add_f32 v[222:223], v[222:223], v[214:215]
    v_pk_add_f32 v[220:221], v[220:221], v[222:223]
    v_add_f32 v220, v220, v221
    v_rcp_f32 v225, v220
    s_nop 0
    v_pk_mul_f32 v[200:201], v[200:201], v[224:225] op_sel:[0,1] op_sel_hi:[1,1]
    v_pk_mul_f32 v[202:203], v[202:203], v[224:225] op_sel:[0,1] op_sel_hi:[1,1]
    v_pk_mul_f32 v[204:205], v[204:205], v[224:225] op_sel:[0,1] op_sel_hi:[1,1]
    v_pk_mul_f32 v[206:207], v[206:207], v[224:225] op_sel:[0,1] op_sel_hi:[1,1]
    v_cvt_pk_bf16_f32 v200, v200, v201
    v_cvt_pk_bf16_f32 v201, v202, v203
    v_cvt_pk_bf16_f32 v202, v204, v205
    v_cvt_pk_bf16_f32 v203, v206, v207
    ds_write_b128 v218, v[200:203] offset:8192
    v_pk_mul_f32 v[208:209], v[208:209], v[224:225] op_sel:[0,1] op_sel_hi:[1,1]
    v_pk_mul_f32 v[210:211], v[210:211], v[224:225] op_sel:[0,1] op_sel_hi:[1,1]
    v_pk_mul_f32 v[212:213], v[212:213], v[224:225] op_sel:[0,1] op_sel_hi:[1,1]
    v_pk_mul_f32 v[214:215], v[214:215], v[224:225] op_sel:[0,1] op_sel_hi:[1,1]
    v_cvt_pk_bf16_f32 v204, v208, v209
    v_cvt_pk_bf16_f32 v205, v210, v211
    v_cvt_pk_bf16_f32 v206, v212, v213
    v_cvt_pk_bf16_f32 v207, v214, v215
    ds_write_b128 v219, v[204:207] offset:8192
    s_waitcnt lgkmcnt(0)
    s_barrier
    ds_read_b64_tr_b16 v[152:153], v216 offset:0
    ds_read_b64_tr_b16 v[154:155], v216 offset:512
    ds_read_b64_tr_b16 v[156:157], v217 offset:0
    ds_read_b64_tr_b16 v[158:159], v217 offset:512
    ds_read_b64_tr_b16 v[160:161], v216 offset:1024
    ds_read_b64_tr_b16 v[162:163], v216 offset:1536
    ds_read_b64_tr_b16 v[164:165], v217 offset:1024
    ds_read_b64_tr_b16 v[166:167], v217 offset:1536
    ds_read_b64_tr_b16 v[168:169], v216 offset:2048
    ds_read_b64_tr_b16 v[170:171], v216 offset:2560
    ds_read_b64_tr_b16 v[172:173], v217 offset:2048
    ds_read_b64_tr_b16 v[174:175], v217 offset:2560
    v_mov_b32 v184, 0x3f803f80
    v_mov_b32 v185, 0x3f803f80
    v_mov_b32 v186, 0x3f803f80
    v_mov_b32 v187, 0x3f803f80
    ds_read_b64_tr_b16 v[176:177], v216 offset:3072
    ds_read_b64_tr_b16 v[178:179], v216 offset:3584
    ds_read_b64_tr_b16 v[180:181], v217 offset:3072
    ds_read_b64_tr_b16 v[182:183], v217 offset:3584
    s_waitcnt lgkmcnt(12)
    v_mfma_f32_16x16x32_bf16 v[188:191], v[152:155], v[156:159], 0
    v_mfma_f32_16x16x32_bf16 v[192:195], v[152:155], v[184:187], 0
    s_waitcnt lgkmcnt(8)
    v_mfma_f32_16x16x32_bf16 v[188:191], v[160:163], v[164:167], v[188:191]
    v_mfma_f32_16x16x32_bf16 v[192:195], v[160:163], v[184:187], v[192:195]
    s_waitcnt lgkmcnt(4)
    v_mfma_f32_16x16x32_bf16 v[188:191], v[168:171], v[172:175], v[188:191]
    v_mfma_f32_16x16x32_bf16 v[192:195], v[168:171], v[184:187], v[192:195]
    s_waitcnt lgkmcnt(0)
    v_mfma_f32_16x16x32_bf16 v[188:191], v[176:179], v[180:183], v[188:191]
    v_mfma_f32_16x16x32_bf16 v[192:195], v[176:179], v[184:187], v[192:195]
    v_lshrrev_b32 v6, 4, v0
    v_lshrrev_b32 v216, 9, v0
    v_lshlrev_b32 v217, 8, v216
    v_sub_u32 v217, v0, v217
    s_mov_b32 s30, 0x00010001
    s_mov_b32 s31, 0x00010001
    s_nop 0
    v_cvt_pk_bf16_f32 v188, v188, v189
    v_cvt_pk_bf16_f32 v189, v190, v191
    s_nop 0
    v_permlane16_swap_b32 v188, v190
    v_permlane16_swap_b32 v189, v191
    s_mov_b32 exec_lo, 0xffff
    s_mov_b32 exec_hi, 0xffff
    buffer_store_dwordx4 v[188:191], v217, s[4:7], s99 offen sc1
    s_mov_b64 exec, s[30:31]
    buffer_store_dwordx4 v[192:195], v6, s[4:7], s82 offen sc1
    s_mov_b64 exec, -1
    v_and_b32 v216, 15, v6
    v_and_b32 v217, 0x30, v6
    v_lshl_add_u32 v216, v216, 8, v217
    s_mov_b32 s47, s98
    v_accvgpr_read_b32 v248, a225
    v_accvgpr_read_b32 v252, a224
    s_lshl_b32 s30, s3, 8
    s_add_u32 s30, s30, 159744
    v_xor_b32 v249, 32, v248
    v_lshl_add_u32 v250, v6, 2, s30
    v_lshlrev_b32 v251, 2, v3
    v_add_u32 v251, 159744, v251
    s_add_u32 s30, s55, 2
    s_and_b32 s30, s30, 7
    s_lshl_b32 s31, s30, 10
    s_add_u32 m0, s56, s31
    s_mul_i32 s30, s30, 49152
    s_add_u32 s30, s30, s54
    buffer_load_dwordx4 v227, s[64:67], s30 offen lds
    s_add_u32 s30, s55, 3
    s_and_b32 s30, s30, 7
    s_lshl_b32 s31, s30, 10
    s_add_u32 m0, s56, s31
    s_mul_i32 s30, s30, 49152
    s_add_u32 s30, s30, s54
    buffer_load_dwordx4 v227, s[64:67], s30 offen lds
    s_waitcnt vmcnt(6)
    ds_read_b128 v[200:203], v248 offset:0
    ds_read_b128 v[204:207], v249 offset:0
    ds_read_b128 v[208:211], v248 offset:2048
    ds_read_b128 v[212:215], v249 offset:2048
    ds_read_b128 v[232:235], v248 offset:4096
    ds_read_b128 v[236:239], v249 offset:4096
    ds_read_b128 v[240:243], v248 offset:6144
    ds_read_b128 v[244:247], v249 offset:6144
    s_add_u32 s30, s55, 4
    s_and_b32 s30, s30, 7
    s_lshl_b32 s31, s30, 10
    s_add_u32 m0, s56, s31
    s_mul_i32 s30, s30, 49152
    s_add_u32 s30, s30, s54
    buffer_load_dwordx4 v227, s[64:67], s30 offen lds
    s_add_u32 s30, s55, 5
    s_and_b32 s30, s30, 7
    s_lshl_b32 s31, s30, 10
    s_add_u32 m0, s56, s31
    s_mul_i32 s30, s30, 49152
    s_add_u32 s30, s30, s54
    buffer_load_dwordx4 v227, s[64:67], s30 offen lds
    s_waitcnt lgkmcnt(6)
    v_mfma_f32_32x32x16_bf16 v[136:151], v[200:203], a[216:219], 0
    v_mfma_f32_32x32x16_bf16 v[136:151], v[204:207], a[220:223], v[136:151]
    s_add_u32 s30, s55, 6
    s_and_b32 s30, s30, 7
    s_lshl_b32 s31, s30, 10
    s_add_u32 m0, s56, s31
    s_mul_i32 s30, s30, 49152
    s_add_u32 s30, s30, s54
    buffer_load_dwordx4 v227, s[64:67], s30 offen lds
    s_waitcnt lgkmcnt(4)
    v_mfma_f32_32x32x16_bf16 v[152:167], v[208:211], a[216:219], 0
    v_mfma_f32_32x32x16_bf16 v[152:167], v[212:215], a[220:223], v[152:167]
    s_add_u32 s30, s55, 7
    s_and_b32 s30, s30, 7
    s_lshl_b32 s31, s30, 10
    s_add_u32 m0, s56, s31
    s_mul_i32 s30, s30, 49152
    s_add_u32 s30, s30, s54
    buffer_load_dwordx4 v227, s[64:67], s30 offen lds
    s_waitcnt lgkmcnt(2)
    v_mfma_f32_32x32x16_bf16 v[168:183], v[232:235], a[216:219], 0
    v_add_f32 v200, v136, v138
    v_add_f32 v201, v137, v139
    v_add_f32 v202, v140, v142
    v_add_f32 v203, v141, v143
    v_add_f32 v200, v200, v144
    v_mfma_f32_32x32x16_bf16 v[168:183], v[236:239], a[220:223], v[168:183]
    v_add_f32 v201, v201, v145
    v_add_f32 v202, v202, v146
    v_add_f32 v203, v203, v147
    v_add_f32 v200, v200, v148
    v_add_f32 v201, v201, v149
    s_waitcnt lgkmcnt(0)
    v_mfma_f32_32x32x16_bf16 v[184:199], v[240:243], a[216:219], 0
    v_add_f32 v202, v202, v150
    v_add_f32 v203, v203, v151
    v_add_f32 v200, v200, v152
    v_add_f32 v201, v201, v153
    v_add_f32 v202, v202, v154
    v_mfma_f32_32x32x16_bf16 v[184:199], v[244:247], a[220:223], v[184:199]
    v_add_f32 v203, v203, v155
    v_add_f32 v200, v200, v156
    v_add_f32 v201, v201, v157
    v_add_f32 v202, v202, v158
    v_add_f32 v203, v203, v159
    v_add_f32 v200, v200, v160
    v_add_f32 v201, v201, v161
    v_add_f32 v202, v202, v162
    v_add_f32 v203, v203, v163
    v_pk_add_f32 v[200:201], v[200:201], v[164:165]
    v_pk_add_f32 v[202:203], v[202:203], v[166:167]
    v_pk_add_f32 v[200:201], v[200:201], v[168:169]
    v_pk_add_f32 v[202:203], v[202:203], v[170:171]
    v_pk_add_f32 v[200:201], v[200:201], v[172:173]
    v_pk_add_f32 v[202:203], v[202:203], v[174:175]
    v_pk_add_f32 v[200:201], v[200:201], v[176:177]
    v_pk_add_f32 v[202:203], v[202:203], v[178:179]
    v_pk_add_f32 v[200:201], v[200:201], v[180:181]
    v_pk_add_f32 v[202:203], v[202:203], v[182:183]
    v_pk_add_f32 v[200:201], v[200:201], v[184:185]
    v_pk_add_f32 v[202:203], v[202:203], v[186:187]
    v_pk_add_f32 v[200:201], v[200:201], v[188:189]
    v_pk_add_f32 v[202:203], v[202:203], v[190:191]
    v_pk_add_f32 v[200:201], v[200:201], v[192:193]
    v_pk_add_f32 v[202:203], v[202:203], v[194:195]
    v_pk_add_f32 v[200:201], v[200:201], v[196:197]
    v_pk_add_f32 v[202:203], v[202:203], v[198:199]
    v_pk_add_f32 v[200:201], v[200:201], v[202:203]
    v_add_f32 v200, v200, v201
    ds_write_b32 v250, v200
    v_lshrrev_b32 v210, 3, v6
    v_and_b32 v211, 7, v6
    v_bfe_u32 v212, v6, 4, 1
    v_lshlrev_b32 v212, 2, v212
    v_xor_b32 v211, v211, v212
    v_lshlrev_b32 v211, 4, v211
    v_lshl_add_u32 v210, v210, 10, v211
    s_lshl_b32 s70, s3, 17
    s_lshl_b32 s31, s23, 7
    s_add_u32 s70, s70, s31
    s_lshl_b32 s71, s3, 14
    s_lshr_b32 s31, s3, 1
    s_lshl_b32 s31, s31, 15
    s_add_u32 s71, s71, s31
    s_add_u32 s71, s71, 32768
    s_cmp_eq_u32 s39, 0
    s_cselect_b64 s[32:33], 0, -1
    s_waitcnt lgkmcnt(0)
    s_barrier
    ds_read2_b32 v[200:201], v251 offset0:0 offset1:32
    ds_read2_b32 v[202:203], v251 offset0:64 offset1:96
    ds_read2_b32 v[204:205], v251 offset0:128 offset1:160
    ds_read2_b32 v[206:207], v251 offset0:192 offset1:224
    s_add_u32 m0, s71, 0
    s_nop 0
    buffer_load_dwordx4 v210, s[88:91], s70 offen lds
    s_add_u32 m0, s71, 1024
    s_add_u32 s70, s70, 8192
    buffer_load_dwordx4 v210, s[88:91], s70 offen lds
    s_add_u32 m0, s71, 2048
    s_add_u32 s70, s70, 8192
    buffer_load_dwordx4 v210, s[88:91], s70 offen lds
    s_add_u32 m0, s71, 3072
    s_add_u32 s70, s70, 8192
    buffer_load_dwordx4 v210, s[88:91], s70 offen lds
    s_waitcnt lgkmcnt(0)
    v_pk_add_f32 v[200:201], v[200:201], v[202:203]
    v_pk_add_f32 v[204:205], v[204:205], v[206:207]
    v_pk_add_f32 v[200:201], v[200:201], v[204:205]
    v_add_f32 v200, v200, v201
    v_mul_f32 v200, s39, v200
    v_cndmask_b32 v200, 0, v200, s[32:33]
    v_mov_b32 v201, v200
    s_cmp_eq_u32 s39, 0
    s_cselect_b32 s33, 0, 0x3e000000
    s_mov_b32 s32, 0x3f803f80
    v_pk_add_f32 v[136:137], v[136:137], v[200:201] op_sel:[0,0] op_sel_hi:[1,0]
    v_pk_add_f32 v[138:139], v[138:139], v[200:201] op_sel:[0,0] op_sel_hi:[1,0]
    v_pk_add_f32 v[140:141], v[140:141], v[200:201] op_sel:[0,0] op_sel_hi:[1,0]
    v_pk_add_f32 v[142:143], v[142:143], v[200:201] op_sel:[0,0] op_sel_hi:[1,0]
    v_pk_add_f32 v[202:203], v[136:137], v[138:139]
    v_pk_add_f32 v[204:205], v[140:141], v[142:143]
    v_cvt_pk_bf16_f32 v136, v136, v137
    v_pk_add_f32 v[202:203], v[202:203], v[204:205]
    v_cvt_pk_bf16_f32 v137, v138, v139
    v_cvt_pk_bf16_f32 v138, v140, v141
    v_add_f32 v202, v202, v203
    v_cvt_pk_bf16_f32 v139, v142, v143
    v_dot2_f32_bf16 v202, v136, s32, v202 neg_lo:[1,0,0] neg_hi:[1,0,0]
    v_dot2_f32_bf16 v202, v137, s32, v202 neg_lo:[1,0,0] neg_hi:[1,0,0]
    v_dot2_f32_bf16 v202, v138, s32, v202 neg_lo:[1,0,0] neg_hi:[1,0,0]
    v_dot2_f32_bf16 v202, v139, s32, v202 neg_lo:[1,0,0] neg_hi:[1,0,0]
    s_mov_b32 s58, s35
    buffer_store_dwordx4 v[136:139], v252, s[92:95], s58 offen sc1
    s_nop 0
    v_fma_f32 v200, v202, s33, v201
    v_pk_add_f32 v[144:145], v[144:145], v[200:201] op_sel:[0,0] op_sel_hi:[1,0]
    v_pk_add_f32 v[146:147], v[146:147], v[200:201] op_sel:[0,0] op_sel_hi:[1,0]
    v_pk_add_f32 v[148:149], v[148:149], v[200:201] op_sel:[0,0] op_sel_hi:[1,0]
    v_pk_add_f32 v[150:151], v[150:151], v[200:201] op_sel:[0,0] op_sel_hi:[1,0]
    v_pk_add_f32 v[202:203], v[144:145], v[146:147]
    v_pk_add_f32 v[204:205], v[148:149], v[150:151]
    v_cvt_pk_bf16_f32 v140, v144, v145
    v_pk_add_f32 v[202:203], v[202:203], v[204:205]
    v_cvt_pk_bf16_f32 v141, v146, v147
    v_cvt_pk_bf16_f32 v142, v148, v149
    v_add_f32 v202, v202, v203
    v_cvt_pk_bf16_f32 v143, v150, v151
    v_dot2_f32_bf16 v202, v140, s32, v202 neg_lo:[1,0,0] neg_hi:[1,0,0]
    v_dot2_f32_bf16 v202, v141, s32, v202 neg_lo:[1,0,0] neg_hi:[1,0,0]
    v_dot2_f32_bf16 v202, v142, s32, v202 neg_lo:[1,0,0] neg_hi:[1,0,0]
    v_dot2_f32_bf16 v202, v143, s32, v202 neg_lo:[1,0,0] neg_hi:[1,0,0]
    s_add_u32 s58, s58, s38
    buffer_store_dwordx4 v[140:143], v252, s[92:95], s58 offen sc1
    s_nop 0
    v_fma_f32 v200, v202, s33, v201
    v_pk_add_f32 v[152:153], v[152:153], v[200:201] op_sel:[0,0] op_sel_hi:[1,0]
    v_pk_add_f32 v[154:155], v[154:155], v[200:201] op_sel:[0,0] op_sel_hi:[1,0]
    v_pk_add_f32 v[156:157], v[156:157], v[200:201] op_sel:[0,0] op_sel_hi:[1,0]
    v_pk_add_f32 v[158:159], v[158:159], v[200:201] op_sel:[0,0] op_sel_hi:[1,0]
    v_pk_add_f32 v[202:203], v[152:153], v[154:155]
    v_pk_add_f32 v[204:205], v[156:157], v[158:159]
    v_cvt_pk_bf16_f32 v144, v152, v153
    v_pk_add_f32 v[202:203], v[202:203], v[204:205]
    v_cvt_pk_bf16_f32 v145, v154, v155
    v_cvt_pk_bf16_f32 v146, v156, v157
    v_add_f32 v202, v202, v203
    v_cvt_pk_bf16_f32 v147, v158, v159
    v_dot2_f32_bf16 v202, v144, s32, v202 neg_lo:[1,0,0] neg_hi:[1,0,0]
    v_dot2_f32_bf16 v202, v145, s32, v202 neg_lo:[1,0,0] neg_hi:[1,0,0]
    v_dot2_f32_bf16 v202, v146, s32, v202 neg_lo:[1,0,0] neg_hi:[1,0,0]
    v_dot2_f32_bf16 v202, v147, s32, v202 neg_lo:[1,0,0] neg_hi:[1,0,0]
    s_add_u32 s58, s35, s37
    buffer_store_dwordx4 v[144:147], v252, s[92:95], s58 offen sc1
    s_nop 0
    v_fma_f32 v200, v202, s33, v201
    v_pk_add_f32 v[160:161], v[160:161], v[200:201] op_sel:[0,0] op_sel_hi:[1,0]
    v_pk_add_f32 v[162:163], v[162:163], v[200:201] op_sel:[0,0] op_sel_hi:[1,0]
    v_pk_add_f32 v[164:165], v[164:165], v[200:201] op_sel:[0,0] op_sel_hi:[1,0]
    v_pk_add_f32 v[166:167], v[166:167], v[200:201] op_sel:[0,0] op_sel_hi:[1,0]
    v_pk_add_f32 v[202:203], v[160:161], v[162:163]
    v_pk_add_f32 v[204:205], v[164:165], v[166:167]
    v_cvt_pk_bf16_f32 v148, v160, v161
    v_pk_add_f32 v[202:203], v[202:203], v[204:205]
    v_cvt_pk_bf16_f32 v149, v162, v163
    v_cvt_pk_bf16_f32 v150, v164, v165
    v_add_f32 v202, v202, v203
    v_cvt_pk_bf16_f32 v151, v166, v167
    v_dot2_f32_bf16 v202, v148, s32, v202 neg_lo:[1,0,0] neg_hi:[1,0,0]
    v_dot2_f32_bf16 v202, v149, s32, v202 neg_lo:[1,0,0] neg_hi:[1,0,0]
    v_dot2_f32_bf16 v202, v150, s32, v202 neg_lo:[1,0,0] neg_hi:[1,0,0]
    v_dot2_f32_bf16 v202, v151, s32, v202 neg_lo:[1,0,0] neg_hi:[1,0,0]
    s_add_u32 s58, s58, s38
    buffer_store_dwordx4 v[148:151], v252, s[92:95], s58 offen sc1
    s_nop 0
    v_fma_f32 v200, v202, s33, v201
    v_pk_add_f32 v[168:169], v[168:169], v[200:201] op_sel:[0,0] op_sel_hi:[1,0]
    v_pk_add_f32 v[170:171], v[170:171], v[200:201] op_sel:[0,0] op_sel_hi:[1,0]
    v_pk_add_f32 v[172:173], v[172:173], v[200:201] op_sel:[0,0] op_sel_hi:[1,0]
    v_pk_add_f32 v[174:175], v[174:175], v[200:201] op_sel:[0,0] op_sel_hi:[1,0]
    v_pk_add_f32 v[202:203], v[168:169], v[170:171]
    v_pk_add_f32 v[204:205], v[172:173], v[174:175]
    v_cvt_pk_bf16_f32 v152, v168, v169
    v_pk_add_f32 v[202:203], v[202:203], v[204:205]
    v_cvt_pk_bf16_f32 v153, v170, v171
    v_cvt_pk_bf16_f32 v154, v172, v173
    v_add_f32 v202, v202, v203
    v_cvt_pk_bf16_f32 v155, v174, v175
    v_dot2_f32_bf16 v202, v152, s32, v202 neg_lo:[1,0,0] neg_hi:[1,0,0]
    v_dot2_f32_bf16 v202, v153, s32, v202 neg_lo:[1,0,0] neg_hi:[1,0,0]
    v_dot2_f32_bf16 v202, v154, s32, v202 neg_lo:[1,0,0] neg_hi:[1,0,0]
    v_dot2_f32_bf16 v202, v155, s32, v202 neg_lo:[1,0,0] neg_hi:[1,0,0]
    s_add_u32 s58, s35, s36
    buffer_store_dwordx4 v[152:155], v252, s[92:95], s58 offen sc1
    s_nop 0
    v_fma_f32 v200, v202, s33, v201
    v_pk_add_f32 v[176:177], v[176:177], v[200:201] op_sel:[0,0] op_sel_hi:[1,0]
    v_pk_add_f32 v[178:179], v[178:179], v[200:201] op_sel:[0,0] op_sel_hi:[1,0]
    v_pk_add_f32 v[180:181], v[180:181], v[200:201] op_sel:[0,0] op_sel_hi:[1,0]
    v_pk_add_f32 v[182:183], v[182:183], v[200:201] op_sel:[0,0] op_sel_hi:[1,0]
    v_pk_add_f32 v[202:203], v[176:177], v[178:179]
    v_pk_add_f32 v[204:205], v[180:181], v[182:183]
    v_cvt_pk_bf16_f32 v156, v176, v177
    v_pk_add_f32 v[202:203], v[202:203], v[204:205]
    v_cvt_pk_bf16_f32 v157, v178, v179
    v_cvt_pk_bf16_f32 v158, v180, v181
    v_add_f32 v202, v202, v203
    v_cvt_pk_bf16_f32 v159, v182, v183
    v_dot2_f32_bf16 v202, v156, s32, v202 neg_lo:[1,0,0] neg_hi:[1,0,0]
    v_dot2_f32_bf16 v202, v157, s32, v202 neg_lo:[1,0,0] neg_hi:[1,0,0]
    v_dot2_f32_bf16 v202, v158, s32, v202 neg_lo:[1,0,0] neg_hi:[1,0,0]
    v_dot2_f32_bf16 v202, v159, s32, v202 neg_lo:[1,0,0] neg_hi:[1,0,0]
    s_add_u32 s58, s58, s38
    buffer_store_dwordx4 v[156:159], v252, s[92:95], s58 offen sc1
    s_nop 0
    v_fma_f32 v200, v202, s33, v201
    v_pk_add_f32 v[184:185], v[184:185], v[200:201] op_sel:[0,0] op_sel_hi:[1,0]
    v_pk_add_f32 v[186:187], v[186:187], v[200:201] op_sel:[0,0] op_sel_hi:[1,0]
    v_pk_add_f32 v[188:189], v[188:189], v[200:201] op_sel:[0,0] op_sel_hi:[1,0]
    v_pk_add_f32 v[190:191], v[190:191], v[200:201] op_sel:[0,0] op_sel_hi:[1,0]
    v_pk_add_f32 v[202:203], v[184:185], v[186:187]
    v_pk_add_f32 v[204:205], v[188:189], v[190:191]
    v_cvt_pk_bf16_f32 v160, v184, v185
    v_pk_add_f32 v[202:203], v[202:203], v[204:205]
    v_cvt_pk_bf16_f32 v161, v186, v187
    v_cvt_pk_bf16_f32 v162, v188, v189
    v_add_f32 v202, v202, v203
    v_cvt_pk_bf16_f32 v163, v190, v191
    v_dot2_f32_bf16 v202, v160, s32, v202 neg_lo:[1,0,0] neg_hi:[1,0,0]
    v_dot2_f32_bf16 v202, v161, s32, v202 neg_lo:[1,0,0] neg_hi:[1,0,0]
    v_dot2_f32_bf16 v202, v162, s32, v202 neg_lo:[1,0,0] neg_hi:[1,0,0]
    v_dot2_f32_bf16 v202, v163, s32, v202 neg_lo:[1,0,0] neg_hi:[1,0,0]
    s_add_u32 s58, s35, s36
    s_add_u32 s58, s58, s37
    buffer_store_dwordx4 v[160:163], v252, s[92:95], s58 offen sc1
    v_fma_f32 v200, v202, s33, v201
    v_pk_add_f32 v[192:193], v[192:193], v[200:201] op_sel:[0,0] op_sel_hi:[1,0]
    v_pk_add_f32 v[194:195], v[194:195], v[200:201] op_sel:[0,0] op_sel_hi:[1,0]
    v_pk_add_f32 v[196:197], v[196:197], v[200:201] op_sel:[0,0] op_sel_hi:[1,0]
    v_pk_add_f32 v[198:199], v[198:199], v[200:201] op_sel:[0,0] op_sel_hi:[1,0]
    v_cvt_pk_bf16_f32 v164, v192, v193
    v_cvt_pk_bf16_f32 v165, v194, v195
    v_cvt_pk_bf16_f32 v166, v196, v197
    v_cvt_pk_bf16_f32 v167, v198, v199
    s_add_u32 s58, s58, s38
    buffer_store_dwordx4 v[164:167], v252, s[92:95], s58 offen sc1
    s_cmp_lt_u32 s19, 29
    s_cselect_b32 s94, 268435456, 0
    s_waitcnt vmcnt(12)
    s_barrier
    ds_read_b64_tr_b16 v[232:233], v1 offset:0
    ds_read_b64_tr_b16 v[234:235], v1 offset:256
    ds_read_b64_tr_b16 v[236:237], v1 offset:1024
    ds_read_b64_tr_b16 v[238:239], v1 offset:1280
    ds_read_b64_tr_b16 v[240:241], v1 offset:2048
    ds_read_b64_tr_b16 v[242:243], v1 offset:2304
    ds_read_b64_tr_b16 v[244:245], v1 offset:3072
    ds_read_b64_tr_b16 v[246:247], v1 offset:3328
    ds_read_b64_tr_b16 v[248:249], v1 offset:4096
    ds_read_b64_tr_b16 v[250:251], v1 offset:4352
    ds_read_b64_tr_b16 v[252:253], v1 offset:5120
    ds_read_b64_tr_b16 v[254:255], v1 offset:5376
    s_waitcnt lgkmcnt(10)
    v_mfma_f32_32x32x16_bf16 v[168:183], v[232:235], v[8:11], 0
    ds_read_b64_tr_b16 v[232:233], v1 offset:6144
    ds_read_b64_tr_b16 v[234:235], v1 offset:6400
    s_waitcnt lgkmcnt(10)
    v_mfma_f32_32x32x16_bf16 v[168:183], v[236:239], v[12:15], v[168:183]
    ds_read_b64_tr_b16 v[236:237], v1 offset:7168
    ds_read_b64_tr_b16 v[238:239], v1 offset:7424
    s_waitcnt lgkmcnt(10)
    v_mfma_f32_32x32x16_bf16 v[168:183], v[240:243], v[16:19], v[168:183]
    ds_read_b64_tr_b16 v[240:241], v1 offset:8192
    ds_read_b64_tr_b16 v[242:243], v1 offset:8448
    s_waitcnt lgkmcnt(10)
    v_mfma_f32_32x32x16_bf16 v[168:183], v[244:247], v[20:23], v[168:183]
    ds_read_b64_tr_b16 v[244:245], v1 offset:9216
    ds_read_b64_tr_b16 v[246:247], v1 offset:9472
    s_waitcnt lgkmcnt(10)
    v_mfma_f32_32x32x16_bf16 v[168:183], v[248:251], v[24:27], v[168:183]
    v_bfe_u32 v16, v0, 4, 1
    v_lshlrev_b32 v16, 4, v16
    v_mov_b32 v17, 0x3f80
    ds_read_b64_tr_b16 v[248:249], v1 offset:10240
    ds_read_b64_tr_b16 v[250:251], v1 offset:10496
IT_2:
    s_cbranch_execz IT_6
    s_waitcnt lgkmcnt(10)
    v_mfma_f32_32x32x16_bf16 v[168:183], v[252:255], v[28:31], v[168:183]
    v_lshlrev_b32 v16, v16, v17
    v_bfe_u32 v17, v0, 7, 1
    v_bfe_u32 v18, v0, 8, 1
    ds_read_b64_tr_b16 v[252:253], v1 offset:11264
    ds_read_b64_tr_b16 v[254:255], v1 offset:11520
    s_waitcnt lgkmcnt(10)
    v_mfma_f32_32x32x16_bf16 v[168:183], v[232:235], v[32:35], v[168:183]
    v_cmp_eq_u32 vcc, v17, v18
    v_bfe_u32 v17, v0, 5, 2
    s_nop 0
    v_cndmask_b32 v16, 0, v16, vcc
    ds_read_b64_tr_b16 v[232:233], v1 offset:12288
    ds_read_b64_tr_b16 v[234:235], v1 offset:12544
    s_waitcnt lgkmcnt(10)
    v_mfma_f32_32x32x16_bf16 v[168:183], v[236:239], v[36:39], v[168:183]
    v_cmp_eq_u32 vcc, 0, v17
    s_nop 1
    v_cndmask_b32 v12, 0, v16, vcc
    v_cmp_eq_u32 vcc, 1, v17
    ds_read_b64_tr_b16 v[236:237], v1 offset:13312
    ds_read_b64_tr_b16 v[238:239], v1 offset:13568
    s_waitcnt lgkmcnt(10)
    v_mfma_f32_32x32x16_bf16 v[168:183], v[240:243], v[40:43], v[168:183]
    v_cndmask_b32 v13, 0, v16, vcc
    v_cmp_eq_u32 vcc, 2, v17
    s_nop 1
    v_cndmask_b32 v14, 0, v16, vcc
    ds_read_b64_tr_b16 v[240:241], v1 offset:14336
    ds_read_b64_tr_b16 v[242:243], v1 offset:14592
    s_waitcnt lgkmcnt(10)
    v_mfma_f32_32x32x16_bf16 v[168:183], v[244:247], v[44:47], v[168:183]
    v_cmp_eq_u32 vcc, 3, v17
    s_nop 1
    v_cndmask_b32 v15, 0, v16, vcc
    v_and_b32 v218, 0xf0, v0
    ds_read_b64_tr_b16 v[244:245], v1 offset:15360
    ds_read_b64_tr_b16 v[246:247], v1 offset:15616
    s_waitcnt lgkmcnt(10)
    v_mfma_f32_32x32x16_bf16 v[168:183], v[248:251], v[48:51], v[168:183]
    v_lshlrev_b32 v218, 1, v218
    v_lshrrev_b32 v219, 8, v0
    v_lshlrev_b32 v219, 3, v219
    ds_read_b64_tr_b16 v[248:249], v1 offset:16384
    ds_read_b64_tr_b16 v[250:251], v1 offset:16640
    s_waitcnt lgkmcnt(10)
    v_mfma_f32_32x32x16_bf16 v[168:183], v[252:255], v[52:55], v[168:183]
    v_add_u32 v218, v218, v219
    s_lshl_b32 s30, s3, 9
    s_add_u32 s30, s30, 155648
    ds_read_b64_tr_b16 v[252:253], v1 offset:17408
    ds_read_b64_tr_b16 v[254:255], v1 offset:17664
    s_waitcnt lgkmcnt(10)
    v_mfma_f32_32x32x16_bf16 v[168:183], v[232:235], v[56:59], v[168:183]
    s_add_u32 m0, s71, 4096
    s_add_u32 s70, s70, 8192
    buffer_load_dwordx4 v210, s[88:91], s70 offen lds
    v_add_u32 v218, s30, v218
    s_lshl_b32 s30, s3, 5
    s_add_u32 s30, s30, 157696
    ds_read_b64_tr_b16 v[232:233], v1 offset:18432
    ds_read_b64_tr_b16 v[234:235], v1 offset:18688
    s_waitcnt lgkmcnt(10)
    v_mfma_f32_32x32x16_bf16 v[168:183], v[236:239], v[60:63], v[168:183]
    v_add_u32 v219, s30, v219
    v_bfe_u32 v20, v0, 7, 2
    v_bfe_u32 v21, v0, 4, 2
    ds_read_b64_tr_b16 v[236:237], v1 offset:19456
    ds_read_b64_tr_b16 v[238:239], v1 offset:19712
    s_waitcnt lgkmcnt(10)
    v_mfma_f32_32x32x16_bf16 v[168:183], v[240:243], v[64:67], v[168:183]
    s_add_u32 m0, s71, 5120
    s_add_u32 s70, s70, 8192
    buffer_load_dwordx4 v210, s[88:91], s70 offen lds
    v_lshl_add_u32 v20, v20, 2, v21
    v_lshlrev_b32 v20, 5, v20
    v_lshrrev_b32 v21, 9, v0
    ds_read_b64_tr_b16 v[240:241], v1 offset:20480
    ds_read_b64_tr_b16 v[242:243], v1 offset:20736
    s_waitcnt lgkmcnt(10)
    v_mfma_f32_32x32x16_bf16 v[168:183], v[244:247], v[68:71], v[168:183]
    v_lshl_add_u32 v20, v21, 10, v20
    v_add_u32 v20, 155648, v20
    v_lshlrev_b32 v21, 6, v21
    ds_read_b64_tr_b16 v[244:245], v1 offset:21504
    ds_read_b64_tr_b16 v[246:247], v1 offset:21760
    s_waitcnt lgkmcnt(10)
    v_mfma_f32_32x32x16_bf16 v[168:183], v[248:251], v[72:75], v[168:183]
    s_add_u32 m0, s71, 6144
    s_add_u32 s70, s70, 8192
    buffer_load_dwordx4 v210, s[88:91], s70 offen lds
    v_add_u32 v21, 157696, v21
    v_mov_b64 v[24:25], 0
    v_mov_b64 v[26:27], 0
    ds_read_b64_tr_b16 v[248:249], v1 offset:22528
    ds_read_b64_tr_b16 v[250:251], v1 offset:22784
    s_waitcnt lgkmcnt(10)
    v_mfma_f32_32x32x16_bf16 v[168:183], v[252:255], v[76:79], v[168:183]
    v_mov_b64 v[28:29], 0
    v_mov_b64 v[30:31], 0
    v_mov_b64 v[32:33], 0
    ds_read_b64_tr_b16 v[252:253], v1 offset:23552
    ds_read_b64_tr_b16 v[254:255], v1 offset:23808
    s_waitcnt lgkmcnt(10)
    v_mfma_f32_32x32x16_bf16 v[168:183], v[232:235], v[80:83], v[168:183]
    s_add_u32 m0, s71, 7168
    s_add_u32 s70, s70, 8192
    buffer_load_dwordx4 v210, s[88:91], s70 offen lds
    v_mov_b64 v[34:35], 0
    v_mov_b64 v[36:37], 0
    v_mov_b64 v[38:39], 0
    ds_read_b64_tr_b16 v[232:233], v1 offset:24576
    ds_read_b64_tr_b16 v[234:235], v1 offset:24832
    s_waitcnt lgkmcnt(10)
    v_mfma_f32_32x32x16_bf16 v[168:183], v[236:239], v[84:87], v[168:183]
    s_mul_i32 s42, s25, 90112
    s_lshl_b32 s31, s21, 11
    s_add_u32 s42, s42, s31
    ds_read_b64_tr_b16 v[236:237], v1 offset:25600
    ds_read_b64_tr_b16 v[238:239], v1 offset:25856
    s_waitcnt lgkmcnt(10)
    v_mfma_f32_32x32x16_bf16 v[168:183], v[240:243], v[88:91], v[168:183]
    s_add_u32 m0, s71, 8192
    s_add_u32 s70, s70, 8192
    buffer_load_dwordx4 v210, s[88:91], s70 offen lds
    s_add_u32 s42, s42, 10485760
    s_lshl_b32 s43, s25, 7
    s_add_u32 s43, s43, s21
    ds_read_b64_tr_b16 v[240:241], v1 offset:26624
    ds_read_b64_tr_b16 v[242:243], v1 offset:26880
    s_waitcnt lgkmcnt(10)
    v_mfma_f32_32x32x16_bf16 v[168:183], v[244:247], v[92:95], v[168:183]
    s_add_u32 s43, s43, 16515072
    s_lshl_b32 s44, s26, 7
    s_add_u32 s44, s44, 16515072
    ds_read_b64_tr_b16 v[244:245], v1 offset:27648
    ds_read_b64_tr_b16 v[246:247], v1 offset:27904
    s_waitcnt lgkmcnt(10)
    v_mfma_f32_32x32x16_bf16 v[168:183], v[248:251], v[96:99], v[168:183]
    s_add_u32 m0, s71, 9216
    s_add_u32 s70, s70, 8192
    buffer_load_dwordx4 v210, s[88:91], s70 offen lds
    s_lshl_b32 s31, s3, 2
    s_lshl_b32 s54, 15, s31
    s_mov_b32 s55, s54
    ds_read_b64_tr_b16 v[248:249], v1 offset:28672
    ds_read_b64_tr_b16 v[250:251], v1 offset:28928
    s_waitcnt lgkmcnt(10)
    v_mfma_f32_32x32x16_bf16 v[168:183], v[252:255], v[100:103], v[168:183]
    s_mul_i32 s56, s26, 90112
    s_lshl_b32 s31, s3, 13
    s_add_u32 s56, s56, s31
    ds_read_b64_tr_b16 v[252:253], v1 offset:29696
    ds_read_b64_tr_b16 v[254:255], v1 offset:29952
    s_waitcnt lgkmcnt(10)
    v_mfma_f32_32x32x16_bf16 v[168:183], v[232:235], v[104:107], v[168:183]
    s_add_u32 m0, s71, 10240
    s_add_u32 s70, s70, 8192
    buffer_load_dwordx4 v210, s[88:91], s70 offen lds
    s_add_u32 s56, s56, 10485760
    s_add_u32 s57, s56, 360448
    s_lshl_b32 s68, s26, 15
    ds_read_b64_tr_b16 v[232:233], v1 offset:30720
    ds_read_b64_tr_b16 v[234:235], v1 offset:30976
    s_waitcnt lgkmcnt(10)
    v_mfma_f32_32x32x16_bf16 v[168:183], v[236:239], v[108:111], v[168:183]
    s_lshl_b32 s31, s3, 13
    s_add_u32 s68, s68, s31
    s_lshl_b32 s31, s23, 7
    ds_read_b64_tr_b16 v[236:237], v1 offset:31744
    ds_read_b64_tr_b16 v[238:239], v1 offset:32000
    s_waitcnt lgkmcnt(10)
    v_mfma_f32_32x32x16_bf16 v[168:183], v[240:243], v[112:115], v[168:183]
    s_add_u32 m0, s71, 11264
    s_add_u32 s70, s70, 8192
    buffer_load_dwordx4 v210, s[88:91], s70 offen lds
    s_add_u32 s68, s68, s31
    s_add_u32 s69, s68, 131072
    v_lshrrev_b32 v82, 7, v0
    s_waitcnt lgkmcnt(8)
    v_mfma_f32_32x32x16_bf16 v[168:183], v[244:247], v[116:119], v[168:183]
    v_and_b32 v81, 0x70, v0
    v_lshl_add_u32 v80, v82, 10, v81
    v_lshlrev_b32 v81, 1, v81
    s_waitcnt lgkmcnt(6)
    v_mfma_f32_32x32x16_bf16 v[168:183], v[248:251], v[120:123], v[168:183]
    s_add_u32 m0, s71, 12288
    s_add_u32 s70, s70, 8192
    buffer_load_dwordx4 v210, s[88:91], s70 offen lds
    v_lshl_add_u32 v81, v82, 2, v81
    s_mul_i32 s46, s19, 98304
    s_add_u32 s46, s46, s28
    s_waitcnt lgkmcnt(4)
    v_mfma_f32_32x32x16_bf16 v[168:183], v[252:255], v[124:127], v[168:183]
    s_add_u32 s46, s46, 2097152
    s_mul_i32 s77, s23, 180224
    s_mul_i32 s31, s3, 45056
    s_waitcnt lgkmcnt(2)
    v_mfma_f32_32x32x16_bf16 v[168:183], v[232:235], v[128:131], v[168:183]
    s_add_u32 m0, s71, 13312
    s_add_u32 s70, s70, 8192
    buffer_load_dwordx4 v210, s[88:91], s70 offen lds
    s_add_u32 s77, s77, s31
    s_add_u32 s77, s77, 5242880
    s_waitcnt lgkmcnt(0)
    v_mfma_f32_32x32x16_bf16 v[168:183], v[236:239], v[132:135], v[168:183]
    v_mov_b32 v83, v210
    v_bfe_u32 v253, v0, 8, 1
    v_and_b32 v248, 0xf0, v0
    v_lshlrev_b32 v249, 7, v253
    v_xor_b32 v248, v248, v249
    v_lshl_add_u32 v248, v253, 10, v248
    v_lshrrev_b32 v253, 9, v0
    v_lshl_add_u32 v248, v253, 9, v248
    s_lshl_b32 s30, s3, 13
    s_add_u32 s30, s30, 98304
    v_add_u32 v248, s30, v248
    s_nop 0
    v_cvt_pk_bf16_f32 v168, v168, v169
    v_cvt_pk_bf16_f32 v169, v170, v171
    v_cvt_pk_bf16_f32 v170, v172, v173
    v_cvt_pk_bf16_f32 v171, v174, v175
    v_cvt_pk_bf16_f32 v172, v176, v177
    v_cvt_pk_bf16_f32 v173, v178, v179
    v_cvt_pk_bf16_f32 v174, v180, v181
    v_cvt_pk_bf16_f32 v175, v182, v183
    v_mfma_f32_32x32x16_bf16 v[56:71], a[232:235], v[168:171], 0
    s_nop 0
    v_mfma_f32_32x32x16_bf16 v[56:71], a[236:239], v[172:175], v[56:71]
    v_lshl_add_u32 v252, v253, 9, v3
    v_and_b32 v250, 0x70, v0
    s_lshl_b32 s30, s3, 7
    v_add_u32 v250, s30, v250
    v_lshl_add_u32 v251, v253, 10, v250
    v_and_b32 v249, 0x80, v0
    v_xor_b32 v249, v249, v250
    v_lshrrev_b32 v253, 7, v0
    v_lshl_add_u32 v249, v253, 10, v249
    v_add_u32 v249, 98304, v249
    v_lshl_add_u32 v250, v253, 9, v250
    v_add_u32 v1, 0x10000, v0
    v_add_u32 v2, 0x20000, v0
    v_bfe_u32 v93, v0, 6, 2
    v_lshrrev_b32 v94, 9, v0
    v_lshl_add_u32 v94, v94, 3, v93
    v_lshlrev_b32 v94, 7, v94
    v_lshrrev_b32 v93, 1, v93
    v_lshl_add_u32 v94, v93, 6, v94
    v_bfe_u32 v93, v0, 8, 1
    v_lshl_add_u32 v94, v93, 11, v94
    v_and_b32 v93, 16, v0
    v_add_u32 v94, v94, v93
    v_bfe_u32 v93, v0, 5, 1
    v_lshl_add_u32 v94, v93, 3, v94
    v_add_u32 v94, s71, v94
    v_xor_b32 v95, 64, v94
    s_mul_i32 s30, s19, 3
    s_lshr_b32 s30, s30, 1
    v_bfe_u32 v96, v0, 4, 1
    v_add_u32 v96, s30, v96
    v_min_u32 v96, 42, v96
    v_mul_u32_u24 v93, 43, v93
    v_add_u32 v96, v96, v93
    v_mul_u32_u24 v97, 5958, v96
    v_lshrrev_b32 v97, 16, v97
    v_mul_u32_u24 v97, 87, v97
    v_lshlrev_b32 v96, 3, v96
    v_sub_u32 v96, v96, v97
    v_lshlrev_b32 v96, 7, v96
    s_mov_b32 s58, 16596992
    v_mov_b32 v92, s80
    v_max3_f32 v230, v56, v57, v58
    s_waitcnt vmcnt(10)
    s_barrier
    s_add_u32 s31, s51, 32768
    s_cmp_eq_u32 s3, 3
    s_cselect_b64 exec, 1, 0
    buffer_store_dword v92, off, s[4:7], s31 sc1
    s_mov_b64 exec, -1
    buffer_load_dwordx4 v[136:139], v0, s[4:7], s47 offen offset:0 sc1
    v_min3_f32 v231, v56, v57, v58
    v_max3_f32 v230, v230, v59, v60
    v_min3_f32 v231, v231, v59, v60
    v_max3_f32 v230, v230, v61, v62
    v_min3_f32 v231, v231, v61, v62
    v_max3_f32 v230, v230, v63, v64
    buffer_load_dwordx4 v[140:143], v0, s[4:7], s47 offen offset:1024 sc1
    v_min3_f32 v231, v231, v63, v64
    v_max3_f32 v230, v230, v65, v66
    v_min3_f32 v231, v231, v65, v66
    v_max3_f32 v230, v230, v67, v68
    v_min3_f32 v231, v231, v67, v68
    v_max3_f32 v230, v230, v69, v70
    buffer_load_dwordx4 v[144:147], v0, s[4:7], s47 offen offset:2048 sc1
    v_min3_f32 v231, v231, v69, v70
    v_max_f32 v230, v230, v71
    v_min_f32 v231, v231, v71
    v_pk_mul_f32 v[230:231], v[230:231], v[228:229] op_sel:[0,1] op_sel_hi:[1,1]
    v_pk_fma_f32 v[184:185], v[56:57], v[228:229], v[230:231] op_sel:[0,1,0] op_sel_hi:[1,1,0] neg_lo:[0,0,1] neg_hi:[0,0,1]
    v_pk_fma_f32 v[186:187], v[58:59], v[228:229], v[230:231] op_sel:[0,1,0] op_sel_hi:[1,1,0] neg_lo:[0,0,1] neg_hi:[0,0,1]
    buffer_load_dwordx4 v[148:151], v0, s[4:7], s47 offen offset:3072 sc1
    v_pk_fma_f32 v[188:189], v[60:61], v[228:229], v[230:231] op_sel:[0,1,0] op_sel_hi:[1,1,0] neg_lo:[0,0,1] neg_hi:[0,0,1]
    v_pk_fma_f32 v[190:191], v[62:63], v[228:229], v[230:231] op_sel:[0,1,0] op_sel_hi:[1,1,0] neg_lo:[0,0,1] neg_hi:[0,0,1]
    v_pk_fma_f32 v[192:193], v[64:65], v[228:229], v[230:231] op_sel:[0,1,0] op_sel_hi:[1,1,0] neg_lo:[0,0,1] neg_hi:[0,0,1]
    v_pk_fma_f32 v[194:195], v[66:67], v[228:229], v[230:231] op_sel:[0,1,0] op_sel_hi:[1,1,0] neg_lo:[0,0,1] neg_hi:[0,0,1]
    v_pk_fma_f32 v[196:197], v[68:69], v[228:229], v[230:231] op_sel:[0,1,0] op_sel_hi:[1,1,0] neg_lo:[0,0,1] neg_hi:[0,0,1]
    v_pk_fma_f32 v[198:199], v[70:71], v[228:229], v[230:231] op_sel:[0,1,0] op_sel_hi:[1,1,0] neg_lo:[0,0,1] neg_hi:[0,0,1]
    buffer_load_dwordx4 v[8:11], v216, s[4:7], s101 offen sc1
    v_pk_fma_f32 v[200:201], v[56:57], v[228:229], v[230:231] op_sel:[0,1,1] op_sel_hi:[1,1,1] neg_lo:[1,0,0] neg_hi:[1,0,0]
    v_pk_fma_f32 v[202:203], v[58:59], v[228:229], v[230:231] op_sel:[0,1,1] op_sel_hi:[1,1,1] neg_lo:[1,0,0] neg_hi:[1,0,0]
    v_pk_fma_f32 v[204:205], v[60:61], v[228:229], v[230:231] op_sel:[0,1,1] op_sel_hi:[1,1,1] neg_lo:[1,0,0] neg_hi:[1,0,0]
    v_pk_fma_f32 v[206:207], v[62:63], v[228:229], v[230:231] op_sel:[0,1,1] op_sel_hi:[1,1,1] neg_lo:[1,0,0] neg_hi:[1,0,0]
    v_pk_fma_f32 v[208:209], v[64:65], v[228:229], v[230:231] op_sel:[0,1,1] op_sel_hi:[1,1,1] neg_lo:[1,0,0] neg_hi:[1,0,0]
    v_pk_fma_f32 v[210:211], v[66:67], v[228:229], v[230:231] op_sel:[0,1,1] op_sel_hi:[1,1,1] neg_lo:[1,0,0] neg_hi:[1,0,0]
    s_add_u32 s47, s47, 4096
    buffer_load_dwordx4 v[152:155], v0, s[4:7], s47 offen offset:0 sc1
    v_pk_fma_f32 v[212:213], v[68:69], v[228:229], v[230:231] op_sel:[0,1,1] op_sel_hi:[1,1,1] neg_lo:[1,0,0] neg_hi:[1,0,0]
    v_pk_fma_f32 v[214:215], v[70:71], v[228:229], v[230:231] op_sel:[0,1,1] op_sel_hi:[1,1,1] neg_lo:[1,0,0] neg_hi:[1,0,0]
    v_exp_f32 v184, v184
    v_exp_f32 v185, v185
    v_exp_f32 v186, v186
    v_exp_f32 v187, v187
    buffer_load_dwordx4 v[156:159], v0, s[4:7], s47 offen offset:1024 sc1
    v_exp_f32 v188, v188
    v_exp_f32 v189, v189
    v_exp_f32 v190, v190
    v_exp_f32 v191, v191
    v_exp_f32 v192, v192
    v_exp_f32 v193, v193
    buffer_load_dwordx4 v[160:163], v0, s[4:7], s47 offen offset:2048 sc1
    v_exp_f32 v194, v194
    v_exp_f32 v195, v195
    v_exp_f32 v196, v196
    v_exp_f32 v197, v197
    v_exp_f32 v198, v198
    v_exp_f32 v199, v199
    buffer_load_dwordx4 v[164:167], v0, s[4:7], s47 offen offset:3072 sc1
    v_exp_f32 v200, v200
    v_exp_f32 v201, v201
    v_exp_f32 v202, v202
    v_exp_f32 v203, v203
    v_exp_f32 v204, v204
    v_exp_f32 v205, v205
    buffer_load_dwordx4 v[72:75], v80, s[8:11], s68 offen
    buffer_load_dwordx4 v[76:79], v80, s[8:11], s69 offen
    v_exp_f32 v206, v206
    v_exp_f32 v207, v207
    v_exp_f32 v208, v208
    v_exp_f32 v209, v209
    v_exp_f32 v210, v210
    v_exp_f32 v211, v211
    v_exp_f32 v212, v212
    v_exp_f32 v213, v213
    v_exp_f32 v214, v214
    v_exp_f32 v215, v215
    v_pk_add_f32 v[220:221], v[184:185], v[186:187]
    v_pk_add_f32 v[222:223], v[200:201], v[202:203]
    v_pk_add_f32 v[220:221], v[220:221], v[188:189]
    v_pk_add_f32 v[222:223], v[222:223], v[204:205]
    v_pk_add_f32 v[220:221], v[220:221], v[190:191]
    v_pk_add_f32 v[222:223], v[222:223], v[206:207]
    v_pk_add_f32 v[220:221], v[220:221], v[192:193]
    v_pk_add_f32 v[222:223], v[222:223], v[208:209]
    v_pk_add_f32 v[220:221], v[220:221], v[194:195]
    v_pk_add_f32 v[222:223], v[222:223], v[210:211]
    v_pk_add_f32 v[220:221], v[220:221], v[196:197]
    v_pk_add_f32 v[222:223], v[222:223], v[212:213]
    v_pk_add_f32 v[220:221], v[220:221], v[198:199]
    v_pk_add_f32 v[222:223], v[222:223], v[214:215]
    v_add_f32 v220, v220, v221
    v_add_f32 v222, v222, v223
    v_rcp_f32 v225, v222
    v_cvt_pk_bf16_f32 v184, v184, v185
    v_cvt_pk_bf16_f32 v185, v186, v187
    v_cvt_pk_bf16_f32 v186, v188, v189
    v_cvt_pk_bf16_f32 v187, v190, v191
    v_cvt_pk_bf16_f32 v188, v192, v193
    v_cvt_pk_bf16_f32 v189, v194, v195
    v_cvt_pk_bf16_f32 v190, v196, v197
    v_cvt_pk_bf16_f32 v191, v198, v199
    v_mul_f32 v225, v225, v220
    v_pk_mul_f32 v[200:201], v[200:201], v[224:225] op_sel:[0,1] op_sel_hi:[1,1]
    v_pk_mul_f32 v[202:203], v[202:203], v[224:225] op_sel:[0,1] op_sel_hi:[1,1]
    v_pk_mul_f32 v[204:205], v[204:205], v[224:225] op_sel:[0,1] op_sel_hi:[1,1]
    v_pk_mul_f32 v[206:207], v[206:207], v[224:225] op_sel:[0,1] op_sel_hi:[1,1]
    v_pk_mul_f32 v[208:209], v[208:209], v[224:225] op_sel:[0,1] op_sel_hi:[1,1]
    v_pk_mul_f32 v[210:211], v[210:211], v[224:225] op_sel:[0,1] op_sel_hi:[1,1]
    v_pk_mul_f32 v[212:213], v[212:213], v[224:225] op_sel:[0,1] op_sel_hi:[1,1]
    v_pk_mul_f32 v[214:215], v[214:215], v[224:225] op_sel:[0,1] op_sel_hi:[1,1]
    v_cvt_pk_bf16_f32 v200, v200, v201
    v_cvt_pk_bf16_f32 v201, v202, v203
    v_cvt_pk_bf16_f32 v202, v204, v205
    v_cvt_pk_bf16_f32 v203, v206, v207
    v_cvt_pk_bf16_f32 v204, v208, v209
    v_cvt_pk_bf16_f32 v205, v210, v211
    v_cvt_pk_bf16_f32 v206, v212, v213
    v_cvt_pk_bf16_f32 v207, v214, v215
    s_add_u32 m0, s71, 14336
    s_add_u32 s70, s70, 8192
    buffer_load_dwordx4 v83, s[88:91], s70 offen lds
    s_add_u32 m0, s71, 15360
    s_add_u32 s70, s70, 8192
    buffer_load_dwordx4 v83, s[88:91], s70 offen lds
    s_lshr_b32 s30, s48, 4
    s_lshl_b32 s31, s18, 3
    s_add_u32 s30, s30, s31
    s_mul_i32 s30, s30, 90112
    s_add_u32 s30, s30, 10485760
    s_and_b32 s31, s48, 15
    s_mul_i32 s100, s31, 3456
    s_add_u32 s100, s100, s30
    s_add_u32 s100, s100, 32768
    s_lshl_b32 s31, s31, 11
    s_add_u32 s30, s30, s31
    v_lshlrev_b32 v253, 3, v0
    v_add_u32 v253, s30, v253
    s_add_u32 s30, s49, 8257536
    v_writelane_b32 v253, s30, 16
    s_add_u32 s30, s49, 8126464
    v_writelane_b32 v253, s30, 17
    s_mov_b64 exec, 0x3ffff
    buffer_load_dword v4, v253, s[4:7], 0 offen
    s_mov_b64 exec, -1
    buffer_load_dword v97, v96, s[4:7], s58 offen sc1
    v_mul_f32 v226, 0x358637bd, v220
Lre_4:
    s_waitcnt vmcnt(14)
    v_mfma_f32_16x16x32_bf16 v[112:115], v[12:15], v[136:139], 0
    s_waitcnt vmcnt(13)
    v_mfma_f32_16x16x32_bf16 v[112:115], v[12:15], v[140:143], v[112:115]
    s_waitcnt vmcnt(12)
    v_mfma_f32_16x16x32_bf16 v[112:115], v[12:15], v[144:147], v[112:115]
    s_waitcnt vmcnt(11)
    v_mfma_f32_16x16x32_bf16 v[112:115], v[12:15], v[148:151], v[112:115]
    s_waitcnt vmcnt(10)
    v_add_f32 v116, v8, v8 row_ror:8 row_mask:0xf bank_mask:0xf
    v_add_f32 v117, v9, v9 row_ror:8 row_mask:0xf bank_mask:0xf
    v_add_f32 v118, v10, v10 row_ror:8 row_mask:0xf bank_mask:0xf
    v_add_f32 v119, v11, v11 row_ror:8 row_mask:0xf bank_mask:0xf
    v_add_f32 v116, v116, v116 row_ror:4 row_mask:0xf bank_mask:0xf
    v_add_f32 v117, v117, v117 row_ror:4 row_mask:0xf bank_mask:0xf
    v_add_f32 v118, v118, v118 row_ror:4 row_mask:0xf bank_mask:0xf
    v_add_f32 v119, v119, v119 row_ror:4 row_mask:0xf bank_mask:0xf
    v_add_f32 v116, v116, v116 row_ror:2 row_mask:0xf bank_mask:0xf
    v_add_f32 v117, v117, v117 row_ror:2 row_mask:0xf bank_mask:0xf
    v_add_f32 v118, v118, v118 row_ror:2 row_mask:0xf bank_mask:0xf
    v_add_f32 v119, v119, v119 row_ror:2 row_mask:0xf bank_mask:0xf
    v_add_f32 v116, v116, v116 row_ror:1 row_mask:0xf bank_mask:0xf
    v_add_f32 v117, v117, v117 row_ror:1 row_mask:0xf bank_mask:0xf
    v_add_f32 v118, v118, v118 row_ror:1 row_mask:0xf bank_mask:0xf
    v_add_f32 v119, v119, v119 row_ror:1 row_mask:0xf bank_mask:0xf
    v_add_f32 v120, v116, v117
    v_add_f32 v121, v118, v119
    v_cvt_pk_bf16_f32 v116, v116, v117
    v_add_f32 v120, v120, v121
    v_cvt_pk_bf16_f32 v117, v118, v119
    s_waitcnt vmcnt(9)
    v_mfma_f32_16x16x32_bf16 v[112:115], v[12:15], v[152:155], v[112:115]
    s_waitcnt vmcnt(8)
    v_mfma_f32_16x16x32_bf16 v[112:115], v[12:15], v[156:159], v[112:115]
    s_waitcnt vmcnt(7)
    v_mfma_f32_16x16x32_bf16 v[112:115], v[12:15], v[160:163], v[112:115]
    s_waitcnt vmcnt(6)
    v_mfma_f32_16x16x32_bf16 v[112:115], v[12:15], v[164:167], v[112:115]
    s_nop 7
    v_cmp_u_f32 vcc, v120, v112
    v_cvt_pk_bf16_f32 v122, v112, v113
    v_cvt_pk_bf16_f32 v123, v114, v115
    s_cbranch_vccnz Lchk_5
Lgo_6:
    ds_write_b64 v218, v[122:123]
    ds_write_b64 v219, v[116:117]
    s_mov_b32 s30, 0x0f0f0f0f
    s_mov_b32 s31, 0xf0f0f0f0
    s_waitcnt lgkmcnt(0)
    s_barrier
    ds_read_b128 v[40:43], v21 offset:0
    ds_read_b128 v[44:47], v21 offset:16
    ds_read_b128 v[48:51], v21 offset:32
    ds_read_b128 v[52:55], v21 offset:48
    s_mov_b64 exec, s[30:31]
    ds_read_b128 v[24:27], v20 offset:0
    ds_read_b128 v[28:31], v20 offset:16
    ds_read_b128 v[32:35], v20 offset:512
    ds_read_b128 v[36:39], v20 offset:528
    s_mov_b64 exec, -1
    s_waitcnt lgkmcnt(7)
    v_dot2_f32_bf16 v226, v184, v40, v226
    v_dot2_f32_bf16 v227, v185, v41, 0
    v_dot2_f32_bf16 v226, v186, v42, v226
    v_dot2_f32_bf16 v227, v187, v43, v227
    s_waitcnt lgkmcnt(6)
    v_dot2_f32_bf16 v226, v188, v44, v226
    v_dot2_f32_bf16 v227, v189, v45, v227
    v_dot2_f32_bf16 v226, v190, v46, v226
    v_dot2_f32_bf16 v227, v191, v47, v227
    s_waitcnt lgkmcnt(5)
    v_dot2_f32_bf16 v226, v200, v48, v226
    v_dot2_f32_bf16 v227, v201, v49, v227
    v_dot2_f32_bf16 v226, v202, v50, v226
    v_dot2_f32_bf16 v227, v203, v51, v227
    s_waitcnt lgkmcnt(4)
    v_dot2_f32_bf16 v226, v204, v52, v226
    v_dot2_f32_bf16 v227, v205, v53, v227
    v_dot2_f32_bf16 v226, v206, v54, v226
    v_dot2_f32_bf16 v227, v207, v55, v227
    s_waitcnt vmcnt(4)
    ds_bpermute_b32 v84, v81, v72
    ds_bpermute_b32 v85, v81, v73
    ds_bpermute_b32 v86, v81, v74
    ds_bpermute_b32 v87, v81, v75
    ds_bpermute_b32 v88, v81, v76
    ds_bpermute_b32 v89, v81, v77
    ds_bpermute_b32 v90, v81, v78
    ds_bpermute_b32 v91, v81, v79
    s_waitcnt lgkmcnt(11)
    v_mfma_f32_32x32x16_bf16 v[136:151], v[24:27], v[184:187], 0
    s_mov_b32 s59, s43
    s_mov_b32 s76, s42
    v_add_f32 v226, v226, v227
    v_rcp_f32 v226, v226
    s_lshl_b32 s42, s26, 15
    s_waitcnt lgkmcnt(10)
    v_mfma_f32_32x32x16_bf16 v[136:151], v[28:31], v[188:191], v[136:151]
    s_lshl_b32 s31, s23, 12
    s_add_u32 s42, s42, s31
    s_lshl_b32 s43, s26, 7
    s_lshl_b32 s31, s23, 2
    s_add_u32 s43, s43, s31
    s_waitcnt lgkmcnt(9)
    v_mfma_f32_32x32x16_bf16 v[136:151], v[32:35], v[200:203], v[136:151]
    s_add_u32 s43, s43, s3
    s_add_u32 s43, s43, 16515104
    s_lshl_b32 s45, s26, 11
    s_add_u32 s45, s45, s31
    s_lshr_b32 s31, s23, 2
    s_waitcnt lgkmcnt(8)
    v_mfma_f32_32x32x16_bf16 v[136:151], v[36:39], v[204:207], v[136:151]
    s_mul_i32 s31, s31, 496
    s_add_u32 s45, s45, s31
    s_add_u32 s45, s45, 8257536
    s_waitcnt lgkmcnt(0)
    v_lshlrev_b32 v104, 16, v84
    v_and_b32 v105, 0xffff0000, v84
    v_lshlrev_b32 v106, 16, v85
    v_and_b32 v107, 0xffff0000, v85
    v_lshlrev_b32 v108, 16, v86
    v_and_b32 v109, 0xffff0000, v86
    v_lshlrev_b32 v110, 16, v87
    v_and_b32 v111, 0xffff0000, v87
    v_pk_mul_f32 v[136:137], v[136:137], v[226:227] op_sel:[0,0] op_sel_hi:[1,0]
    v_pk_mul_f32 v[138:139], v[138:139], v[226:227] op_sel:[0,0] op_sel_hi:[1,0]
    v_pk_mul_f32 v[140:141], v[140:141], v[226:227] op_sel:[0,0] op_sel_hi:[1,0]
    v_pk_mul_f32 v[142:143], v[142:143], v[226:227] op_sel:[0,0] op_sel_hi:[1,0]
    v_cvt_pk_bf16_f32 v136, v136, v137
    v_cvt_pk_bf16_f32 v137, v138, v139
    v_cvt_pk_bf16_f32 v138, v140, v141
    v_cvt_pk_bf16_f32 v139, v142, v143
    buffer_store_dwordx4 v[136:139], v0, s[4:7], s76 offen offset:0
    v_pk_mul_f32 v[144:145], v[144:145], v[226:227] op_sel:[0,0] op_sel_hi:[1,0]
    v_pk_mul_f32 v[146:147], v[146:147], v[226:227] op_sel:[0,0] op_sel_hi:[1,0]
    v_pk_mul_f32 v[148:149], v[148:149], v[226:227] op_sel:[0,0] op_sel_hi:[1,0]
    v_pk_mul_f32 v[150:151], v[150:151], v[226:227] op_sel:[0,0] op_sel_hi:[1,0]
    v_cvt_pk_bf16_f32 v144, v144, v145
    v_cvt_pk_bf16_f32 v145, v146, v147
    v_cvt_pk_bf16_f32 v146, v148, v149
    v_cvt_pk_bf16_f32 v147, v150, v151
    buffer_store_dwordx4 v[144:147], v0, s[4:7], s76 offen offset:1024
    v_lshlrev_b32 v112, 16, v88
    v_and_b32 v113, 0xffff0000, v88
    v_lshlrev_b32 v114, 16, v89
    v_and_b32 v115, 0xffff0000, v89
    v_lshlrev_b32 v116, 16, v90
    v_and_b32 v117, 0xffff0000, v90
    v_lshlrev_b32 v118, 16, v91
    v_and_b32 v119, 0xffff0000, v91
    s_waitcnt vmcnt(4)
    ds_read_b64_tr_b16 a[0:1], v94 offset:0
    ds_read_b64_tr_b16 a[2:3], v94 offset:512
    ds_read_b64_tr_b16 a[4:5], v94 offset:32
    ds_read_b64_tr_b16 a[6:7], v94 offset:544
    ds_read_b64_tr_b16 a[8:9], v95 offset:0
    ds_read_b64_tr_b16 a[10:11], v95 offset:512
    ds_read_b64_tr_b16 a[12:13], v95 offset:32
    ds_read_b64_tr_b16 a[14:15], v95 offset:544
    ds_read_b64_tr_b16 a[16:17], v94 offset:4096
    ds_read_b64_tr_b16 a[18:19], v94 offset:4608
    ds_read_b64_tr_b16 a[20:21], v94 offset:4128
    ds_read_b64_tr_b16 a[22:23], v94 offset:4640
    ds_read_b64_tr_b16 a[24:25], v95 offset:4096
    ds_read_b64_tr_b16 a[26:27], v95 offset:4608
    ds_read_b64_tr_b16 a[28:29], v95 offset:4128
    ds_read_b64_tr_b16 a[30:31], v95 offset:4640
    s_waitcnt vmcnt(0)
    s_mov_b64 exec, 2
    s_cmp_eq_u32 s24, 0
    s_cbranch_scc1 Limp_7
    buffer_store_byte v3, off, s[4:7], s59
Lfl_8:
    s_mov_b64 exec, -1
    v_cmp_ne_u32 vcc, s80, v97
    s_nop 0
    s_cbranch_vccz Lspin_9_r
Lspin_9:
    s_sleep 1
    buffer_load_dword v97, v96, s[4:7], s58 offen sc1
    s_sub_u32 s60, s60, 1
    s_cbranch_scc1 K1_fail
    s_waitcnt vmcnt(0)
    v_cmp_ne_u32 vcc, s80, v97
    s_nop 0
    s_cbranch_vccnz Lspin_9
Lspin_9_r:
    s_add_u32 m0, s28, 0
    s_nop 0
    buffer_load_dwordx4 v0, s[92:95], s46 offen sc1  lds
    s_add_u32 m0, s28, 4096
    s_add_u32 s46, s46, 4096
    buffer_load_dwordx4 v0, s[92:95], s46 offen sc1  lds
    s_add_u32 m0, s28, 8192
    s_add_u32 s46, s46, 4096
    buffer_load_dwordx4 v0, s[92:95], s46 offen sc1  lds
    s_add_u32 m0, s28, 12288
    s_add_u32 s46, s46, 4096
    buffer_load_dwordx4 v0, s[92:95], s46 offen sc1  lds
    ds_read_b64_tr_b16 a[32:33], v94 offset:8192
    ds_read_b64_tr_b16 a[34:35], v94 offset:8704
    ds_read_b64_tr_b16 a[36:37], v94 offset:8224
    ds_read_b64_tr_b16 a[38:39], v94 offset:8736
    ds_read_b64_tr_b16 a[40:41], v95 offset:8192
    ds_read_b64_tr_b16 a[42:43], v95 offset:8704
    ds_read_b64_tr_b16 a[44:45], v95 offset:8224
IT_3:
    s_cbranch_execz IT_7
    ds_read_b64_tr_b16 a[46:47], v95 offset:8736
    ds_read_b64_tr_b16 a[48:49], v94 offset:12288
    ds_read_b64_tr_b16 a[50:51], v94 offset:12800
    ds_read_b64_tr_b16 a[52:53], v94 offset:12320
    ds_read_b64_tr_b16 a[54:55], v94 offset:12832
    ds_read_b64_tr_b16 a[56:57], v95 offset:12288
    ds_read_b64_tr_b16 a[58:59], v95 offset:12800
    ds_read_b64_tr_b16 a[60:61], v95 offset:12320
    ds_read_b64_tr_b16 a[62:63], v95 offset:12832
    s_waitcnt lgkmcnt(0)
    s_barrier
    buffer_load_ubyte v4, v252, s[4:7], s44 offen sc1
    s_add_u32 m0, s28, 16384
    s_add_u32 s46, s46, 4096
    buffer_load_dwordx4 v0, s[92:95], s46 offen sc1  lds
    s_add_u32 m0, s28, 20480
    s_add_u32 s46, s46, 4096
    buffer_load_dwordx4 v0, s[92:95], s46 offen sc1  lds
    s_add_u32 m0, s28, 24576
    s_add_u32 s46, s46, 4096
    buffer_load_dwordx4 v0, s[92:95], s46 offen sc1  lds
    s_add_u32 m0, s28, 28672
    s_add_u32 s46, s46, 4096
    buffer_load_dwordx4 v0, s[92:95], s46 offen sc1  lds
    s_waitcnt vmcnt(4)
    v_cmp_gt_u32 vcc, 1, v4
    s_nop 0
    s_and_b64 vcc, vcc, s[54:55]
    s_cbranch_vccz Lspin_12_r
Lspin_12:
    buffer_load_ubyte v4, v252, s[4:7], s44 offen sc1
    s_sub_u32 s60, s60, 1
    s_cbranch_scc1 K1_fail
    s_waitcnt vmcnt(0)
    v_cmp_gt_u32 vcc, 1, v4
    s_nop 0
    s_and_b64 vcc, vcc, s[54:55]
    s_cbranch_vccnz Lspin_12
Lspin_12_r:
    s_cmp_eq_u32 s24, 0
    s_cbranch_scc1 Linv_14
Lok_13:
    buffer_load_dwordx4 v[8:11], v5, s[4:7], s56 offen offset:0 sc1
    buffer_load_dwordx4 v[12:15], v5, s[4:7], s56 offen offset:256 sc1
    buffer_load_dwordx4 v[16:19], v5, s[4:7], s56 offen offset:2048 sc1
    buffer_load_dwordx4 v[20:23], v5, s[4:7], s56 offen offset:2304 sc1
    s_add_u32 s56, s56, 4096
    buffer_load_dwordx4 v[24:27], v5, s[4:7], s56 offen offset:0 sc1
    buffer_load_dwordx4 v[28:31], v5, s[4:7], s56 offen offset:256 sc1
    s_waitcnt vmcnt(4)
    v_mfma_f32_16x16x32_bf16 v[136:139], a[0:3], v[8:11], 0
    buffer_load_dwordx4 v[32:35], v5, s[4:7], s56 offen offset:2048 sc1
    s_lshl_b32 s44, s27, 7
    v_mfma_f32_16x16x32_bf16 v[140:143], a[0:3], v[12:15], 0
    s_add_u32 s44, s44, 16515104
    s_lshl_b32 s72, s27, 15
    v_mfma_f32_16x16x32_bf16 v[152:155], a[8:11], v[8:11], 0
    buffer_load_dwordx4 v[36:39], v5, s[4:7], s56 offen offset:2304 sc1
    s_add_u32 s73, s72, 131072
    v_mfma_f32_16x16x32_bf16 v[156:159], a[8:11], v[12:15], 0
    s_mul_i32 s74, s26, 90112
    s_mul_i32 s31, s3, 22528
    v_mfma_f32_16x16x32_bf16 v[144:147], a[4:7], v[8:11], 0
    buffer_load_dwordx4 v[40:43], v5, s[4:7], s57 offen offset:0 sc1
    s_add_u32 s74, s74, s31
    v_mfma_f32_16x16x32_bf16 v[148:151], a[4:7], v[12:15], 0
    s_add_u32 s74, s74, 10485760
    s_add_u32 s75, s74, 360448
    v_mfma_f32_16x16x32_bf16 v[160:163], a[12:15], v[8:11], 0
    buffer_load_dwordx4 v[44:47], v5, s[4:7], s57 offen offset:256 sc1
    s_lshl_b32 s58, s26, 7
    v_mfma_f32_16x16x32_bf16 v[164:167], a[12:15], v[12:15], 0
    s_add_u32 s58, s58, 16515136
    s_mul_i32 s31, s3, 7
    s_waitcnt vmcnt(6)
    v_mfma_f32_16x16x32_bf16 v[136:139], a[16:19], v[16:19], v[136:139]
    buffer_load_dwordx4 v[48:51], v5, s[4:7], s57 offen offset:2048 sc1
    s_lshl_b32 s54, 0xff, s31
    v_mfma_f32_16x16x32_bf16 v[140:143], a[16:19], v[20:23], v[140:143]
    s_cmp_eq_u32 s3, 3
    s_cselect_b32 s54, 0x1fc00000, s54
    s_mov_b32 s55, -1
    v_mfma_f32_16x16x32_bf16 v[152:155], a[24:27], v[16:19], v[152:155]
    v_lshrrev_b32 v6, 9, v0
    v_mul_u32_u24 v6, 480, v6
    v_mfma_f32_16x16x32_bf16 v[156:159], a[24:27], v[20:23], v[156:159]
    v_add_u32 v6, v6, v3
    v_mfma_f32_16x16x32_bf16 v[144:147], a[20:23], v[16:19], v[144:147]
    buffer_load_dwordx4 v[52:55], v5, s[4:7], s57 offen offset:2304 sc1
    s_lshl_b32 s59, s26, 11
    v_mfma_f32_16x16x32_bf16 v[148:151], a[20:23], v[20:23], v[148:151]
    s_add_u32 s59, s59, 8257536
    s_lshl_b32 s31, s3, 7
    v_mfma_f32_16x16x32_bf16 v[160:163], a[28:31], v[16:19], v[160:163]
    s_add_u32 s59, s59, s31
    s_mul_i32 s47, s27, 90112
    v_mfma_f32_16x16x32_bf16 v[164:167], a[28:31], v[20:23], v[164:167]
    s_mul_i32 s31, s19, 3072
    s_waitcnt vmcnt(6)
    v_mfma_f32_16x16x32_bf16 v[136:139], a[32:35], v[24:27], v[136:139]
    s_add_u32 s57, s57, 4096
    buffer_load_dwordx4 v[56:59], v5, s[4:7], s57 offen offset:0 sc1
    v_mfma_f32_16x16x32_bf16 v[140:143], a[32:35], v[28:31], v[140:143]
    s_add_u32 s47, s47, s31
    s_add_u32 s47, s47, 10485760
    s_lshl_b32 s48, s27, 7
    v_mfma_f32_16x16x32_bf16 v[152:155], a[40:43], v[24:27], v[152:155]
    s_add_u32 s48, s48, s19
    s_add_u32 s48, s48, 16515136
    v_mfma_f32_16x16x32_bf16 v[156:159], a[40:43], v[28:31], v[156:159]
    v_lshrrev_b32 v1, 9, v0
    v_mfma_f32_16x16x32_bf16 v[144:147], a[36:39], v[24:27], v[144:147]
    buffer_load_dwordx4 v[60:63], v5, s[4:7], s57 offen offset:256 sc1
    v_mul_u32_u24 v1, 3072, v1
    v_mfma_f32_16x16x32_bf16 v[148:151], a[36:39], v[28:31], v[148:151]
    v_bfe_u32 v2, v0, 8, 1
    v_lshl_add_u32 v1, v2, 9, v1
    v_mfma_f32_16x16x32_bf16 v[160:163], a[44:47], v[24:27], v[160:163]
    v_bfe_u32 v2, v0, 6, 1
    v_lshl_add_u32 v1, v2, 7, v1
    v_mfma_f32_16x16x32_bf16 v[164:167], a[44:47], v[28:31], v[164:167]
    v_bfe_u32 v2, v0, 7, 1
    s_waitcnt vmcnt(6)
    v_mfma_f32_16x16x32_bf16 v[136:139], a[48:51], v[32:35], v[136:139]
    buffer_load_dwordx4 v[64:67], v5, s[4:7], s57 offen offset:2048 sc1
    v_lshl_add_u32 v1, v2, 6, v1
    v_mfma_f32_16x16x32_bf16 v[140:143], a[48:51], v[36:39], v[140:143]
    v_and_b32 v2, 0x30, v0
    v_add_u32 v1, v1, v2
    v_mfma_f32_16x16x32_bf16 v[152:155], a[56:59], v[32:35], v[152:155]
    v_add_u32 v2, 49152, v1
    s_mul_i32 s78, s21, 98304
    v_mfma_f32_16x16x32_bf16 v[156:159], a[56:59], v[36:39], v[156:159]
    s_add_u32 s78, s78, s28
    v_mfma_f32_16x16x32_bf16 v[144:147], a[52:55], v[32:35], v[144:147]
    buffer_load_dwordx4 v[68:71], v5, s[4:7], s57 offen offset:2304 sc1
    s_add_u32 s78, s78, 0
    v_mfma_f32_16x16x32_bf16 v[148:151], a[52:55], v[36:39], v[148:151]
    s_add_u32 s79, s28, 98304
    s_add_u32 s51, s78, 32768
    v_mfma_f32_16x16x32_bf16 v[160:163], a[60:63], v[32:35], v[160:163]
    v_mfma_f32_16x16x32_bf16 v[164:167], a[60:63], v[36:39], v[164:167]
    s_waitcnt vmcnt(6)
    v_mfma_f32_16x16x32_bf16 v[168:171], a[0:3], v[40:43], 0
    ds_write_b128 v248, v[136:139] offset:0
    v_mfma_f32_16x16x32_bf16 v[172:175], a[0:3], v[44:47], 0
    v_mfma_f32_16x16x32_bf16 v[184:187], a[8:11], v[40:43], 0
    ds_write_b128 v248, v[140:143] offset:256
    v_mfma_f32_16x16x32_bf16 v[188:191], a[8:11], v[44:47], 0
    v_bfe_u32 v128, v0, 4, 4
    s_mul_i32 s30, s3, 11
    v_add_u32 v129, s30, v128
    v_min_u32 v129, 42, v129
    v_and_b32 v130, 7, v129
    v_lshrrev_b32 v129, 3, v129
    v_lshl_add_u32 v129, v130, 1, v129
    v_add_u32 v129, 2, v129
    v_and_b32 v129, 15, v129
    v_lshl_add_u32 v129, v129, 3, v130
    v_min_u32 v130, 13, v128
    s_lshr_b32 s30, s21, 1
    s_add_u32 s30, s30, 5
    v_add_u32 v130, s30, v130
    v_and_b32 v130, 7, v130
    s_lshl_b32 s30, s21, 3
    v_add_u32 v130, s30, v130
    v_cmp_lt_u32 vcc, 10, v128
    s_mov_b32 s70, 16580608
    s_nop 0
    v_cndmask_b32 v129, v129, v130, vcc
    v_lshlrev_b32 v129, 7, v129
    s_mov_b64 exec, 0xffff
    buffer_load_dword v128, v129, s[4:7], s70 offen sc1
    s_mov_b64 exec, -1
    s_add_u32 m0, s28, 32768
    s_add_u32 s46, s46, 4096
    buffer_load_dwordx4 v0, s[92:95], s46 offen sc1  lds
    v_mfma_f32_16x16x32_bf16 v[176:179], a[4:7], v[40:43], 0
    ds_write_b128 v248, v[144:147] offset:2048
    v_mfma_f32_16x16x32_bf16 v[180:183], a[4:7], v[44:47], 0
    v_mfma_f32_16x16x32_bf16 v[192:195], a[12:15], v[40:43], 0
    ds_write_b128 v248, v[148:151] offset:2304
    v_mfma_f32_16x16x32_bf16 v[196:199], a[12:15], v[44:47], 0
    s_add_u32 m0, s28, 36864
    s_add_u32 s46, s46, 4096
    buffer_load_dwordx4 v0, s[92:95], s46 offen sc1  lds
    s_waitcnt vmcnt(7)
    v_mfma_f32_16x16x32_bf16 v[168:171], a[16:19], v[48:51], v[168:171]
    ds_write_b128 v248, v[152:155] offset:4096
    v_mfma_f32_16x16x32_bf16 v[172:175], a[16:19], v[52:55], v[172:175]
    v_mfma_f32_16x16x32_bf16 v[184:187], a[24:27], v[48:51], v[184:187]
    ds_write_b128 v248, v[156:159] offset:4352
    v_mfma_f32_16x16x32_bf16 v[188:191], a[24:27], v[52:55], v[188:191]
    s_add_u32 m0, s28, 40960
    s_add_u32 s46, s46, 4096
    buffer_load_dwordx4 v0, s[92:95], s46 offen sc1  lds
    v_mfma_f32_16x16x32_bf16 v[176:179], a[20:23], v[48:51], v[176:179]
    ds_write_b128 v248, v[160:163] offset:6144
    v_mfma_f32_16x16x32_bf16 v[180:183], a[20:23], v[52:55], v[180:183]
    v_mfma_f32_16x16x32_bf16 v[192:195], a[28:31], v[48:51], v[192:195]
    ds_write_b128 v248, v[164:167] offset:6400
    v_mfma_f32_16x16x32_bf16 v[196:199], a[28:31], v[52:55], v[196:199]
    s_add_u32 m0, s28, 45056
    s_add_u32 s46, s46, 4096
    buffer_load_dwordx4 v0, s[92:95], s46 offen sc1  lds
    s_waitcnt lgkmcnt(0)
    s_barrier
    ds_read_b128 v[72:75], v249 offset:0
    ds_read_b128 v[76:79], v249 offset:512
    ds_read_b128 v[80:83], v249 offset:8192
    ds_read_b128 v[84:87], v249 offset:8704
    ds_read_b128 v[88:91], v249 offset:16384
    ds_read_b128 v[92:95], v249 offset:16896
    ds_read_b128 v[96:99], v249 offset:24576
    ds_read_b128 v[100:103], v249 offset:25088
    s_waitcnt vmcnt(7)
    v_mfma_f32_16x16x32_bf16 v[168:171], a[32:35], v[56:59], v[168:171]
    v_mfma_f32_16x16x32_bf16 v[172:175], a[32:35], v[60:63], v[172:175]
    v_mfma_f32_16x16x32_bf16 v[184:187], a[40:43], v[56:59], v[184:187]
    v_mfma_f32_16x16x32_bf16 v[188:191], a[40:43], v[60:63], v[188:191]
    s_add_u32 m0, s28, 49152
    s_add_u32 s46, s46, 4096
    buffer_load_dwordx4 v0, s[92:95], s46 offen sc1  lds
    s_waitcnt lgkmcnt(4)
    v_pk_add_f32 v[72:73], v[72:73], v[80:81]
    v_pk_add_f32 v[74:75], v[74:75], v[82:83]
    v_pk_add_f32 v[76:77], v[76:77], v[84:85]
    v_pk_add_f32 v[78:79], v[78:79], v[86:87]
    v_pk_add_f32 v[104:105], v[104:105], v[72:73]
    v_pk_add_f32 v[106:107], v[106:107], v[74:75]
    v_pk_add_f32 v[108:109], v[108:109], v[76:77]
    v_pk_add_f32 v[110:111], v[110:111], v[78:79]
    s_waitcnt lgkmcnt(0)
    v_pk_add_f32 v[88:89], v[88:89], v[96:97]
    v_pk_add_f32 v[90:91], v[90:91], v[98:99]
    v_pk_add_f32 v[92:93], v[92:93], v[100:101]
    v_pk_add_f32 v[94:95], v[94:95], v[102:103]
    v_pk_add_f32 v[104:105], v[104:105], v[88:89]
    v_pk_add_f32 v[106:107], v[106:107], v[90:91]
    v_pk_add_f32 v[108:109], v[108:109], v[92:93]
    v_pk_add_f32 v[110:111], v[110:111], v[94:95]
    v_cvt_pk_bf16_f32 v72, v104, v105
    v_cvt_pk_bf16_f32 v73, v106, v107
    v_cvt_pk_bf16_f32 v74, v108, v109
    v_cvt_pk_bf16_f32 v75, v110, v111
    buffer_store_dwordx4 v[72:75], v250, s[12:15], s42 offen
    v_mfma_f32_16x16x32_bf16 v[176:179], a[36:39], v[56:59], v[176:179]
    v_mfma_f32_16x16x32_bf16 v[180:183], a[36:39], v[60:63], v[180:183]
    v_mfma_f32_16x16x32_bf16 v[192:195], a[44:47], v[56:59], v[192:195]
    v_mfma_f32_16x16x32_bf16 v[196:199], a[44:47], v[60:63], v[196:199]
    s_add_u32 m0, s28, 53248
    s_add_u32 s46, s46, 4096
    buffer_load_dwordx4 v0, s[92:95], s46 offen sc1  lds
    s_waitcnt vmcnt(8)
    v_mfma_f32_16x16x32_bf16 v[168:171], a[48:51], v[64:67], v[168:171]
    v_mfma_f32_16x16x32_bf16 v[172:175], a[48:51], v[68:71], v[172:175]
    v_mfma_f32_16x16x32_bf16 v[184:187], a[56:59], v[64:67], v[184:187]
    v_mfma_f32_16x16x32_bf16 v[188:191], a[56:59], v[68:71], v[188:191]
    v_mfma_f32_16x16x32_bf16 v[176:179], a[52:55], v[64:67], v[176:179]
    v_mfma_f32_16x16x32_bf16 v[180:183], a[52:55], v[68:71], v[180:183]
    v_mfma_f32_16x16x32_bf16 v[192:195], a[60:63], v[64:67], v[192:195]
    v_mfma_f32_16x16x32_bf16 v[196:199], a[60:63], v[68:71], v[196:199]
    s_nop 0
    ds_write_b128 v248, v[168:171] offset:32768
    ds_write_b128 v248, v[172:175] offset:33024
    s_waitcnt vmcnt(1)
    s_mov_b64 exec, 2
    s_cmp_eq_u32 s24, 0
    s_cbranch_scc1 Limp_15
    buffer_store_byte v3, off, s[4:7], s43
Lfl_16:
    s_mov_b64 exec, -1
    ds_write_b128 v248, v[176:179] offset:34816
    ds_write_b128 v248, v[180:183] offset:35072
    ds_write_b128 v248, v[184:187] offset:36864
    ds_write_b128 v248, v[188:191] offset:37120
    ds_write_b128 v248, v[192:195] offset:38912
    ds_write_b128 v248, v[196:199] offset:39168
    s_add_u32 m0, s28, 57344
    s_add_u32 s46, s46, 4096
    buffer_load_dwordx4 v0, s[92:95], s46 offen sc1  lds
    s_add_u32 m0, s28, 61440
    s_add_u32 s46, s46, 4096
    buffer_load_dwordx4 v0, s[92:95], s46 offen sc1  lds
    s_add_u32 m0, s28, 65536
    s_add_u32 s46, s46, 4096
    buffer_load_dwordx4 v0, s[92:95], s46 offen sc1  lds
    s_add_u32 m0, s28, 69632
    s_add_u32 s46, s46, 4096
    buffer_load_dwordx4 v0, s[92:95], s46 offen sc1  lds
    v_pk_add_f32 v[120:121], v[104:105], v[106:107]
    v_pk_mul_f32 v[122:123], v[104:105], v[104:105]
    v_pk_add_f32 v[120:121], v[120:121], v[108:109]
    v_pk_fma_f32 v[122:123], v[106:107], v[106:107], v[122:123]
    v_pk_add_f32 v[120:121], v[120:121], v[110:111]
    v_pk_fma_f32 v[122:123], v[108:109], v[108:109], v[122:123]
    v_add_f32 v120, v120, v121
    v_pk_fma_f32 v[122:123], v[110:111], v[110:111], v[122:123]
    v_add_f32 v122, v122, v123
    v_bfe_u32 v253, v0, 8, 1
    v_lshl_add_u32 v251, v253, 13, v251
    v_cmp_ne_u32 vcc, s80, v128
    s_nop 0
    s_and_b64 vcc, vcc, 0xffff
    s_cbranch_vccnz Lspin_17
Lspin_17_r:
    s_waitcnt lgkmcnt(0)
    s_barrier
    ds_read_b128 v[72:75], v249 offset:32768
    ds_read_b128 v[76:79], v249 offset:33280
    ds_read_b128 v[80:83], v249 offset:40960
    ds_read_b128 v[84:87], v249 offset:41472
    ds_read_b128 v[88:91], v249 offset:49152
    ds_read_b128 v[92:95], v249 offset:49664
    ds_read_b128 v[96:99], v249 offset:57344
    ds_read_b128 v[100:103], v249 offset:57856
    buffer_load_ubyte v4, v3, s[4:7], s44 offen sc1
    s_add_u32 m0, s28, 73728
    s_add_u32 s46, s46, 4096
    buffer_load_dwordx4 v0, s[92:95], s46 offen sc1  lds
    s_add_u32 m0, s28, 77824
    s_add_u32 s46, s46, 4096
    buffer_load_dwordx4 v0, s[92:95], s46 offen sc1  lds
    s_add_u32 s42, s42, 131072
    s_add_u32 s45, s45, 8192
    s_add_u32 s43, s43, 512
    s_waitcnt lgkmcnt(4)
    v_pk_add_f32 v[72:73], v[72:73], v[80:81]
    v_pk_add_f32 v[74:75], v[74:75], v[82:83]
    v_pk_add_f32 v[76:77], v[76:77], v[84:85]
    v_pk_add_f32 v[78:79], v[78:79], v[86:87]
    v_pk_add_f32 v[112:113], v[112:113], v[72:73]
    v_pk_add_f32 v[114:115], v[114:115], v[74:75]
    v_pk_add_f32 v[116:117], v[116:117], v[76:77]
    v_pk_add_f32 v[118:119], v[118:119], v[78:79]
    s_waitcnt lgkmcnt(0)
    v_pk_add_f32 v[88:89], v[88:89], v[96:97]
    v_pk_add_f32 v[90:91], v[90:91], v[98:99]
    v_pk_add_f32 v[92:93], v[92:93], v[100:101]
    v_pk_add_f32 v[94:95], v[94:95], v[102:103]
    v_pk_add_f32 v[112:113], v[112:113], v[88:89]
    v_pk_add_f32 v[114:115], v[114:115], v[90:91]
    v_pk_add_f32 v[116:117], v[116:117], v[92:93]
    v_pk_add_f32 v[118:119], v[118:119], v[94:95]
    v_cvt_pk_bf16_f32 v72, v112, v113
    v_cvt_pk_bf16_f32 v73, v114, v115
    v_cvt_pk_bf16_f32 v74, v116, v117
    v_cvt_pk_bf16_f32 v75, v118, v119
    s_cmp_ge_u32 s19, 29
    s_cbranch_scc1 Lskip3_20
    s_waitcnt vmcnt(2)
    v_cmp_gt_u32 vcc, 1, v4
    s_nop 0
    s_cbranch_vccz Lspin_22_r
Lspin_22:
    buffer_load_ubyte v4, v3, s[4:7], s44 offen sc1
    s_sub_u32 s60, s60, 1
    s_cbranch_scc1 K1_fail
    s_waitcnt vmcnt(0)
    v_cmp_gt_u32 vcc, 1, v4
    s_nop 0
    s_cbranch_vccnz Lspin_22
Lspin_22_r:
    s_cmp_eq_u32 s24, 0
    s_cbranch_scc1 Linv_24
Lok_23:
    buffer_load_dwordx4 v[8:11], v5, s[12:15], s72 offen offset:0 sc1
    buffer_load_dwordx4 v[12:15], v5, s[12:15], s72 offen offset:256 sc1
    buffer_load_dwordx4 v[16:19], v5, s[12:15], s72 offen offset:2048 sc1
    buffer_load_dwordx4 v[20:23], v5, s[12:15], s72 offen offset:2304 sc1
    s_add_u32 s72, s72, 4096
    buffer_load_dwordx4 v[24:27], v5, s[12:15], s72 offen offset:0 sc1
    buffer_store_dwordx4 v[72:75], v250, s[12:15], s42 offen
    v_pk_add_f32 v[124:125], v[112:113], v[114:115]
    v_pk_mul_f32 v[126:127], v[112:113], v[112:113]
    v_pk_add_f32 v[124:125], v[124:125], v[116:117]
    v_pk_fma_f32 v[126:127], v[114:115], v[114:115], v[126:127]
    v_pk_add_f32 v[124:125], v[124:125], v[118:119]
    v_pk_fma_f32 v[126:127], v[116:117], v[116:117], v[126:127]
    v_add_f32 v124, v124, v125
    v_pk_fma_f32 v[126:127], v[118:119], v[118:119], v[126:127]
    v_add_f32 v126, v126, v127
    v_permlane32_swap_b32 v120, v122
    s_sub_u32 s45, s45, 8192
    v_permlane32_swap_b32 v124, v126
    v_add_f32 v120, v120, v122
    v_add_f32 v124, v124, v126
    v_accvgpr_write_b32 a240, v104
    v_accvgpr_write_b32 a241, v105
    v_permlane16_swap_b32 v120, v124
    v_add_f32 v120, v120, v124
    v_accvgpr_write_b32 a242, v106
    v_accvgpr_write_b32 a243, v107
    v_add_f32 v120, v120, v120 row_ror:8 row_mask:0xf bank_mask:0xf
    s_mov_b32 exec_lo, 0x00ff00ff
    s_mov_b32 exec_hi, 0x00ff00ff
    buffer_store_dword v120, v251, s[4:7], s45 offen
    s_mov_b64 exec, -1
    s_barrier
    ds_read_b128 v[232:235], v1 offset:0
    ds_read_b128 v[236:239], v1 offset:256
    ds_read_b128 v[240:243], v1 offset:1024
    ds_read_b128 v[244:247], v1 offset:1280
    ds_read_b128 v[248:251], v1 offset:2048
    s_add_u32 s44, s44, 512
    s_waitcnt vmcnt(5) lgkmcnt(4)
    v_mfma_f32_16x16x32_bf16 v[136:139], v[232:235], v[8:11], 0
    ds_read_b128 v[252:255], v1 offset:2304
    buffer_load_dwordx4 v[28:31], v5, s[12:15], s72 offen offset:256 sc1
    v_mfma_f32_16x16x32_bf16 v[140:143], v[232:235], v[12:15], 0
    v_accvgpr_write_b32 a244, v108
    v_accvgpr_write_b32 a245, v109
    v_accvgpr_write_b32 a246, v110
    s_waitcnt lgkmcnt(4)
    v_mfma_f32_16x16x32_bf16 v[144:147], v[236:239], v[8:11], 0
    ds_read_b128 v[232:235], v1 offset:6144
    s_add_u32 m0, s28, 81920
    s_add_u32 s46, s46, 4096
    buffer_load_dwordx4 v0, s[92:95], s46 offen sc1  lds
    v_mfma_f32_16x16x32_bf16 v[148:151], v[236:239], v[12:15], 0
    v_accvgpr_write_b32 a247, v111
    v_accvgpr_write_b32 a248, v112
    v_accvgpr_write_b32 a249, v113
    s_waitcnt lgkmcnt(4)
    v_mfma_f32_16x16x32_bf16 v[152:155], v[240:243], v[8:11], 0
    ds_read_b128 v[236:239], v1 offset:6400
    buffer_load_dwordx4 v[32:35], v5, s[12:15], s72 offen offset:2048 sc1
    v_mfma_f32_16x16x32_bf16 v[156:159], v[240:243], v[12:15], 0
    v_accvgpr_write_b32 a250, v114
    v_accvgpr_write_b32 a251, v115
    v_accvgpr_write_b32 a252, v116
    s_waitcnt lgkmcnt(4)
    v_mfma_f32_16x16x32_bf16 v[160:163], v[244:247], v[8:11], 0
    ds_read_b128 v[240:243], v1 offset:7168
    buffer_load_dwordx4 v[36:39], v5, s[12:15], s72 offen offset:2304 sc1
    v_mfma_f32_16x16x32_bf16 v[164:167], v[244:247], v[12:15], 0
    v_accvgpr_write_b32 a253, v117
    v_accvgpr_write_b32 a254, v118
    v_accvgpr_write_b32 a255, v119
    s_waitcnt lgkmcnt(4)
    v_mfma_f32_16x16x32_bf16 v[168:171], v[248:251], v[8:11], 0
    ds_read_b128 v[244:247], v1 offset:7424
    v_mfma_f32_16x16x32_bf16 v[172:175], v[248:251], v[12:15], 0
    s_waitcnt lgkmcnt(4)
    v_mfma_f32_16x16x32_bf16 v[176:179], v[252:255], v[8:11], 0
    ds_read_b128 v[248:251], v1 offset:8192
    s_add_u32 s72, s72, 4096
    buffer_load_dwordx4 v[40:43], v5, s[12:15], s72 offen offset:0 sc1
    v_mfma_f32_16x16x32_bf16 v[180:183], v[252:255], v[12:15], 0
    s_waitcnt vmcnt(8) lgkmcnt(4)
    v_mfma_f32_16x16x32_bf16 v[136:139], v[232:235], v[16:19], v[136:139]
    ds_read_b128 v[252:255], v1 offset:8448
    buffer_load_dwordx4 v[44:47], v5, s[12:15], s72 offen offset:256 sc1
    v_mfma_f32_16x16x32_bf16 v[140:143], v[232:235], v[20:23], v[140:143]
    s_waitcnt lgkmcnt(4)
    v_mfma_f32_16x16x32_bf16 v[144:147], v[236:239], v[16:19], v[144:147]
    ds_read_b128 v[232:235], v1 offset:12288
    v_mfma_f32_16x16x32_bf16 v[148:151], v[236:239], v[20:23], v[148:151]
    s_waitcnt lgkmcnt(4)
    v_mfma_f32_16x16x32_bf16 v[152:155], v[240:243], v[16:19], v[152:155]
    ds_read_b128 v[236:239], v1 offset:12544
    buffer_load_dwordx4 v[48:51], v5, s[12:15], s72 offen offset:2048 sc1
    v_mfma_f32_16x16x32_bf16 v[156:159], v[240:243], v[20:23], v[156:159]
    s_waitcnt lgkmcnt(4)
    v_mfma_f32_16x16x32_bf16 v[160:163], v[244:247], v[16:19], v[160:163]
    ds_read_b128 v[240:243], v1 offset:13312
    buffer_load_dwordx4 v[52:55], v5, s[12:15], s72 offen offset:2304 sc1
    v_mfma_f32_16x16x32_bf16 v[164:167], v[244:247], v[20:23], v[164:167]
    s_waitcnt lgkmcnt(4)
    v_mfma_f32_16x16x32_bf16 v[168:171], v[248:251], v[16:19], v[168:171]
    ds_read_b128 v[244:247], v1 offset:13568
    s_add_u32 m0, s28, 86016
    s_add_u32 s46, s46, 4096
    buffer_load_dwordx4 v0, s[92:95], s46 offen sc1  lds
    v_mfma_f32_16x16x32_bf16 v[172:175], v[248:251], v[20:23], v[172:175]
    s_waitcnt lgkmcnt(4)
    v_mfma_f32_16x16x32_bf16 v[176:179], v[252:255], v[16:19], v[176:179]
    ds_read_b128 v[248:251], v1 offset:14336
    s_add_u32 s72, s72, 4096
    buffer_load_dwordx4 v[56:59], v5, s[12:15], s72 offen offset:0 sc1
    v_mfma_f32_16x16x32_bf16 v[180:183], v[252:255], v[20:23], v[180:183]
    s_waitcnt vmcnt(9) lgkmcnt(4)
    v_mfma_f32_16x16x32_bf16 v[136:139], v[232:235], v[24:27], v[136:139]
    ds_read_b128 v[252:255], v1 offset:14592
    v_mfma_f32_16x16x32_bf16 v[140:143], v[232:235], v[28:31], v[140:143]
    s_waitcnt lgkmcnt(4)
    v_mfma_f32_16x16x32_bf16 v[144:147], v[236:239], v[24:27], v[144:147]
    ds_read_b128 v[232:235], v1 offset:18432
    v_mfma_f32_16x16x32_bf16 v[148:151], v[236:239], v[28:31], v[148:151]
    s_waitcnt lgkmcnt(4)
    v_mfma_f32_16x16x32_bf16 v[152:155], v[240:243], v[24:27], v[152:155]
    ds_read_b128 v[236:239], v1 offset:18688
    buffer_load_dwordx4 v[60:63], v5, s[12:15], s72 offen offset:256 sc1
    v_mfma_f32_16x16x32_bf16 v[156:159], v[240:243], v[28:31], v[156:159]
    s_waitcnt lgkmcnt(4)
    v_mfma_f32_16x16x32_bf16 v[160:163], v[244:247], v[24:27], v[160:163]
    ds_read_b128 v[240:243], v1 offset:19456
    v_mfma_f32_16x16x32_bf16 v[164:167], v[244:247], v[28:31], v[164:167]
    s_waitcnt lgkmcnt(4)
    v_mfma_f32_16x16x32_bf16 v[168:171], v[248:251], v[24:27], v[168:171]
    ds_read_b128 v[244:247], v1 offset:19712
    s_mov_b64 exec, 2
    s_cmp_eq_u32 s24, 0
    s_cbranch_scc1 Limp_25
    buffer_store_byte v3, off, s[4:7], s43
Lfl_26:
    s_mov_b64 exec, -1
    v_mfma_f32_16x16x32_bf16 v[172:175], v[248:251], v[28:31], v[172:175]
    s_waitcnt lgkmcnt(4)
    v_mfma_f32_16x16x32_bf16 v[176:179], v[252:255], v[24:27], v[176:179]
    ds_read_b128 v[248:251], v1 offset:20480
    buffer_load_dwordx4 v[64:67], v5, s[12:15], s72 offen offset:2048 sc1
    v_mfma_f32_16x16x32_bf16 v[180:183], v[252:255], v[28:31], v[180:183]
    s_waitcnt vmcnt(9) lgkmcnt(4)
    v_mfma_f32_16x16x32_bf16 v[136:139], v[232:235], v[32:35], v[136:139]
    ds_read_b128 v[252:255], v1 offset:20736
    v_mfma_f32_16x16x32_bf16 v[140:143], v[232:235], v[36:39], v[140:143]
    s_waitcnt lgkmcnt(4)
    v_mfma_f32_16x16x32_bf16 v[144:147], v[236:239], v[32:35], v[144:147]
    ds_read_b128 v[232:235], v1 offset:24576
    s_add_u32 m0, s28, 90112
    s_add_u32 s46, s46, 4096
    buffer_load_dwordx4 v0, s[92:95], s46 offen sc1  lds
    v_mfma_f32_16x16x32_bf16 v[148:151], v[236:239], v[36:39], v[148:151]
    s_waitcnt lgkmcnt(4)
    v_mfma_f32_16x16x32_bf16 v[152:155], v[240:243], v[32:35], v[152:155]
    ds_read_b128 v[236:239], v1 offset:24832
    buffer_load_dwordx4 v[68:71], v5, s[12:15], s72 offen offset:2304 sc1
    v_mfma_f32_16x16x32_bf16 v[156:159], v[240:243], v[36:39], v[156:159]
    s_waitcnt lgkmcnt(4)
    v_mfma_f32_16x16x32_bf16 v[160:163], v[244:247], v[32:35], v[160:163]
    ds_read_b128 v[240:243], v1 offset:25600
    v_mfma_f32_16x16x32_bf16 v[164:167], v[244:247], v[36:39], v[164:167]
    s_waitcnt lgkmcnt(4)
    v_mfma_f32_16x16x32_bf16 v[168:171], v[248:251], v[32:35], v[168:171]
    ds_read_b128 v[244:247], v1 offset:25856
    v_mfma_f32_16x16x32_bf16 v[172:175], v[248:251], v[36:39], v[172:175]
    s_waitcnt lgkmcnt(4)
    v_mfma_f32_16x16x32_bf16 v[176:179], v[252:255], v[32:35], v[176:179]
    ds_read_b128 v[248:251], v1 offset:26624
    s_add_u32 s72, s72, 4096
    buffer_load_dwordx4 v[72:75], v5, s[12:15], s72 offen offset:0 sc1
    v_mfma_f32_16x16x32_bf16 v[180:183], v[252:255], v[36:39], v[180:183]
    s_waitcnt vmcnt(10) lgkmcnt(4)
    v_mfma_f32_16x16x32_bf16 v[136:139], v[232:235], v[40:43], v[136:139]
    ds_read_b128 v[252:255], v1 offset:26880
    v_mfma_f32_16x16x32_bf16 v[140:143], v[232:235], v[44:47], v[140:143]
    s_waitcnt lgkmcnt(4)
    v_mfma_f32_16x16x32_bf16 v[144:147], v[236:239], v[40:43], v[144:147]
    ds_read_b128 v[232:235], v1 offset:30720
    v_mfma_f32_16x16x32_bf16 v[148:151], v[236:239], v[44:47], v[148:151]
    s_waitcnt lgkmcnt(4)
    v_mfma_f32_16x16x32_bf16 v[152:155], v[240:243], v[40:43], v[152:155]
    ds_read_b128 v[236:239], v1 offset:30976
    buffer_load_dwordx4 v[76:79], v5, s[12:15], s72 offen offset:256 sc1
    v_mfma_f32_16x16x32_bf16 v[156:159], v[240:243], v[44:47], v[156:159]
    s_waitcnt lgkmcnt(4)
    v_mfma_f32_16x16x32_bf16 v[160:163], v[244:247], v[40:43], v[160:163]
    ds_read_b128 v[240:243], v1 offset:31744
    v_mfma_f32_16x16x32_bf16 v[164:167], v[244:247], v[44:47], v[164:167]
    s_waitcnt lgkmcnt(4)
    v_mfma_f32_16x16x32_bf16 v[168:171], v[248:251], v[40:43], v[168:171]
    ds_read_b128 v[244:247], v1 offset:32000
    s_add_u32 m0, s28, 94208
    s_add_u32 s46, s46, 4096
    buffer_load_dwordx4 v0, s[92:95], s46 offen sc1  lds
    v_mfma_f32_16x16x32_bf16 v[172:175], v[248:251], v[44:47], v[172:175]
    s_waitcnt lgkmcnt(4)
    v_mfma_f32_16x16x32_bf16 v[176:179], v[252:255], v[40:43], v[176:179]
    ds_read_b128 v[248:251], v1 offset:32768
    buffer_load_dwordx4 v[80:83], v5, s[12:15], s72 offen offset:2048 sc1
    v_mfma_f32_16x16x32_bf16 v[180:183], v[252:255], v[44:47], v[180:183]
    s_waitcnt vmcnt(11) lgkmcnt(4)
    v_mfma_f32_16x16x32_bf16 v[136:139], v[232:235], v[48:51], v[136:139]
    ds_read_b128 v[252:255], v1 offset:33024
    v_mfma_f32_16x16x32_bf16 v[140:143], v[232:235], v[52:55], v[140:143]
    s_waitcnt lgkmcnt(4)
    v_mfma_f32_16x16x32_bf16 v[144:147], v[236:239], v[48:51], v[144:147]
    ds_read_b128 v[232:235], v1 offset:36864
    v_mfma_f32_16x16x32_bf16 v[148:151], v[236:239], v[52:55], v[148:151]
    s_waitcnt lgkmcnt(4)
    v_mfma_f32_16x16x32_bf16 v[152:155], v[240:243], v[48:51], v[152:155]
    ds_read_b128 v[236:239], v1 offset:37120
    buffer_load_dwordx4 v[84:87], v5, s[12:15], s72 offen offset:2304 sc1
    v_mfma_f32_16x16x32_bf16 v[156:159], v[240:243], v[52:55], v[156:159]
    s_waitcnt lgkmcnt(4)
    v_mfma_f32_16x16x32_bf16 v[160:163], v[244:247], v[48:51], v[160:163]
    ds_read_b128 v[240:243], v1 offset:37888
    v_mfma_f32_16x16x32_bf16 v[164:167], v[244:247], v[52:55], v[164:167]
    s_waitcnt lgkmcnt(4)
    v_mfma_f32_16x16x32_bf16 v[168:171], v[248:251], v[48:51], v[168:171]
    ds_read_b128 v[244:247], v1 offset:38144
    v_mfma_f32_16x16x32_bf16 v[172:175], v[248:251], v[52:55], v[172:175]
IT_4:
    s_cbranch_execz IT_8
    s_waitcnt lgkmcnt(4)
    v_mfma_f32_16x16x32_bf16 v[176:179], v[252:255], v[48:51], v[176:179]
    ds_read_b128 v[248:251], v1 offset:38912
    s_add_u32 s72, s72, 4096
    buffer_load_dwordx4 v[88:91], v5, s[12:15], s72 offen offset:0 sc1
    v_mfma_f32_16x16x32_bf16 v[180:183], v[252:255], v[52:55], v[180:183]
    s_waitcnt vmcnt(10) lgkmcnt(4)
    v_mfma_f32_16x16x32_bf16 v[136:139], v[232:235], v[56:59], v[136:139]
    ds_read_b128 v[252:255], v1 offset:39168
    v_mfma_f32_16x16x32_bf16 v[140:143], v[232:235], v[60:63], v[140:143]
    s_waitcnt lgkmcnt(4)
    v_mfma_f32_16x16x32_bf16 v[144:147], v[236:239], v[56:59], v[144:147]
    ds_read_b128 v[232:235], v1 offset:43008
    buffer_load_dwordx4 a[64:67], v5, s[4:7], s77 offen offset:0 sc1
    v_mfma_f32_16x16x32_bf16 v[148:151], v[236:239], v[60:63], v[148:151]
    s_waitcnt lgkmcnt(4)
    v_mfma_f32_16x16x32_bf16 v[152:155], v[240:243], v[56:59], v[152:155]
    ds_read_b128 v[236:239], v1 offset:43264
    buffer_load_dwordx4 v[92:95], v5, s[12:15], s72 offen offset:256 sc1
    v_mfma_f32_16x16x32_bf16 v[156:159], v[240:243], v[60:63], v[156:159]
    s_waitcnt lgkmcnt(4)
    v_mfma_f32_16x16x32_bf16 v[160:163], v[244:247], v[56:59], v[160:163]
    ds_read_b128 v[240:243], v1 offset:44032
    v_mfma_f32_16x16x32_bf16 v[164:167], v[244:247], v[60:63], v[164:167]
    s_waitcnt lgkmcnt(4)
    v_mfma_f32_16x16x32_bf16 v[168:171], v[248:251], v[56:59], v[168:171]
    ds_read_b128 v[244:247], v1 offset:44288
    buffer_load_dwordx4 a[68:71], v5, s[4:7], s77 offen offset:256 sc1
    v_mfma_f32_16x16x32_bf16 v[172:175], v[248:251], v[60:63], v[172:175]
    s_waitcnt lgkmcnt(4)
    v_mfma_f32_16x16x32_bf16 v[176:179], v[252:255], v[56:59], v[176:179]
    ds_read_b128 v[248:251], v1 offset:45056
    buffer_load_dwordx4 v[96:99], v5, s[12:15], s72 offen offset:2048 sc1
    v_mfma_f32_16x16x32_bf16 v[180:183], v[252:255], v[60:63], v[180:183]
    s_waitcnt vmcnt(10) lgkmcnt(4)
    v_mfma_f32_16x16x32_bf16 v[136:139], v[232:235], v[64:67], v[136:139]
    ds_read_b128 v[252:255], v1 offset:45312
    v_mfma_f32_16x16x32_bf16 v[140:143], v[232:235], v[68:71], v[140:143]
    s_waitcnt lgkmcnt(4)
    v_mfma_f32_16x16x32_bf16 v[144:147], v[236:239], v[64:67], v[144:147]
    ds_read_b128 v[232:235], v2 offset:0
    buffer_load_dwordx4 a[72:75], v5, s[4:7], s77 offen offset:2048 sc1
    v_mfma_f32_16x16x32_bf16 v[148:151], v[236:239], v[68:71], v[148:151]
    s_waitcnt lgkmcnt(4)
    v_mfma_f32_16x16x32_bf16 v[152:155], v[240:243], v[64:67], v[152:155]
    ds_read_b128 v[236:239], v2 offset:256
    buffer_load_dwordx4 v[100:103], v5, s[12:15], s72 offen offset:2304 sc1
    v_mfma_f32_16x16x32_bf16 v[156:159], v[240:243], v[68:71], v[156:159]
    s_waitcnt lgkmcnt(4)
    v_mfma_f32_16x16x32_bf16 v[160:163], v[244:247], v[64:67], v[160:163]
    ds_read_b128 v[240:243], v2 offset:1024
    v_mfma_f32_16x16x32_bf16 v[164:167], v[244:247], v[68:71], v[164:167]
    s_waitcnt lgkmcnt(4)
    v_mfma_f32_16x16x32_bf16 v[168:171], v[248:251], v[64:67], v[168:171]
    ds_read_b128 v[244:247], v2 offset:1280
    buffer_load_dwordx4 a[76:79], v5, s[4:7], s77 offen offset:2304 sc1
    v_mfma_f32_16x16x32_bf16 v[172:175], v[248:251], v[68:71], v[172:175]
    s_waitcnt lgkmcnt(4)
    v_mfma_f32_16x16x32_bf16 v[176:179], v[252:255], v[64:67], v[176:179]
    ds_read_b128 v[248:251], v2 offset:2048
    s_add_u32 s72, s72, 4096
    buffer_load_dwordx4 v[104:107], v5, s[12:15], s72 offen offset:0 sc1
    v_mfma_f32_16x16x32_bf16 v[180:183], v[252:255], v[68:71], v[180:183]
    s_waitcnt vmcnt(12) lgkmcnt(4)
    v_mfma_f32_16x16x32_bf16 v[136:139], v[232:235], v[72:75], v[136:139]
    ds_read_b128 v[252:255], v2 offset:2304
    v_mfma_f32_16x16x32_bf16 v[140:143], v[232:235], v[76:79], v[140:143]
    s_waitcnt lgkmcnt(4)
    v_mfma_f32_16x16x32_bf16 v[144:147], v[236:239], v[72:75], v[144:147]
    ds_read_b128 v[232:235], v2 offset:6144
    s_add_u32 s77, s77, 4096
    buffer_load_dwordx4 a[80:83], v5, s[4:7], s77 offen offset:0 sc1
    v_mfma_f32_16x16x32_bf16 v[148:151], v[236:239], v[76:79], v[148:151]
    s_waitcnt lgkmcnt(4)
    v_mfma_f32_16x16x32_bf16 v[152:155], v[240:243], v[72:75], v[152:155]
    ds_read_b128 v[236:239], v2 offset:6400
    buffer_load_dwordx4 v[108:111], v5, s[12:15], s72 offen offset:256 sc1
    v_mfma_f32_16x16x32_bf16 v[156:159], v[240:243], v[76:79], v[156:159]
    s_waitcnt lgkmcnt(4)
    v_mfma_f32_16x16x32_bf16 v[160:163], v[244:247], v[72:75], v[160:163]
    ds_read_b128 v[240:243], v2 offset:7168
    v_mfma_f32_16x16x32_bf16 v[164:167], v[244:247], v[76:79], v[164:167]
    s_waitcnt lgkmcnt(4)
    v_mfma_f32_16x16x32_bf16 v[168:171], v[248:251], v[72:75], v[168:171]
    ds_read_b128 v[244:247], v2 offset:7424
    buffer_load_dwordx4 a[84:87], v5, s[4:7], s77 offen offset:256 sc1
    v_mfma_f32_16x16x32_bf16 v[172:175], v[248:251], v[76:79], v[172:175]
    s_waitcnt lgkmcnt(4)
    v_mfma_f32_16x16x32_bf16 v[176:179], v[252:255], v[72:75], v[176:179]
    ds_read_b128 v[248:251], v2 offset:8192
    buffer_load_dwordx4 v[112:115], v5, s[12:15], s72 offen offset:2048 sc1
    v_mfma_f32_16x16x32_bf16 v[180:183], v[252:255], v[76:79], v[180:183]
    s_waitcnt vmcnt(13) lgkmcnt(4)
    v_mfma_f32_16x16x32_bf16 v[136:139], v[232:235], v[80:83], v[136:139]
    ds_read_b128 v[252:255], v2 offset:8448
    v_mfma_f32_16x16x32_bf16 v[140:143], v[232:235], v[84:87], v[140:143]
    s_waitcnt lgkmcnt(4)
    v_mfma_f32_16x16x32_bf16 v[144:147], v[236:239], v[80:83], v[144:147]
    ds_read_b128 v[232:235], v2 offset:12288
    buffer_load_dwordx4 a[88:91], v5, s[4:7], s77 offen offset:2048 sc1
    v_mfma_f32_16x16x32_bf16 v[148:151], v[236:239], v[84:87], v[148:151]
    s_waitcnt lgkmcnt(4)
    v_mfma_f32_16x16x32_bf16 v[152:155], v[240:243], v[80:83], v[152:155]
    ds_read_b128 v[236:239], v2 offset:12544
    buffer_load_dwordx4 v[116:119], v5, s[12:15], s72 offen offset:2304 sc1
    v_mfma_f32_16x16x32_bf16 v[156:159], v[240:243], v[84:87], v[156:159]
    s_waitcnt lgkmcnt(4)
    v_mfma_f32_16x16x32_bf16 v[160:163], v[244:247], v[80:83], v[160:163]
    ds_read_b128 v[240:243], v2 offset:13312
    buffer_load_ubyte v4, v3, s[4:7], s44 offen sc1
    v_mfma_f32_16x16x32_bf16 v[164:167], v[244:247], v[84:87], v[164:167]
    s_waitcnt lgkmcnt(4)
    v_mfma_f32_16x16x32_bf16 v[168:171], v[248:251], v[80:83], v[168:171]
    ds_read_b128 v[244:247], v2 offset:13568
    buffer_load_dwordx4 a[92:95], v5, s[4:7], s77 offen offset:2304 sc1
    v_mfma_f32_16x16x32_bf16 v[172:175], v[248:251], v[84:87], v[172:175]
    s_waitcnt lgkmcnt(4)
    v_mfma_f32_16x16x32_bf16 v[176:179], v[252:255], v[80:83], v[176:179]
    ds_read_b128 v[248:251], v2 offset:14336
    s_add_u32 s72, s72, 4096
    buffer_load_dwordx4 v[120:123], v5, s[12:15], s72 offen offset:0 sc1
    v_mfma_f32_16x16x32_bf16 v[180:183], v[252:255], v[84:87], v[180:183]
    s_waitcnt vmcnt(15) lgkmcnt(4)
    v_mfma_f32_16x16x32_bf16 v[136:139], v[232:235], v[88:91], v[136:139]
    ds_read_b128 v[252:255], v2 offset:14592
    v_mfma_f32_16x16x32_bf16 v[140:143], v[232:235], v[92:95], v[140:143]
    s_waitcnt lgkmcnt(4)
    v_mfma_f32_16x16x32_bf16 v[144:147], v[236:239], v[88:91], v[144:147]
    ds_read_b128 v[232:235], v2 offset:18432
    s_add_u32 s77, s77, 4096
    buffer_load_dwordx4 a[96:99], v5, s[4:7], s77 offen offset:0 sc1
    v_mfma_f32_16x16x32_bf16 v[148:151], v[236:239], v[92:95], v[148:151]
    s_waitcnt lgkmcnt(4)
    v_mfma_f32_16x16x32_bf16 v[152:155], v[240:243], v[88:91], v[152:155]
    ds_read_b128 v[236:239], v2 offset:18688
    buffer_load_dwordx4 v[124:127], v5, s[12:15], s72 offen offset:256 sc1
    v_mfma_f32_16x16x32_bf16 v[156:159], v[240:243], v[92:95], v[156:159]
    s_waitcnt lgkmcnt(4)
    v_mfma_f32_16x16x32_bf16 v[160:163], v[244:247], v[88:91], v[160:163]
    ds_read_b128 v[240:243], v2 offset:19456
    v_mfma_f32_16x16x32_bf16 v[164:167], v[244:247], v[92:95], v[164:167]
    s_waitcnt lgkmcnt(4)
    v_mfma_f32_16x16x32_bf16 v[168:171], v[248:251], v[88:91], v[168:171]
    ds_read_b128 v[244:247], v2 offset:19712
    buffer_load_dwordx4 a[100:103], v5, s[4:7], s77 offen offset:256 sc1
    v_mfma_f32_16x16x32_bf16 v[172:175], v[248:251], v[92:95], v[172:175]
    s_waitcnt lgkmcnt(4)
    v_mfma_f32_16x16x32_bf16 v[176:179], v[252:255], v[88:91], v[176:179]
    ds_read_b128 v[248:251], v2 offset:20480
    buffer_load_dwordx4 v[128:131], v5, s[12:15], s72 offen offset:2048 sc1
    v_mfma_f32_16x16x32_bf16 v[180:183], v[252:255], v[92:95], v[180:183]
    s_waitcnt vmcnt(15) lgkmcnt(4)
    v_mfma_f32_16x16x32_bf16 v[136:139], v[232:235], v[96:99], v[136:139]
    ds_read_b128 v[252:255], v2 offset:20736
    v_mfma_f32_16x16x32_bf16 v[140:143], v[232:235], v[100:103], v[140:143]
    s_waitcnt lgkmcnt(4)
    v_mfma_f32_16x16x32_bf16 v[144:147], v[236:239], v[96:99], v[144:147]
    s_barrier
    ds_read_b128 v[232:235], v2 offset:24576
    v_mfma_f32_16x16x32_bf16 v[148:151], v[236:239], v[100:103], v[148:151]
    s_waitcnt vmcnt(6)
    v_cmp_gt_u32 vcc, 1, v4
    s_nop 0
    s_cbranch_vccnz Lspin_27
Lspin_27_r:
    s_cmp_eq_u32 s24, 0
    s_cbranch_scc1 Linv_29
Lok_28:
    buffer_load_dwordx4 a[104:107], v5, s[4:7], s77 offen offset:2048 sc1
    s_waitcnt lgkmcnt(4)
    v_mfma_f32_16x16x32_bf16 v[152:155], v[240:243], v[96:99], v[152:155]
    ds_read_b128 v[236:239], v2 offset:24832
    buffer_load_dwordx4 v[132:135], v5, s[12:15], s72 offen offset:2304 sc1
    v_mfma_f32_16x16x32_bf16 v[156:159], v[240:243], v[100:103], v[156:159]
    s_waitcnt lgkmcnt(4)
    v_mfma_f32_16x16x32_bf16 v[160:163], v[244:247], v[96:99], v[160:163]
    ds_read_b128 v[240:243], v2 offset:25600
    v_mfma_f32_16x16x32_bf16 v[164:167], v[244:247], v[100:103], v[164:167]
    s_waitcnt lgkmcnt(4)
    v_mfma_f32_16x16x32_bf16 v[168:171], v[248:251], v[96:99], v[168:171]
    ds_read_b128 v[244:247], v2 offset:25856
    buffer_load_dwordx4 a[108:111], v5, s[4:7], s77 offen offset:2304 sc1
    v_mfma_f32_16x16x32_bf16 v[172:175], v[248:251], v[100:103], v[172:175]
    s_waitcnt lgkmcnt(4)
    v_mfma_f32_16x16x32_bf16 v[176:179], v[252:255], v[96:99], v[176:179]
    ds_read_b128 v[248:251], v2 offset:26624
    buffer_load_dwordx4 v[8:11], v5, s[12:15], s73 offen offset:0 sc1
    v_mfma_f32_16x16x32_bf16 v[180:183], v[252:255], v[100:103], v[180:183]
    s_waitcnt lgkmcnt(4)
    v_mfma_f32_16x16x32_bf16 v[136:139], v[232:235], v[104:107], v[136:139]
    ds_read_b128 v[252:255], v2 offset:26880
    v_mfma_f32_16x16x32_bf16 v[140:143], v[232:235], v[108:111], v[140:143]
    s_waitcnt lgkmcnt(4)
    v_mfma_f32_16x16x32_bf16 v[144:147], v[236:239], v[104:107], v[144:147]
    ds_read_b128 v[232:235], v2 offset:30720
    s_add_u32 s77, s77, 4096
    buffer_load_dwordx4 a[112:115], v5, s[4:7], s77 offen offset:0 sc1
    v_mfma_f32_16x16x32_bf16 v[148:151], v[236:239], v[108:111], v[148:151]
    s_waitcnt lgkmcnt(4)
    v_mfma_f32_16x16x32_bf16 v[152:155], v[240:243], v[104:107], v[152:155]
    ds_read_b128 v[236:239], v2 offset:30976
    buffer_load_dwordx4 v[12:15], v5, s[12:15], s73 offen offset:256 sc1
    v_mfma_f32_16x16x32_bf16 v[156:159], v[240:243], v[108:111], v[156:159]
    s_waitcnt lgkmcnt(4)
    v_mfma_f32_16x16x32_bf16 v[160:163], v[244:247], v[104:107], v[160:163]
    ds_read_b128 v[240:243], v2 offset:31744
    v_mfma_f32_16x16x32_bf16 v[164:167], v[244:247], v[108:111], v[164:167]
    s_waitcnt lgkmcnt(4)
    v_mfma_f32_16x16x32_bf16 v[168:171], v[248:251], v[104:107], v[168:171]
    ds_read_b128 v[244:247], v2 offset:32000
    buffer_load_dwordx4 a[116:119], v5, s[4:7], s77 offen offset:256 sc1
    v_mfma_f32_16x16x32_bf16 v[172:175], v[248:251], v[108:111], v[172:175]
    s_waitcnt lgkmcnt(4)
    v_mfma_f32_16x16x32_bf16 v[176:179], v[252:255], v[104:107], v[176:179]
    ds_read_b128 v[248:251], v2 offset:32768
    buffer_load_dwordx4 v[16:19], v5, s[12:15], s73 offen offset:2048 sc1
    v_mfma_f32_16x16x32_bf16 v[180:183], v[252:255], v[108:111], v[180:183]
    s_waitcnt lgkmcnt(4)
    v_mfma_f32_16x16x32_bf16 v[136:139], v[232:235], v[112:115], v[136:139]
    ds_read_b128 v[252:255], v2 offset:33024
    v_mfma_f32_16x16x32_bf16 v[140:143], v[232:235], v[116:119], v[140:143]
    s_waitcnt lgkmcnt(4)
    v_mfma_f32_16x16x32_bf16 v[144:147], v[236:239], v[112:115], v[144:147]
    ds_read_b128 v[232:235], v2 offset:36864
    buffer_load_dwordx4 a[120:123], v5, s[4:7], s77 offen offset:2048 sc1
    v_mfma_f32_16x16x32_bf16 v[148:151], v[236:239], v[116:119], v[148:151]
    s_waitcnt lgkmcnt(4)
    v_mfma_f32_16x16x32_bf16 v[152:155], v[240:243], v[112:115], v[152:155]
    ds_read_b128 v[236:239], v2 offset:37120
    buffer_load_dwordx4 v[20:23], v5, s[12:15], s73 offen offset:2304 sc1
    v_mfma_f32_16x16x32_bf16 v[156:159], v[240:243], v[116:119], v[156:159]
    s_waitcnt lgkmcnt(4)
    v_mfma_f32_16x16x32_bf16 v[160:163], v[244:247], v[112:115], v[160:163]
    ds_read_b128 v[240:243], v2 offset:37888
    v_mfma_f32_16x16x32_bf16 v[164:167], v[244:247], v[116:119], v[164:167]
    s_waitcnt lgkmcnt(4)
    v_mfma_f32_16x16x32_bf16 v[168:171], v[248:251], v[112:115], v[168:171]
    ds_read_b128 v[244:247], v2 offset:38144
    buffer_load_dwordx4 a[124:127], v5, s[4:7], s77 offen offset:2304 sc1
    v_mfma_f32_16x16x32_bf16 v[172:175], v[248:251], v[116:119], v[172:175]
    s_waitcnt lgkmcnt(4)
    v_mfma_f32_16x16x32_bf16 v[176:179], v[252:255], v[112:115], v[176:179]
    ds_read_b128 v[248:251], v2 offset:38912
    s_add_u32 s73, s73, 4096
    buffer_load_dwordx4 v[24:27], v5, s[12:15], s73 offen offset:0 sc1
    v_mfma_f32_16x16x32_bf16 v[180:183], v[252:255], v[116:119], v[180:183]
    s_waitcnt vmcnt(14) lgkmcnt(4)
    v_mfma_f32_16x16x32_bf16 v[136:139], v[232:235], v[120:123], v[136:139]
    ds_read_b128 v[252:255], v2 offset:39168
    v_mfma_f32_16x16x32_bf16 v[140:143], v[232:235], v[124:127], v[140:143]
    s_waitcnt lgkmcnt(4)
    v_mfma_f32_16x16x32_bf16 v[144:147], v[236:239], v[120:123], v[144:147]
    ds_read_b128 v[232:235], v2 offset:43008
    s_add_u32 s77, s77, 4096
    buffer_load_dwordx4 a[128:131], v5, s[4:7], s77 offen offset:0 sc1
    v_mfma_f32_16x16x32_bf16 v[148:151], v[236:239], v[124:127], v[148:151]
    s_waitcnt lgkmcnt(4)
    v_mfma_f32_16x16x32_bf16 v[152:155], v[240:243], v[120:123], v[152:155]
    ds_read_b128 v[236:239], v2 offset:43264
    buffer_load_dwordx4 v[28:31], v5, s[12:15], s73 offen offset:256 sc1
    v_mfma_f32_16x16x32_bf16 v[156:159], v[240:243], v[124:127], v[156:159]
    s_waitcnt lgkmcnt(4)
    v_mfma_f32_16x16x32_bf16 v[160:163], v[244:247], v[120:123], v[160:163]
    ds_read_b128 v[240:243], v2 offset:44032
    v_mfma_f32_16x16x32_bf16 v[164:167], v[244:247], v[124:127], v[164:167]
    s_waitcnt lgkmcnt(4)
    v_mfma_f32_16x16x32_bf16 v[168:171], v[248:251], v[120:123], v[168:171]
    ds_read_b128 v[244:247], v2 offset:44288
    buffer_load_dwordx4 a[132:135], v5, s[4:7], s77 offen offset:256 sc1
    v_mfma_f32_16x16x32_bf16 v[172:175], v[248:251], v[124:127], v[172:175]
    s_waitcnt lgkmcnt(4)
    v_mfma_f32_16x16x32_bf16 v[176:179], v[252:255], v[120:123], v[176:179]
    ds_read_b128 v[248:251], v2 offset:45056
    buffer_load_dwordx4 v[32:35], v5, s[12:15], s73 offen offset:2048 sc1
    v_mfma_f32_16x16x32_bf16 v[180:183], v[252:255], v[124:127], v[180:183]
    s_waitcnt vmcnt(14) lgkmcnt(4)
    v_mfma_f32_16x16x32_bf16 v[136:139], v[232:235], v[128:131], v[136:139]
    ds_read_b128 v[252:255], v2 offset:45312
    v_mfma_f32_16x16x32_bf16 v[140:143], v[232:235], v[132:135], v[140:143]
    s_waitcnt lgkmcnt(4)
    v_mfma_f32_16x16x32_bf16 v[144:147], v[236:239], v[128:131], v[144:147]
    ds_read_b128 v[232:235], v1 offset:0
    buffer_load_dwordx4 a[136:139], v5, s[4:7], s77 offen offset:2048 sc1
    v_mfma_f32_16x16x32_bf16 v[148:151], v[236:239], v[132:135], v[148:151]
    s_waitcnt lgkmcnt(4)
    v_mfma_f32_16x16x32_bf16 v[152:155], v[240:243], v[128:131], v[152:155]
    ds_read_b128 v[236:239], v1 offset:256
    buffer_load_dwordx4 v[36:39], v5, s[12:15], s73 offen offset:2304 sc1
    v_mfma_f32_16x16x32_bf16 v[156:159], v[240:243], v[132:135], v[156:159]
    s_waitcnt lgkmcnt(4)
    v_mfma_f32_16x16x32_bf16 v[160:163], v[244:247], v[128:131], v[160:163]
    ds_read_b128 v[240:243], v1 offset:1024
    v_mfma_f32_16x16x32_bf16 v[164:167], v[244:247], v[132:135], v[164:167]
    s_waitcnt lgkmcnt(4)
    v_mfma_f32_16x16x32_bf16 v[168:171], v[248:251], v[128:131], v[168:171]
    ds_read_b128 v[244:247], v1 offset:1280
    buffer_load_dwordx4 a[140:143], v5, s[4:7], s77 offen offset:2304 sc1
    v_mfma_f32_16x16x32_bf16 v[172:175], v[248:251], v[132:135], v[172:175]
    s_waitcnt lgkmcnt(4)
    v_mfma_f32_16x16x32_bf16 v[176:179], v[252:255], v[128:131], v[176:179]
    ds_read_b128 v[248:251], v1 offset:2048
    s_add_u32 s73, s73, 4096
    buffer_load_dwordx4 v[40:43], v5, s[12:15], s73 offen offset:0 sc1
    v_mfma_f32_16x16x32_bf16 v[180:183], v[252:255], v[132:135], v[180:183]
    s_waitcnt vmcnt(14) lgkmcnt(4)
    v_mfma_f32_16x16x32_bf16 v[184:187], v[232:235], v[8:11], 0
    ds_read_b128 v[252:255], v1 offset:2304
    v_mfma_f32_16x16x32_bf16 v[188:191], v[232:235], v[12:15], 0
    s_waitcnt lgkmcnt(4)
    v_mfma_f32_16x16x32_bf16 v[192:195], v[236:239], v[8:11], 0
    ds_read_b128 v[232:235], v1 offset:6144
    s_add_u32 s77, s77, 4096
    buffer_load_dwordx4 a[144:147], v5, s[4:7], s77 offen offset:0 sc1
    v_mfma_f32_16x16x32_bf16 v[196:199], v[236:239], v[12:15], 0
    s_waitcnt lgkmcnt(4)
    v_mfma_f32_16x16x32_bf16 v[200:203], v[240:243], v[8:11], 0
    ds_read_b128 v[236:239], v1 offset:6400
    buffer_load_dwordx4 v[44:47], v5, s[12:15], s73 offen offset:256 sc1
    v_mfma_f32_16x16x32_bf16 v[204:207], v[240:243], v[12:15], 0
    s_waitcnt lgkmcnt(4)
    v_mfma_f32_16x16x32_bf16 v[208:211], v[244:247], v[8:11], 0
    ds_read_b128 v[240:243], v1 offset:7168
    v_max_f32 v136, 0, v136
    v_mfma_f32_16x16x32_bf16 v[212:215], v[244:247], v[12:15], 0
    v_max_f32 v137, 0, v137
    v_max_f32 v138, 0, v138
    s_waitcnt lgkmcnt(4)
    v_mfma_f32_16x16x32_bf16 v[216:219], v[248:251], v[8:11], 0
    ds_read_b128 v[244:247], v1 offset:7424
    buffer_load_dwordx4 a[148:151], v5, s[4:7], s77 offen offset:256 sc1
    v_mfma_f32_16x16x32_bf16 v[220:223], v[248:251], v[12:15], 0
    v_max_f32 v139, 0, v139
    v_max_f32 v140, 0, v140
    v_max_f32 v141, 0, v141
    s_waitcnt lgkmcnt(4)
    v_mfma_f32_16x16x32_bf16 v[224:227], v[252:255], v[8:11], 0
    ds_read_b128 v[248:251], v1 offset:8192
    buffer_load_dwordx4 v[48:51], v5, s[12:15], s73 offen offset:2048 sc1
    v_mfma_f32_16x16x32_bf16 v[228:231], v[252:255], v[12:15], 0
    v_max_f32 v142, 0, v142
    v_max_f32 v143, 0, v143
    v_mul_f32 v136, v136, v144
    s_waitcnt vmcnt(14) lgkmcnt(4)
    v_mfma_f32_16x16x32_bf16 v[184:187], v[232:235], v[16:19], v[184:187]
    ds_read_b128 v[252:255], v1 offset:8448
    v_mul_f32 v137, v137, v145
    v_mfma_f32_16x16x32_bf16 v[188:191], v[232:235], v[20:23], v[188:191]
    v_mul_f32 v138, v138, v146
    v_mul_f32 v139, v139, v147
    s_waitcnt lgkmcnt(4)
    v_mfma_f32_16x16x32_bf16 v[192:195], v[236:239], v[16:19], v[192:195]
    ds_read_b128 v[232:235], v1 offset:12288
    buffer_load_dwordx4 a[152:155], v5, s[4:7], s77 offen offset:2048 sc1
    v_mfma_f32_16x16x32_bf16 v[196:199], v[236:239], v[20:23], v[196:199]
    v_mul_f32 v140, v140, v148
    v_mul_f32 v141, v141, v149
    v_mul_f32 v142, v142, v150
    s_waitcnt lgkmcnt(4)
    v_mfma_f32_16x16x32_bf16 v[200:203], v[240:243], v[16:19], v[200:203]
    ds_read_b128 v[236:239], v1 offset:12544
    buffer_load_dwordx4 v[52:55], v5, s[12:15], s73 offen offset:2304 sc1
    v_mfma_f32_16x16x32_bf16 v[204:207], v[240:243], v[20:23], v[204:207]
    v_mul_f32 v143, v143, v151
    v_cvt_pk_bf16_f32 v136, v136, v137
    v_cvt_pk_bf16_f32 v137, v138, v139
    s_waitcnt lgkmcnt(4)
    v_mfma_f32_16x16x32_bf16 v[208:211], v[244:247], v[16:19], v[208:211]
    ds_read_b128 v[240:243], v1 offset:13312
    v_cvt_pk_bf16_f32 v138, v140, v141
    v_mfma_f32_16x16x32_bf16 v[212:215], v[244:247], v[20:23], v[212:215]
    v_cvt_pk_bf16_f32 v139, v142, v143
    v_permlane16_swap_b32 v136, v138
    s_waitcnt lgkmcnt(4)
    v_mfma_f32_16x16x32_bf16 v[216:219], v[248:251], v[16:19], v[216:219]
    ds_read_b128 v[244:247], v1 offset:13568
    buffer_load_dwordx4 a[156:159], v5, s[4:7], s77 offen offset:2304 sc1
    v_mfma_f32_16x16x32_bf16 v[220:223], v[248:251], v[20:23], v[220:223]
    v_permlane16_swap_b32 v137, v139
    buffer_store_dwordx4 v[136:139], v0, s[92:95], s47 offen offset:0
    v_max_f32 v152, 0, v152
    s_waitcnt lgkmcnt(4)
    v_mfma_f32_16x16x32_bf16 v[224:227], v[252:255], v[16:19], v[224:227]
    ds_read_b128 v[248:251], v1 offset:14336
    s_add_u32 s73, s73, 4096
    buffer_load_dwordx4 v[56:59], v5, s[12:15], s73 offen offset:0 sc1
    v_mfma_f32_16x16x32_bf16 v[228:231], v[252:255], v[20:23], v[228:231]
    v_max_f32 v153, 0, v153
    v_max_f32 v154, 0, v154
    v_max_f32 v155, 0, v155
    s_waitcnt vmcnt(15) lgkmcnt(4)
    v_mfma_f32_16x16x32_bf16 v[184:187], v[232:235], v[24:27], v[184:187]
    ds_read_b128 v[252:255], v1 offset:14592
    v_max_f32 v156, 0, v156
    v_mfma_f32_16x16x32_bf16 v[188:191], v[232:235], v[28:31], v[188:191]
    v_max_f32 v157, 0, v157
    v_max_f32 v158, 0, v158
    s_waitcnt lgkmcnt(4)
    v_mfma_f32_16x16x32_bf16 v[192:195], v[236:239], v[24:27], v[192:195]
    ds_read_b128 v[232:235], v1 offset:18432
    s_add_u32 s77, s77, 4096
    buffer_load_dwordx4 a[160:163], v5, s[4:7], s77 offen offset:0 sc1
    v_mfma_f32_16x16x32_bf16 v[196:199], v[236:239], v[28:31], v[196:199]
    v_max_f32 v159, 0, v159
    v_mul_f32 v152, v152, v160
    v_mul_f32 v153, v153, v161
    s_waitcnt lgkmcnt(4)
    v_mfma_f32_16x16x32_bf16 v[200:203], v[240:243], v[24:27], v[200:203]
    ds_read_b128 v[236:239], v1 offset:18688
    buffer_load_dwordx4 v[60:63], v5, s[12:15], s73 offen offset:256 sc1
    v_mfma_f32_16x16x32_bf16 v[204:207], v[240:243], v[28:31], v[204:207]
    v_mul_f32 v154, v154, v162
    v_mul_f32 v155, v155, v163
    v_mul_f32 v156, v156, v164
    s_waitcnt lgkmcnt(4)
    v_mfma_f32_16x16x32_bf16 v[208:211], v[244:247], v[24:27], v[208:211]
    ds_read_b128 v[240:243], v1 offset:19456
    v_mul_f32 v157, v157, v165
    v_mfma_f32_16x16x32_bf16 v[212:215], v[244:247], v[28:31], v[212:215]
    v_mul_f32 v158, v158, v166
    v_mul_f32 v159, v159, v167
    s_waitcnt lgkmcnt(4)
    v_mfma_f32_16x16x32_bf16 v[216:219], v[248:251], v[24:27], v[216:219]
    ds_read_b128 v[244:247], v1 offset:19712
    buffer_load_dwordx4 a[164:167], v5, s[4:7], s77 offen offset:256 sc1
    v_mfma_f32_16x16x32_bf16 v[220:223], v[248:251], v[28:31], v[220:223]
    v_cvt_pk_bf16_f32 v152, v152, v153
    v_cvt_pk_bf16_f32 v153, v154, v155
    v_cvt_pk_bf16_f32 v154, v156, v157
    s_waitcnt lgkmcnt(4)
    v_mfma_f32_16x16x32_bf16 v[224:227], v[252:255], v[24:27], v[224:227]
    ds_read_b128 v[248:251], v1 offset:20480
    buffer_load_dwordx4 v[64:67], v5, s[12:15], s73 offen offset:2048 sc1
    v_mfma_f32_16x16x32_bf16 v[228:231], v[252:255], v[28:31], v[228:231]
    v_cvt_pk_bf16_f32 v155, v158, v159
    v_permlane16_swap_b32 v152, v154
    s_nop 0
    v_permlane16_swap_b32 v153, v155
    s_waitcnt vmcnt(15) lgkmcnt(4)
    v_mfma_f32_16x16x32_bf16 v[184:187], v[232:235], v[32:35], v[184:187]
    ds_read_b128 v[252:255], v1 offset:20736
    buffer_store_dwordx4 v[152:155], v0, s[92:95], s47 offen offset:1024
    v_mfma_f32_16x16x32_bf16 v[188:191], v[232:235], v[36:39], v[188:191]
    v_max_f32 v168, 0, v168
    v_max_f32 v169, 0, v169
    s_waitcnt lgkmcnt(4)
    v_mfma_f32_16x16x32_bf16 v[192:195], v[236:239], v[32:35], v[192:195]
    ds_read_b128 v[232:235], v1 offset:24576
    buffer_load_dwordx4 a[168:171], v5, s[4:7], s77 offen offset:2048 sc1
    v_mfma_f32_16x16x32_bf16 v[196:199], v[236:239], v[36:39], v[196:199]
    v_max_f32 v170, 0, v170
    v_max_f32 v171, 0, v171
    v_max_f32 v172, 0, v172
    s_waitcnt lgkmcnt(4)
    v_mfma_f32_16x16x32_bf16 v[200:203], v[240:243], v[32:35], v[200:203]
    ds_read_b128 v[236:239], v1 offset:24832
    buffer_load_dwordx4 v[68:71], v5, s[12:15], s73 offen offset:2304 sc1
    v_mfma_f32_16x16x32_bf16 v[204:207], v[240:243], v[36:39], v[204:207]
    v_max_f32 v173, 0, v173
    v_max_f32 v174, 0, v174
    v_max_f32 v175, 0, v175
    s_waitcnt lgkmcnt(4)
    v_mfma_f32_16x16x32_bf16 v[208:211], v[244:247], v[32:35], v[208:211]
    ds_read_b128 v[240:243], v1 offset:25600
    v_mul_f32 v168, v168, v176
    v_mfma_f32_16x16x32_bf16 v[212:215], v[244:247], v[36:39], v[212:215]
    v_mul_f32 v169, v169, v177
    v_mul_f32 v170, v170, v178
    s_waitcnt lgkmcnt(4)
    v_mfma_f32_16x16x32_bf16 v[216:219], v[248:251], v[32:35], v[216:219]
    ds_read_b128 v[244:247], v1 offset:25856
    buffer_load_dwordx4 a[172:175], v5, s[4:7], s77 offen offset:2304 sc1
    v_mfma_f32_16x16x32_bf16 v[220:223], v[248:251], v[36:39], v[220:223]
    v_mul_f32 v171, v171, v179
    v_mul_f32 v172, v172, v180
    v_mul_f32 v173, v173, v181
    s_waitcnt lgkmcnt(4)
    v_mfma_f32_16x16x32_bf16 v[224:227], v[252:255], v[32:35], v[224:227]
    ds_read_b128 v[248:251], v1 offset:26624
    s_add_u32 s73, s73, 4096
    buffer_load_dwordx4 v[72:75], v5, s[12:15], s73 offen offset:0 sc1
    v_mfma_f32_16x16x32_bf16 v[228:231], v[252:255], v[36:39], v[228:231]
    v_mul_f32 v174, v174, v182
    v_mul_f32 v175, v175, v183
    v_cvt_pk_bf16_f32 v168, v168, v169
    s_waitcnt vmcnt(16) lgkmcnt(4)
    v_mfma_f32_16x16x32_bf16 v[184:187], v[232:235], v[40:43], v[184:187]
    ds_read_b128 v[252:255], v1 offset:26880
    v_cvt_pk_bf16_f32 v169, v170, v171
    v_mfma_f32_16x16x32_bf16 v[188:191], v[232:235], v[44:47], v[188:191]
    v_cvt_pk_bf16_f32 v170, v172, v173
    v_cvt_pk_bf16_f32 v171, v174, v175
    s_waitcnt lgkmcnt(4)
    v_mfma_f32_16x16x32_bf16 v[192:195], v[236:239], v[40:43], v[192:195]
    ds_read_b128 v[232:235], v1 offset:30720
    s_add_u32 s77, s77, 4096
    buffer_load_dwordx4 a[176:179], v5, s[4:7], s77 offen offset:0 sc1
    v_mfma_f32_16x16x32_bf16 v[196:199], v[236:239], v[44:47], v[196:199]
    v_permlane16_swap_b32 v168, v170
    v_permlane16_swap_b32 v169, v171
    buffer_store_dwordx4 v[168:171], v0, s[92:95], s47 offen offset:2048
    s_waitcnt lgkmcnt(4)
    v_mfma_f32_16x16x32_bf16 v[200:203], v[240:243], v[40:43], v[200:203]
    ds_read_b128 v[236:239], v1 offset:30976
    buffer_load_dwordx4 v[76:79], v5, s[12:15], s73 offen offset:256 sc1
    v_mfma_f32_16x16x32_bf16 v[204:207], v[240:243], v[44:47], v[204:207]
    s_waitcnt lgkmcnt(4)
    v_mfma_f32_16x16x32_bf16 v[208:211], v[244:247], v[40:43], v[208:211]
    ds_read_b128 v[240:243], v1 offset:31744
    v_mfma_f32_16x16x32_bf16 v[212:215], v[244:247], v[44:47], v[212:215]
    s_waitcnt lgkmcnt(4)
    v_mfma_f32_16x16x32_bf16 v[216:219], v[248:251], v[40:43], v[216:219]
    ds_read_b128 v[244:247], v1 offset:32000
    buffer_load_dwordx4 a[180:183], v5, s[4:7], s77 offen offset:256 sc1
    v_mfma_f32_16x16x32_bf16 v[220:223], v[248:251], v[44:47], v[220:223]
    s_waitcnt lgkmcnt(4)
    v_mfma_f32_16x16x32_bf16 v[224:227], v[252:255], v[40:43], v[224:227]
    ds_read_b128 v[248:251], v1 offset:32768
    buffer_load_dwordx4 v[80:83], v5, s[12:15], s73 offen offset:2048 sc1
    v_mfma_f32_16x16x32_bf16 v[228:231], v[252:255], v[44:47], v[228:231]
    s_waitcnt vmcnt(17) lgkmcnt(4)
    v_mfma_f32_16x16x32_bf16 v[184:187], v[232:235], v[48:51], v[184:187]
    ds_read_b128 v[252:255], v1 offset:33024
    v_mfma_f32_16x16x32_bf16 v[188:191], v[232:235], v[52:55], v[188:191]
    s_waitcnt lgkmcnt(4)
    v_mfma_f32_16x16x32_bf16 v[192:195], v[236:239], v[48:51], v[192:195]
    ds_read_b128 v[232:235], v1 offset:36864
    buffer_load_dwordx4 a[184:187], v5, s[4:7], s77 offen offset:2048 sc1
    v_mfma_f32_16x16x32_bf16 v[196:199], v[236:239], v[52:55], v[196:199]
    s_waitcnt lgkmcnt(4)
    v_mfma_f32_16x16x32_bf16 v[200:203], v[240:243], v[48:51], v[200:203]
    ds_read_b128 v[236:239], v1 offset:37120
    buffer_load_dwordx4 v[84:87], v5, s[12:15], s73 offen offset:2304 sc1
    v_mfma_f32_16x16x32_bf16 v[204:207], v[240:243], v[52:55], v[204:207]
    s_waitcnt lgkmcnt(4)
    v_mfma_f32_16x16x32_bf16 v[208:211], v[244:247], v[48:51], v[208:211]
    ds_read_b128 v[240:243], v1 offset:37888
    v_mfma_f32_16x16x32_bf16 v[212:215], v[244:247], v[52:55], v[212:215]
    s_waitcnt lgkmcnt(4)
    v_mfma_f32_16x16x32_bf16 v[216:219], v[248:251], v[48:51], v[216:219]
    ds_read_b128 v[244:247], v1 offset:38144
    buffer_load_dwordx4 a[188:191], v5, s[4:7], s77 offen offset:2304 sc1
    v_mfma_f32_16x16x32_bf16 v[220:223], v[248:251], v[52:55], v[220:223]
    s_waitcnt lgkmcnt(4)
    v_mfma_f32_16x16x32_bf16 v[224:227], v[252:255], v[48:51], v[224:227]
    ds_read_b128 v[248:251], v1 offset:38912
    s_add_u32 s73, s73, 4096
    buffer_load_dwordx4 v[88:91], v5, s[12:15], s73 offen offset:0 sc1
    v_mfma_f32_16x16x32_bf16 v[228:231], v[252:255], v[52:55], v[228:231]
    s_waitcnt vmcnt(16) lgkmcnt(4)
    v_mfma_f32_16x16x32_bf16 v[184:187], v[232:235], v[56:59], v[184:187]
    ds_read_b128 v[252:255], v1 offset:39168
    s_waitcnt vmcnt(7)
    s_mov_b64 exec, 2
    s_cmp_eq_u32 s24, 0
    s_cbranch_scc1 Limp_30
    buffer_store_byte v3, off, s[4:7], s48
Lfl_31:
    s_mov_b64 exec, -1
    v_mfma_f32_16x16x32_bf16 v[188:191], v[232:235], v[60:63], v[188:191]
    s_waitcnt lgkmcnt(4)
    v_mfma_f32_16x16x32_bf16 v[192:195], v[236:239], v[56:59], v[192:195]
    ds_read_b128 v[232:235], v1 offset:43008
    s_add_u32 s77, s77, 4096
    buffer_load_dwordx4 a[192:195], v5, s[4:7], s77 offen offset:0 sc1
    v_mfma_f32_16x16x32_bf16 v[196:199], v[236:239], v[60:63], v[196:199]
    s_waitcnt lgkmcnt(4)
    v_mfma_f32_16x16x32_bf16 v[200:203], v[240:243], v[56:59], v[200:203]
    ds_read_b128 v[236:239], v1 offset:43264
    buffer_load_dwordx4 v[92:95], v5, s[12:15], s73 offen offset:256 sc1
    v_mfma_f32_16x16x32_bf16 v[204:207], v[240:243], v[60:63], v[204:207]
    s_waitcnt lgkmcnt(4)
    v_mfma_f32_16x16x32_bf16 v[208:211], v[244:247], v[56:59], v[208:211]
    ds_read_b128 v[240:243], v1 offset:44032
    v_mfma_f32_16x16x32_bf16 v[212:215], v[244:247], v[60:63], v[212:215]
    s_waitcnt lgkmcnt(4)
    v_mfma_f32_16x16x32_bf16 v[216:219], v[248:251], v[56:59], v[216:219]
    ds_read_b128 v[244:247], v1 offset:44288
    buffer_load_dwordx4 a[196:199], v5, s[4:7], s77 offen offset:256 sc1
    v_mfma_f32_16x16x32_bf16 v[220:223], v[248:251], v[60:63], v[220:223]
    s_waitcnt lgkmcnt(4)
    v_mfma_f32_16x16x32_bf16 v[224:227], v[252:255], v[56:59], v[224:227]
    ds_read_b128 v[248:251], v1 offset:45056
    buffer_load_dwordx4 v[96:99], v5, s[12:15], s73 offen offset:2048 sc1
    v_mfma_f32_16x16x32_bf16 v[228:231], v[252:255], v[60:63], v[228:231]
    s_waitcnt lgkmcnt(4)
    v_mfma_f32_16x16x32_bf16 v[184:187], v[232:235], v[64:67], v[184:187]
    ds_read_b128 v[252:255], v1 offset:45312
    v_mfma_f32_16x16x32_bf16 v[188:191], v[232:235], v[68:71], v[188:191]
    s_waitcnt lgkmcnt(4)
    v_mfma_f32_16x16x32_bf16 v[192:195], v[236:239], v[64:67], v[192:195]
    ds_read_b128 v[232:235], v2 offset:0
    buffer_load_dwordx4 a[200:203], v5, s[4:7], s77 offen offset:2048 sc1
    v_mfma_f32_16x16x32_bf16 v[196:199], v[236:239], v[68:71], v[196:199]
    s_waitcnt lgkmcnt(4)
    v_mfma_f32_16x16x32_bf16 v[200:203], v[240:243], v[64:67], v[200:203]
    ds_read_b128 v[236:239], v2 offset:256
    buffer_load_dwordx4 v[100:103], v5, s[12:15], s73 offen offset:2304 sc1
    v_mfma_f32_16x16x32_bf16 v[204:207], v[240:243], v[68:71], v[204:207]
    s_waitcnt lgkmcnt(4)
    v_mfma_f32_16x16x32_bf16 v[208:211], v[244:247], v[64:67], v[208:211]
    ds_read_b128 v[240:243], v2 offset:1024
    v_mfma_f32_16x16x32_bf16 v[212:215], v[244:247], v[68:71], v[212:215]
IT_5:
    s_cbranch_execz IT_9
    s_waitcnt lgkmcnt(4)
    v_mfma_f32_16x16x32_bf16 v[216:219], v[248:251], v[64:67], v[216:219]
    ds_read_b128 v[244:247], v2 offset:1280
    buffer_load_dwordx4 a[204:207], v5, s[4:7], s77 offen offset:2304 sc1
    v_mfma_f32_16x16x32_bf16 v[220:223], v[248:251], v[68:71], v[220:223]
    s_waitcnt lgkmcnt(4)
    v_mfma_f32_16x16x32_bf16 v[224:227], v[252:255], v[64:67], v[224:227]
    ds_read_b128 v[248:251], v2 offset:2048
    s_add_u32 s73, s73, 4096
    buffer_load_dwordx4 v[104:107], v5, s[12:15], s73 offen offset:0 sc1
    v_mfma_f32_16x16x32_bf16 v[228:231], v[252:255], v[68:71], v[228:231]
    s_waitcnt vmcnt(15) lgkmcnt(4)
    v_mfma_f32_16x16x32_bf16 v[184:187], v[232:235], v[72:75], v[184:187]
    ds_read_b128 v[252:255], v2 offset:2304
    v_mfma_f32_16x16x32_bf16 v[188:191], v[232:235], v[76:79], v[188:191]
    s_waitcnt lgkmcnt(4)
    v_mfma_f32_16x16x32_bf16 v[192:195], v[236:239], v[72:75], v[192:195]
    ds_read_b128 v[232:235], v2 offset:6144
    s_add_u32 s77, s77, 4096
    buffer_load_dwordx4 a[208:211], v5, s[4:7], s77 offen offset:0 sc1
    v_mfma_f32_16x16x32_bf16 v[196:199], v[236:239], v[76:79], v[196:199]
    s_waitcnt lgkmcnt(4)
    v_mfma_f32_16x16x32_bf16 v[200:203], v[240:243], v[72:75], v[200:203]
    ds_read_b128 v[236:239], v2 offset:6400
    buffer_load_dwordx4 v[108:111], v5, s[12:15], s73 offen offset:256 sc1
    v_mfma_f32_16x16x32_bf16 v[204:207], v[240:243], v[76:79], v[204:207]
    s_waitcnt lgkmcnt(4)
    v_mfma_f32_16x16x32_bf16 v[208:211], v[244:247], v[72:75], v[208:211]
    ds_read_b128 v[240:243], v2 offset:7168
    buffer_load_ubyte v4, v6, s[4:7], s58 offen sc1
    v_mfma_f32_16x16x32_bf16 v[212:215], v[244:247], v[76:79], v[212:215]
    s_waitcnt lgkmcnt(4)
    v_mfma_f32_16x16x32_bf16 v[216:219], v[248:251], v[72:75], v[216:219]
    ds_read_b128 v[244:247], v2 offset:7424
    buffer_load_dwordx4 a[212:215], v5, s[4:7], s77 offen offset:256 sc1
    v_mfma_f32_16x16x32_bf16 v[220:223], v[248:251], v[76:79], v[220:223]
    s_waitcnt lgkmcnt(4)
    v_mfma_f32_16x16x32_bf16 v[224:227], v[252:255], v[72:75], v[224:227]
    ds_read_b128 v[248:251], v2 offset:8192
    buffer_load_dwordx4 v[112:115], v5, s[12:15], s73 offen offset:2048 sc1
    v_mfma_f32_16x16x32_bf16 v[228:231], v[252:255], v[76:79], v[228:231]
    s_waitcnt vmcnt(16) lgkmcnt(4)
    v_mfma_f32_16x16x32_bf16 v[184:187], v[232:235], v[80:83], v[184:187]
    ds_read_b128 v[252:255], v2 offset:8448
    v_mfma_f32_16x16x32_bf16 v[188:191], v[232:235], v[84:87], v[188:191]
    s_waitcnt lgkmcnt(4)
    v_mfma_f32_16x16x32_bf16 v[192:195], v[236:239], v[80:83], v[192:195]
    ds_read_b128 v[232:235], v2 offset:12288
    buffer_load_dwordx4 a[216:219], v5, s[4:7], s77 offen offset:2048 sc1
    v_mfma_f32_16x16x32_bf16 v[196:199], v[236:239], v[84:87], v[196:199]
    s_waitcnt lgkmcnt(4)
    v_mfma_f32_16x16x32_bf16 v[200:203], v[240:243], v[80:83], v[200:203]
    ds_read_b128 v[236:239], v2 offset:12544
    buffer_load_dwordx4 v[116:119], v5, s[12:15], s73 offen offset:2304 sc1
    v_mfma_f32_16x16x32_bf16 v[204:207], v[240:243], v[84:87], v[204:207]
    s_waitcnt lgkmcnt(4)
    v_mfma_f32_16x16x32_bf16 v[208:211], v[244:247], v[80:83], v[208:211]
    ds_read_b128 v[240:243], v2 offset:13312
    v_mfma_f32_16x16x32_bf16 v[212:215], v[244:247], v[84:87], v[212:215]
    s_waitcnt lgkmcnt(4)
    v_mfma_f32_16x16x32_bf16 v[216:219], v[248:251], v[80:83], v[216:219]
    ds_read_b128 v[244:247], v2 offset:13568
    buffer_load_dwordx4 a[220:223], v5, s[4:7], s77 offen offset:2304 sc1
    v_mfma_f32_16x16x32_bf16 v[220:223], v[248:251], v[84:87], v[220:223]
    s_waitcnt lgkmcnt(4)
    v_mfma_f32_16x16x32_bf16 v[224:227], v[252:255], v[80:83], v[224:227]
    ds_read_b128 v[248:251], v2 offset:14336
    s_add_u32 s73, s73, 4096
    buffer_load_dwordx4 v[120:123], v5, s[12:15], s73 offen offset:0 sc1
    v_mfma_f32_16x16x32_bf16 v[228:231], v[252:255], v[84:87], v[228:231]
    s_waitcnt vmcnt(15) lgkmcnt(4)
    v_mfma_f32_16x16x32_bf16 v[184:187], v[232:235], v[88:91], v[184:187]
    ds_read_b128 v[252:255], v2 offset:14592
    v_mfma_f32_16x16x32_bf16 v[188:191], v[232:235], v[92:95], v[188:191]
    s_waitcnt lgkmcnt(4)
    v_mfma_f32_16x16x32_bf16 v[192:195], v[236:239], v[88:91], v[192:195]
    ds_read_b128 v[232:235], v2 offset:18432
    s_add_u32 s77, s77, 4096
    buffer_load_dwordx4 a[224:227], v5, s[4:7], s77 offen offset:0 sc1
    v_mfma_f32_16x16x32_bf16 v[196:199], v[236:239], v[92:95], v[196:199]
    s_waitcnt lgkmcnt(4)
    v_mfma_f32_16x16x32_bf16 v[200:203], v[240:243], v[88:91], v[200:203]
    ds_read_b128 v[236:239], v2 offset:18688
    buffer_load_dwordx4 v[124:127], v5, s[12:15], s73 offen offset:256 sc1
    v_mfma_f32_16x16x32_bf16 v[204:207], v[240:243], v[92:95], v[204:207]
    s_waitcnt lgkmcnt(4)
    v_mfma_f32_16x16x32_bf16 v[208:211], v[244:247], v[88:91], v[208:211]
    ds_read_b128 v[240:243], v2 offset:19456
    v_mfma_f32_16x16x32_bf16 v[212:215], v[244:247], v[92:95], v[212:215]
    s_waitcnt lgkmcnt(4)
    v_mfma_f32_16x16x32_bf16 v[216:219], v[248:251], v[88:91], v[216:219]
    ds_read_b128 v[244:247], v2 offset:19712
    buffer_load_dwordx4 a[228:231], v5, s[4:7], s77 offen offset:256 sc1
    v_mfma_f32_16x16x32_bf16 v[220:223], v[248:251], v[92:95], v[220:223]
    s_waitcnt lgkmcnt(4)
    v_mfma_f32_16x16x32_bf16 v[224:227], v[252:255], v[88:91], v[224:227]
    ds_read_b128 v[248:251], v2 offset:20480
    buffer_load_dwordx4 v[128:131], v5, s[12:15], s73 offen offset:2048 sc1
    v_mfma_f32_16x16x32_bf16 v[228:231], v[252:255], v[92:95], v[228:231]
    s_waitcnt vmcnt(15) lgkmcnt(4)
    v_mfma_f32_16x16x32_bf16 v[184:187], v[232:235], v[96:99], v[184:187]
    ds_read_b128 v[252:255], v2 offset:20736
    s_waitcnt vmcnt(10)
    v_cmp_gt_u32 vcc, 1, v4
    s_nop 0
    s_and_b64 vcc, vcc, s[54:55]
    s_cbranch_vccnz Lspin_32
Lspin_32_r:
    s_cmp_eq_u32 s24, 0
    s_cbranch_scc1 Linv_34
Lok_33:
    v_mfma_f32_16x16x32_bf16 v[188:191], v[232:235], v[100:103], v[188:191]
    s_waitcnt lgkmcnt(4)
    v_mfma_f32_16x16x32_bf16 v[192:195], v[236:239], v[96:99], v[192:195]
    ds_read_b128 v[232:235], v2 offset:24576
    buffer_load_dwordx4 a[232:235], v5, s[4:7], s77 offen offset:2048 sc1
    v_mfma_f32_16x16x32_bf16 v[196:199], v[236:239], v[100:103], v[196:199]
    s_waitcnt lgkmcnt(4)
    v_mfma_f32_16x16x32_bf16 v[200:203], v[240:243], v[96:99], v[200:203]
    ds_read_b128 v[236:239], v2 offset:24832
    buffer_load_dwordx4 v[132:135], v5, s[12:15], s73 offen offset:2304 sc1
    v_mfma_f32_16x16x32_bf16 v[204:207], v[240:243], v[100:103], v[204:207]
    s_waitcnt lgkmcnt(4)
    v_mfma_f32_16x16x32_bf16 v[208:211], v[244:247], v[96:99], v[208:211]
    ds_read_b128 v[240:243], v2 offset:25600
    buffer_load_dwordx4 v[8:11], v5, s[4:7], s74 offen offset:0 sc1
    v_mfma_f32_16x16x32_bf16 v[212:215], v[244:247], v[100:103], v[212:215]
    s_waitcnt lgkmcnt(4)
    v_mfma_f32_16x16x32_bf16 v[216:219], v[248:251], v[96:99], v[216:219]
    ds_read_b128 v[244:247], v2 offset:25856
    v_mfma_f32_16x16x32_bf16 v[220:223], v[248:251], v[100:103], v[220:223]
    s_waitcnt lgkmcnt(4)
    v_mfma_f32_16x16x32_bf16 v[224:227], v[252:255], v[96:99], v[224:227]
    ds_read_b128 v[248:251], v2 offset:26624
    buffer_load_dwordx4 v[12:15], v5, s[4:7], s74 offen offset:256 sc1
    v_mfma_f32_16x16x32_bf16 v[228:231], v[252:255], v[100:103], v[228:231]
    s_waitcnt lgkmcnt(4)
    v_mfma_f32_16x16x32_bf16 v[184:187], v[232:235], v[104:107], v[184:187]
    ds_read_b128 v[252:255], v2 offset:26880
    buffer_load_dwordx4 v[16:19], v5, s[4:7], s74 offen offset:2048 sc1
    v_mfma_f32_16x16x32_bf16 v[188:191], v[232:235], v[108:111], v[188:191]
    s_waitcnt lgkmcnt(4)
    v_mfma_f32_16x16x32_bf16 v[192:195], v[236:239], v[104:107], v[192:195]
    ds_read_b128 v[232:235], v2 offset:30720
    v_mfma_f32_16x16x32_bf16 v[196:199], v[236:239], v[108:111], v[196:199]
    s_waitcnt lgkmcnt(4)
    v_mfma_f32_16x16x32_bf16 v[200:203], v[240:243], v[104:107], v[200:203]
    ds_read_b128 v[236:239], v2 offset:30976
    buffer_load_dwordx4 v[20:23], v5, s[4:7], s74 offen offset:2304 sc1
    v_mfma_f32_16x16x32_bf16 v[204:207], v[240:243], v[108:111], v[204:207]
    s_waitcnt lgkmcnt(4)
    v_mfma_f32_16x16x32_bf16 v[208:211], v[244:247], v[104:107], v[208:211]
    ds_read_b128 v[240:243], v2 offset:31744
    s_add_u32 s74, s74, 4096
    buffer_load_dwordx4 v[24:27], v5, s[4:7], s74 offen offset:0 sc1
    v_mfma_f32_16x16x32_bf16 v[212:215], v[244:247], v[108:111], v[212:215]
    s_waitcnt lgkmcnt(4)
    v_mfma_f32_16x16x32_bf16 v[216:219], v[248:251], v[104:107], v[216:219]
    ds_read_b128 v[244:247], v2 offset:32000
    v_mfma_f32_16x16x32_bf16 v[220:223], v[248:251], v[108:111], v[220:223]
    s_waitcnt lgkmcnt(4)
    v_mfma_f32_16x16x32_bf16 v[224:227], v[252:255], v[104:107], v[224:227]
    ds_read_b128 v[248:251], v2 offset:32768
    buffer_load_dwordx4 v[28:31], v5, s[4:7], s74 offen offset:256 sc1
    v_mfma_f32_16x16x32_bf16 v[228:231], v[252:255], v[108:111], v[228:231]
    s_waitcnt vmcnt(14) lgkmcnt(4)
    v_mfma_f32_16x16x32_bf16 v[184:187], v[232:235], v[112:115], v[184:187]
    ds_read_b128 v[252:255], v2 offset:33024
    buffer_load_dwordx4 v[32:35], v5, s[4:7], s74 offen offset:2048 sc1
    v_mfma_f32_16x16x32_bf16 v[188:191], v[232:235], v[116:119], v[188:191]
    s_waitcnt lgkmcnt(4)
    v_mfma_f32_16x16x32_bf16 v[192:195], v[236:239], v[112:115], v[192:195]
    ds_read_b128 v[232:235], v2 offset:36864
    v_mfma_f32_16x16x32_bf16 v[196:199], v[236:239], v[116:119], v[196:199]
    s_waitcnt lgkmcnt(4)
    v_mfma_f32_16x16x32_bf16 v[200:203], v[240:243], v[112:115], v[200:203]
    ds_read_b128 v[236:239], v2 offset:37120
    buffer_load_dwordx4 v[36:39], v5, s[4:7], s74 offen offset:2304 sc1
    v_mfma_f32_16x16x32_bf16 v[204:207], v[240:243], v[116:119], v[204:207]
    s_waitcnt lgkmcnt(4)
    v_mfma_f32_16x16x32_bf16 v[208:211], v[244:247], v[112:115], v[208:211]
    ds_read_b128 v[240:243], v2 offset:43008
    v_and_b32 v136, 0x70, v0
    v_bfe_u32 v137, v0, 7, 1
    v_lshl_add_u32 v136, v137, 9, v136
    v_bfe_u32 v137, v0, 8, 1
    v_lshl_add_u32 v136, v137, 13, v136
    v_lshrrev_b32 v137, 9, v0
    v_lshl_add_u32 v136, v137, 10, v136
    buffer_load_dwordx4 v[168:171], v136, s[4:7], s59 offen sc1
    v_mfma_f32_16x16x32_bf16 v[212:215], v[244:247], v[116:119], v[212:215]
    s_waitcnt lgkmcnt(4)
    v_mfma_f32_16x16x32_bf16 v[216:219], v[248:251], v[112:115], v[216:219]
    ds_read_b128 v[244:247], v2 offset:43264
    v_mfma_f32_16x16x32_bf16 v[220:223], v[248:251], v[116:119], v[220:223]
    s_waitcnt lgkmcnt(4)
    v_mfma_f32_16x16x32_bf16 v[224:227], v[252:255], v[112:115], v[224:227]
    ds_read_b128 v[248:251], v2 offset:37888
    s_add_u32 s74, s74, 4096
    buffer_load_dwordx4 v[40:43], v5, s[4:7], s74 offen offset:0 sc1
    v_mfma_f32_16x16x32_bf16 v[228:231], v[252:255], v[116:119], v[228:231]
    s_waitcnt vmcnt(14) lgkmcnt(4)
    v_mfma_f32_16x16x32_bf16 v[184:187], v[232:235], v[120:123], v[184:187]
    ds_read_b128 v[252:255], v2 offset:38144
    buffer_load_dwordx4 v[44:47], v5, s[4:7], s74 offen offset:256 sc1
    v_mfma_f32_16x16x32_bf16 v[188:191], v[232:235], v[124:127], v[188:191]
    s_waitcnt lgkmcnt(4)
    v_mfma_f32_16x16x32_bf16 v[192:195], v[236:239], v[120:123], v[192:195]
    ds_read_b128 v[232:235], v2 offset:44032
    v_mfma_f32_16x16x32_bf16 v[196:199], v[236:239], v[124:127], v[196:199]
    s_waitcnt vmcnt(11) lgkmcnt(4)
    v_mfma_f32_16x16x32_bf16 v[184:187], v[240:243], v[128:131], v[184:187]
    ds_read_b128 v[236:239], v2 offset:44288
    buffer_load_dwordx4 v[48:51], v5, s[4:7], s74 offen offset:2048 sc1
    v_mfma_f32_16x16x32_bf16 v[188:191], v[240:243], v[132:135], v[188:191]
    s_waitcnt lgkmcnt(4)
    v_mfma_f32_16x16x32_bf16 v[192:195], v[244:247], v[128:131], v[192:195]
    ds_read_b128 v[240:243], v2 offset:38912
    s_add_u32 s47, s47, 360448
    v_mfma_f32_16x16x32_bf16 v[196:199], v[244:247], v[132:135], v[196:199]
    buffer_load_dwordx4 v[52:55], v5, s[4:7], s74 offen offset:2304 sc1
    s_waitcnt lgkmcnt(4)
    v_mfma_f32_16x16x32_bf16 v[200:203], v[248:251], v[120:123], v[200:203]
    ds_read_b128 v[244:247], v2 offset:39168
    v_mfma_f32_16x16x32_bf16 v[204:207], v[248:251], v[124:127], v[204:207]
    s_waitcnt lgkmcnt(4)
    v_mfma_f32_16x16x32_bf16 v[208:211], v[252:255], v[120:123], v[208:211]
    ds_read_b128 v[248:251], v2 offset:45056
    s_add_u32 s74, s74, 4096
    buffer_load_dwordx4 v[56:59], v5, s[4:7], s74 offen offset:0 sc1
    v_mfma_f32_16x16x32_bf16 v[212:215], v[252:255], v[124:127], v[212:215]
    v_max_f32 v184, 0, v184
    v_max_f32 v185, 0, v185
    v_max_f32 v186, 0, v186
    v_max_f32 v187, 0, v187
    s_waitcnt lgkmcnt(4)
    v_mfma_f32_16x16x32_bf16 v[200:203], v[232:235], v[128:131], v[200:203]
    ds_read_b128 v[252:255], v2 offset:45312
    buffer_load_dwordx4 v[60:63], v5, s[4:7], s74 offen offset:256 sc1
    v_mfma_f32_16x16x32_bf16 v[204:207], v[232:235], v[132:135], v[204:207]
    v_max_f32 v188, 0, v188
    v_max_f32 v189, 0, v189
    v_max_f32 v190, 0, v190
    v_max_f32 v191, 0, v191
    s_waitcnt lgkmcnt(4)
    v_mfma_f32_16x16x32_bf16 v[208:211], v[236:239], v[128:131], v[208:211]
    v_mul_f32 v184, v184, v192
    v_mul_f32 v185, v185, v193
    v_mfma_f32_16x16x32_bf16 v[212:215], v[236:239], v[132:135], v[212:215]
    v_mul_f32 v186, v186, v194
    v_mul_f32 v187, v187, v195
    s_waitcnt lgkmcnt(3)
    v_mfma_f32_16x16x32_bf16 v[216:219], v[240:243], v[120:123], v[216:219]
    buffer_load_dwordx4 v[64:67], v5, s[4:7], s74 offen offset:2048 sc1
    v_mul_f32 v188, v188, v196
    v_mfma_f32_16x16x32_bf16 v[220:223], v[240:243], v[124:127], v[220:223]
    v_mul_f32 v189, v189, v197
    v_mul_f32 v190, v190, v198
    v_mul_f32 v191, v191, v199
    s_waitcnt lgkmcnt(2)
    v_mfma_f32_16x16x32_bf16 v[224:227], v[244:247], v[120:123], v[224:227]
    buffer_load_dwordx4 v[68:71], v5, s[4:7], s74 offen offset:2304 sc1
    v_cvt_pk_bf16_f32 v184, v184, v185
    v_mfma_f32_16x16x32_bf16 v[228:231], v[244:247], v[124:127], v[228:231]
    v_cvt_pk_bf16_f32 v185, v186, v187
    v_cvt_pk_bf16_f32 v186, v188, v189
    v_cvt_pk_bf16_f32 v187, v190, v191
    s_waitcnt lgkmcnt(1)
    v_mfma_f32_16x16x32_bf16 v[216:219], v[248:251], v[128:131], v[216:219]
    v_permlane16_swap_b32 v184, v186
    v_permlane16_swap_b32 v185, v187
    v_mfma_f32_16x16x32_bf16 v[220:223], v[248:251], v[132:135], v[220:223]
    buffer_store_dwordx4 v[184:187], v0, s[92:95], s47 offen offset:0
    v_max_f32 v200, 0, v200
    s_waitcnt lgkmcnt(0)
    v_mfma_f32_16x16x32_bf16 v[224:227], v[252:255], v[128:131], v[224:227]
    s_add_u32 s74, s74, 4096
    buffer_load_dwordx4 v[72:75], v5, s[4:7], s74 offen offset:0 sc1
    v_mfma_f32_16x16x32_bf16 v[228:231], v[252:255], v[132:135], v[228:231]
    v_max_f32 v201, 0, v201
    v_max_f32 v202, 0, v202
    v_max_f32 v203, 0, v203
    v_max_f32 v204, 0, v204
Lp4_21:
    s_add_u32 s48, s48, 512
    s_add_u32 s58, s58, 512
    s_mov_b32 s55, 0
    s_waitcnt vmcnt(17)
    v_mfma_f32_16x16x32_bf16 v[136:139], a[64:67], v[8:11], 0
    v_max_f32 v205, 0, v205
    v_max_f32 v206, 0, v206
    v_mfma_f32_16x16x32_bf16 v[140:143], a[64:67], v[12:15], 0
    v_max_f32 v207, 0, v207
    v_mul_f32 v200, v200, v208
    v_mfma_f32_16x16x32_bf16 v[152:155], a[72:75], v[8:11], 0
    v_mul_f32 v201, v201, v209
    v_mul_f32 v202, v202, v210
    v_mfma_f32_16x16x32_bf16 v[156:159], a[72:75], v[12:15], 0
    v_mul_f32 v203, v203, v211
    v_mul_f32 v204, v204, v212
    v_mfma_f32_16x16x32_bf16 v[144:147], a[68:71], v[8:11], 0
    v_mul_f32 v205, v205, v213
    v_mul_f32 v206, v206, v214
    v_mfma_f32_16x16x32_bf16 v[148:151], a[68:71], v[12:15], 0
    v_mul_f32 v207, v207, v215
    v_cvt_pk_bf16_f32 v200, v200, v201
    v_mfma_f32_16x16x32_bf16 v[160:163], a[76:79], v[8:11], 0
    v_cvt_pk_bf16_f32 v201, v202, v203
    v_cvt_pk_bf16_f32 v202, v204, v205
    v_mfma_f32_16x16x32_bf16 v[164:167], a[76:79], v[12:15], 0
    v_cvt_pk_bf16_f32 v203, v206, v207
    v_permlane16_swap_b32 v200, v202
    s_waitcnt vmcnt(15)
    v_mfma_f32_16x16x32_bf16 v[136:139], a[80:83], v[16:19], v[136:139]
    v_permlane16_swap_b32 v201, v203
    buffer_store_dwordx4 v[200:203], v0, s[92:95], s47 offen offset:1024
    v_mfma_f32_16x16x32_bf16 v[140:143], a[80:83], v[20:23], v[140:143]
    v_max_f32 v216, 0, v216
    v_max_f32 v217, 0, v217
    v_mfma_f32_16x16x32_bf16 v[152:155], a[88:91], v[16:19], v[152:155]
    v_max_f32 v218, 0, v218
    v_max_f32 v219, 0, v219
    v_mfma_f32_16x16x32_bf16 v[156:159], a[88:91], v[20:23], v[156:159]
    v_max_f32 v220, 0, v220
    v_max_f32 v221, 0, v221
    v_mfma_f32_16x16x32_bf16 v[144:147], a[84:87], v[16:19], v[144:147]
    v_max_f32 v222, 0, v222
    v_max_f32 v223, 0, v223
    v_mfma_f32_16x16x32_bf16 v[148:151], a[84:87], v[20:23], v[148:151]
    v_mul_f32 v216, v216, v224
    v_mul_f32 v217, v217, v225
    v_mfma_f32_16x16x32_bf16 v[160:163], a[92:95], v[16:19], v[160:163]
    v_mul_f32 v218, v218, v226
    v_mul_f32 v219, v219, v227
    v_mfma_f32_16x16x32_bf16 v[164:167], a[92:95], v[20:23], v[164:167]
    v_mul_f32 v220, v220, v228
    v_mul_f32 v221, v221, v229
    s_waitcnt vmcnt(14)
    v_mfma_f32_16x16x32_bf16 v[136:139], a[96:99], v[24:27], v[136:139]
    v_mul_f32 v222, v222, v230
    v_mul_f32 v223, v223, v231
    v_mfma_f32_16x16x32_bf16 v[140:143], a[96:99], v[28:31], v[140:143]
    v_cvt_pk_bf16_f32 v216, v216, v217
    v_cvt_pk_bf16_f32 v217, v218, v219
    v_mfma_f32_16x16x32_bf16 v[152:155], a[104:107], v[24:27], v[152:155]
    v_cvt_pk_bf16_f32 v218, v220, v221
    v_cvt_pk_bf16_f32 v219, v222, v223
    v_mfma_f32_16x16x32_bf16 v[156:159], a[104:107], v[28:31], v[156:159]
    v_permlane16_swap_b32 v216, v218
    v_permlane16_swap_b32 v217, v219
    v_mfma_f32_16x16x32_bf16 v[144:147], a[100:103], v[24:27], v[144:147]
    buffer_store_dwordx4 v[216:219], v0, s[92:95], s47 offen offset:2048
    v_mfma_f32_16x16x32_bf16 v[148:151], a[100:103], v[28:31], v[148:151]
    v_mfma_f32_16x16x32_bf16 v[160:163], a[108:111], v[24:27], v[160:163]
    buffer_load_dwordx4 a[236:239], v5, s[4:7], s77 offen offset:2304 sc1
    v_bfe_u32 v253, v0, 8, 1
    v_mfma_f32_16x16x32_bf16 v[164:167], a[108:111], v[28:31], v[164:167]
    v_and_b32 v248, 0xf0, v0
    v_lshlrev_b32 v249, 7, v253
    s_waitcnt vmcnt(14)
    v_mfma_f32_16x16x32_bf16 v[136:139], a[112:115], v[32:35], v[136:139]
    buffer_load_dwordx4 v[76:79], v5, s[4:7], s74 offen offset:256 sc1
    v_xor_b32 v248, v248, v249
    v_mfma_f32_16x16x32_bf16 v[140:143], a[112:115], v[36:39], v[140:143]
    v_lshl_add_u32 v248, v253, 10, v248
    v_lshrrev_b32 v253, 9, v0
    v_mfma_f32_16x16x32_bf16 v[152:155], a[120:123], v[32:35], v[152:155]
    s_add_u32 m0, s79, 0
    s_nop 0
    buffer_load_dwordx4 v0, s[4:7], s78 offen sc1 lds
    v_mfma_f32_16x16x32_bf16 v[156:159], a[120:123], v[36:39], v[156:159]
    v_lshl_add_u32 v248, v253, 9, v248
    s_lshl_b32 s30, s3, 13
    s_add_u32 s30, s30, 131072
    s_waitcnt vmcnt(3)
    s_mov_b64 exec, 2
    s_cmp_eq_u32 s24, 0
    s_cbranch_scc1 Limp_42
    buffer_store_byte v3, off, s[4:7], s48
Lfl_43:
    s_mov_b64 exec, -1
    v_mfma_f32_16x16x32_bf16 v[144:147], a[116:119], v[32:35], v[144:147]
    buffer_load_dwordx4 v[80:83], v5, s[4:7], s74 offen offset:2048 sc1
    v_add_u32 v248, s30, v248
    v_mfma_f32_16x16x32_bf16 v[148:151], a[116:119], v[36:39], v[148:151]
    v_and_b32 v250, 0x70, v0
    s_lshl_b32 s30, s3, 7
    v_mfma_f32_16x16x32_bf16 v[160:163], a[124:127], v[32:35], v[160:163]
    s_add_u32 m0, s79, 4096
    s_add_u32 s78, s78, 4096
    buffer_load_dwordx4 v0, s[4:7], s78 offen sc1 lds
    v_mfma_f32_16x16x32_bf16 v[164:167], a[124:127], v[36:39], v[164:167]
    v_add_u32 v250, s30, v250
    v_lshl_add_u32 v251, v253, 10, v250
    v_and_b32 v249, 0x80, v0
    v_mfma_f32_16x16x32_bf16 v[136:139], a[128:131], v[40:43], v[136:139]
    buffer_load_dwordx4 v[84:87], v5, s[4:7], s74 offen offset:2304 sc1
    v_xor_b32 v249, v249, v250
    v_mfma_f32_16x16x32_bf16 v[140:143], a[128:131], v[44:47], v[140:143]
    v_lshrrev_b32 v253, 7, v0
    v_lshl_add_u32 v249, v253, 10, v249
    v_mfma_f32_16x16x32_bf16 v[152:155], a[136:139], v[40:43], v[152:155]
    s_add_u32 m0, s79, 8192
    s_add_u32 s78, s78, 4096
    buffer_load_dwordx4 v0, s[4:7], s78 offen sc1 lds
    v_mfma_f32_16x16x32_bf16 v[156:159], a[136:139], v[44:47], v[156:159]
    v_add_u32 v249, 131072, v249
    v_lshl_add_u32 v250, v253, 9, v250
    v_add_u32 v1, 0x10000, v0
    v_mfma_f32_16x16x32_bf16 v[144:147], a[132:135], v[40:43], v[144:147]
    s_add_u32 s74, s74, 4096
    buffer_load_dwordx4 v[88:91], v5, s[4:7], s74 offen offset:0 sc1
    v_mfma_f32_16x16x32_bf16 v[148:151], a[132:135], v[44:47], v[148:151]
    v_add_u32 v2, 0x20000, v0
    v_add_f32 v168, v168, v169
    v_mfma_f32_16x16x32_bf16 v[160:163], a[140:143], v[40:43], v[160:163]
    s_add_u32 m0, s79, 12288
    s_add_u32 s78, s78, 4096
    buffer_load_dwordx4 v0, s[4:7], s78 offen sc1 lds
    v_mfma_f32_16x16x32_bf16 v[164:167], a[140:143], v[44:47], v[164:167]
    v_add_f32 v170, v170, v171
    v_add_f32 v168, v168, v170
    v_mul_f32 v168, 0x3b000000, v168
    buffer_load_ubyte v4, v3, s[4:7], s58 offen sc1
    v_mfma_f32_16x16x32_bf16 v[136:139], a[144:147], v[48:51], v[136:139]
    buffer_load_dwordx4 v[92:95], v5, s[4:7], s74 offen offset:256 sc1
    v_add_f32 v168, v168, v168 row_ror:8 row_mask:0xf bank_mask:0xf
    v_mfma_f32_16x16x32_bf16 v[140:143], a[144:147], v[52:55], v[140:143]
    v_mov_b32 v169, v168
    s_nop 1
    v_permlane32_swap_b32 v168, v169
    v_mfma_f32_16x16x32_bf16 v[152:155], a[152:155], v[48:51], v[152:155]
    s_add_u32 m0, s79, 16384
    s_add_u32 s78, s78, 4096
    buffer_load_dwordx4 v0, s[4:7], s78 offen sc1 lds
    v_mfma_f32_16x16x32_bf16 v[156:159], a[152:155], v[52:55], v[156:159]
    v_fma_f32 v168, -v168, v168, v169
    v_max_f32 v168, 0, v168
    v_add_f32 v168, 0x3727c5ac, v168
    v_mfma_f32_16x16x32_bf16 v[144:147], a[148:151], v[48:51], v[144:147]
    s_add_u32 m0, s79, 20480
    s_add_u32 s78, s78, 4096
    buffer_load_dwordx4 v0, s[4:7], s78 offen sc1 lds
    v_mfma_f32_16x16x32_bf16 v[148:151], a[148:151], v[52:55], v[148:151]
    v_rcp_f32 v254, v168
    v_rcp_f32 v255, v168
    s_nop 0
    v_mfma_f32_16x16x32_bf16 v[160:163], a[156:159], v[48:51], v[160:163]
    s_add_u32 m0, s79, 24576
    s_add_u32 s78, s78, 4096
    buffer_load_dwordx4 v0, s[4:7], s78 offen sc1 lds
    v_mfma_f32_16x16x32_bf16 v[164:167], a[156:159], v[52:55], v[164:167]
    v_permlane16_swap_b32 v254, v255
    s_lshl_b32 s42, s26, 15
    s_lshl_b32 s31, s23, 12
    v_mfma_f32_16x16x32_bf16 v[136:139], a[160:163], v[56:59], v[136:139]
    s_add_u32 m0, s79, 28672
    s_add_u32 s78, s78, 4096
    buffer_load_dwordx4 v0, s[4:7], s78 offen sc1 lds
    v_mfma_f32_16x16x32_bf16 v[140:143], a[160:163], v[60:63], v[140:143]
    s_add_u32 s42, s42, s31
    s_lshl_b32 s43, s26, 7
    s_lshl_b32 s31, s23, 2
    v_mfma_f32_16x16x32_bf16 v[152:155], a[168:171], v[56:59], v[152:155]
    s_add_u32 s43, s43, s31
    s_add_u32 s43, s43, s3
    v_mfma_f32_16x16x32_bf16 v[156:159], a[168:171], v[60:63], v[156:159]
    s_add_u32 s43, s43, 16515168
    v_mfma_f32_16x16x32_bf16 v[144:147], a[164:167], v[56:59], v[144:147]
    s_lshl_b32 s45, s26, 11
    s_add_u32 s45, s45, s31
    v_mfma_f32_16x16x32_bf16 v[148:151], a[164:167], v[60:63], v[148:151]
    s_lshr_b32 s31, s23, 2
    v_mfma_f32_16x16x32_bf16 v[160:163], a[172:175], v[56:59], v[160:163]
    s_mul_i32 s31, s31, 496
    s_add_u32 s45, s45, s31
    v_mfma_f32_16x16x32_bf16 v[164:167], a[172:175], v[60:63], v[164:167]
    s_add_u32 s45, s45, 8126464
    s_waitcnt vmcnt(5)
    v_cmp_gt_u32 vcc, 1, v4
    s_nop 0
    s_and_b64 vcc, vcc, s[54:55]
    s_cbranch_vccz Lspin_44_r
Lspin_44:
    buffer_load_ubyte v4, v3, s[4:7], s58 offen sc1
    s_sub_u32 s60, s60, 1
    s_cbranch_scc1 K1_fail
    s_waitcnt vmcnt(0)
    v_cmp_gt_u32 vcc, 1, v4
    s_nop 0
    s_and_b64 vcc, vcc, s[54:55]
    s_cbranch_vccnz Lspin_44
Lspin_44_r:
    s_cmp_eq_u32 s24, 0
    s_cbranch_scc1 Linv_46
Lok_45:
    buffer_load_dwordx4 v[96:99], v5, s[4:7], s75 offen offset:0 sc1
    buffer_load_dwordx4 v[100:103], v5, s[4:7], s75 offen offset:256 sc1
    buffer_load_dwordx4 v[104:107], v5, s[4:7], s75 offen offset:2048 sc1
    buffer_load_dwordx4 v[108:111], v5, s[4:7], s75 offen offset:2304 sc1
    v_mfma_f32_16x16x32_bf16 v[136:139], a[176:179], v[64:67], v[136:139]
    s_add_u32 s75, s75, 4096
    buffer_load_dwordx4 v[112:115], v5, s[4:7], s75 offen offset:0 sc1
    v_mfma_f32_16x16x32_bf16 v[140:143], a[176:179], v[68:71], v[140:143]
    v_mfma_f32_16x16x32_bf16 v[152:155], a[184:187], v[64:67], v[152:155]
    v_mfma_f32_16x16x32_bf16 v[156:159], a[184:187], v[68:71], v[156:159]
    v_mfma_f32_16x16x32_bf16 v[144:147], a[180:183], v[64:67], v[144:147]
    buffer_load_dwordx4 v[116:119], v5, s[4:7], s75 offen offset:256 sc1
    v_mfma_f32_16x16x32_bf16 v[148:151], a[180:183], v[68:71], v[148:151]
    v_mfma_f32_16x16x32_bf16 v[160:163], a[188:191], v[64:67], v[160:163]
    v_mfma_f32_16x16x32_bf16 v[164:167], a[188:191], v[68:71], v[164:167]
    v_mfma_f32_16x16x32_bf16 v[136:139], a[192:195], v[72:75], v[136:139]
    buffer_load_dwordx4 v[120:123], v5, s[4:7], s75 offen offset:2048 sc1
    v_mfma_f32_16x16x32_bf16 v[140:143], a[192:195], v[76:79], v[140:143]
    v_mfma_f32_16x16x32_bf16 v[152:155], a[200:203], v[72:75], v[152:155]
    v_mfma_f32_16x16x32_bf16 v[156:159], a[200:203], v[76:79], v[156:159]
    v_mfma_f32_16x16x32_bf16 v[144:147], a[196:199], v[72:75], v[144:147]
    buffer_load_dwordx4 v[124:127], v5, s[4:7], s75 offen offset:2304 sc1
    v_mfma_f32_16x16x32_bf16 v[148:151], a[196:199], v[76:79], v[148:151]
    v_mfma_f32_16x16x32_bf16 v[160:163], a[204:207], v[72:75], v[160:163]
    v_mfma_f32_16x16x32_bf16 v[164:167], a[204:207], v[76:79], v[164:167]
    v_mfma_f32_16x16x32_bf16 v[136:139], a[208:211], v[80:83], v[136:139]
    s_add_u32 s75, s75, 4096
    buffer_load_dwordx4 v[128:131], v5, s[4:7], s75 offen offset:0 sc1
    v_mfma_f32_16x16x32_bf16 v[140:143], a[208:211], v[84:87], v[140:143]
    v_mfma_f32_16x16x32_bf16 v[152:155], a[216:219], v[80:83], v[152:155]
    v_mfma_f32_16x16x32_bf16 v[156:159], a[216:219], v[84:87], v[156:159]
    v_mfma_f32_16x16x32_bf16 v[144:147], a[212:215], v[80:83], v[144:147]
    buffer_load_dwordx4 v[132:135], v5, s[4:7], s75 offen offset:256 sc1
    v_mfma_f32_16x16x32_bf16 v[148:151], a[212:215], v[84:87], v[148:151]
    v_mfma_f32_16x16x32_bf16 v[160:163], a[220:223], v[80:83], v[160:163]
    v_mfma_f32_16x16x32_bf16 v[164:167], a[220:223], v[84:87], v[164:167]
    s_cmp_eq_u32 s3, 3
    s_cbranch_scc1 Lk3_41
    s_waitcnt vmcnt(14)
    v_mfma_f32_16x16x32_bf16 v[152:155], a[232:235], v[88:91], v[152:155]
    v_mfma_f32_16x16x32_bf16 v[156:159], a[232:235], v[92:95], v[156:159]
    v_mfma_f32_16x16x32_bf16 v[136:139], a[224:227], v[88:91], v[136:139]
    v_mfma_f32_16x16x32_bf16 v[140:143], a[224:227], v[92:95], v[140:143]
    v_mfma_f32_16x16x32_bf16 v[160:163], a[236:239], v[88:91], v[160:163]
    v_mfma_f32_16x16x32_bf16 v[164:167], a[236:239], v[92:95], v[164:167]
    v_mfma_f32_16x16x32_bf16 v[144:147], a[228:231], v[88:91], v[144:147]
    v_mfma_f32_16x16x32_bf16 v[148:151], a[228:231], v[92:95], v[148:151]
Lk3_41:
    buffer_load_dwordx4 v[184:187], v5, s[4:7], s75 offen offset:2048 sc1
    buffer_load_dwordx4 v[188:191], v5, s[4:7], s75 offen offset:2304 sc1
    s_barrier
    ds_write_b128 v248, v[136:139] offset:0
    v_accvgpr_read_b32 v72, a240
    v_accvgpr_read_b32 v73, a241
    ds_write_b128 v248, v[140:143] offset:256
    v_accvgpr_read_b32 v74, a242
    v_accvgpr_read_b32 v75, a243
    ds_write_b128 v248, v[144:147] offset:2048
    v_accvgpr_read_b32 v76, a244
    v_accvgpr_read_b32 v77, a245
    ds_write_b128 v248, v[148:151] offset:2304
    v_accvgpr_read_b32 v78, a246
    v_accvgpr_read_b32 v79, a247
    s_waitcnt vmcnt(10)
    v_mfma_f32_16x16x32_bf16 v[168:171], a[64:67], v[96:99], 0
    s_add_u32 s75, s75, 4096
    buffer_load_dwordx4 v[192:195], v5, s[4:7], s75 offen offset:0 sc1
    v_mfma_f32_16x16x32_bf16 v[172:175], a[64:67], v[100:103], 0
    v_mfma_f32_16x16x32_bf16 v[232:235], a[72:75], v[96:99], 0
    ds_write_b128 v248, v[152:155] offset:4096
    v_accvgpr_read_b32 v80, a248
    v_mfma_f32_16x16x32_bf16 v[236:239], a[72:75], v[100:103], 0
    v_accvgpr_read_b32 v81, a249
    v_mfma_f32_16x16x32_bf16 v[176:179], a[68:71], v[96:99], 0
    buffer_load_dwordx4 v[196:199], v5, s[4:7], s75 offen offset:256 sc1
    v_mfma_f32_16x16x32_bf16 v[180:183], a[68:71], v[100:103], 0
    v_mfma_f32_16x16x32_bf16 v[240:243], a[76:79], v[96:99], 0
    ds_write_b128 v248, v[156:159] offset:4352
    v_accvgpr_read_b32 v82, a250
    v_mfma_f32_16x16x32_bf16 v[244:247], a[76:79], v[100:103], 0
    v_accvgpr_read_b32 v83, a251
    s_waitcnt vmcnt(10)
    v_mfma_f32_16x16x32_bf16 v[168:171], a[80:83], v[104:107], v[168:171]
    buffer_load_dwordx4 v[200:203], v5, s[4:7], s75 offen offset:2048 sc1
    v_mfma_f32_16x16x32_bf16 v[172:175], a[80:83], v[108:111], v[172:175]
    v_mfma_f32_16x16x32_bf16 v[232:235], a[88:91], v[104:107], v[232:235]
    ds_write_b128 v248, v[160:163] offset:6144
    v_accvgpr_read_b32 v84, a252
    v_mfma_f32_16x16x32_bf16 v[236:239], a[88:91], v[108:111], v[236:239]
    v_accvgpr_read_b32 v85, a253
    v_mfma_f32_16x16x32_bf16 v[176:179], a[84:87], v[104:107], v[176:179]
    buffer_load_dwordx4 v[204:207], v5, s[4:7], s75 offen offset:2304 sc1
    v_mfma_f32_16x16x32_bf16 v[180:183], a[84:87], v[108:111], v[180:183]
    v_mfma_f32_16x16x32_bf16 v[240:243], a[92:95], v[104:107], v[240:243]
    ds_write_b128 v248, v[164:167] offset:6400
    v_accvgpr_read_b32 v86, a254
    v_mfma_f32_16x16x32_bf16 v[244:247], a[92:95], v[108:111], v[244:247]
    v_accvgpr_read_b32 v87, a255
    s_waitcnt vmcnt(10)
    v_mfma_f32_16x16x32_bf16 v[168:171], a[96:99], v[112:115], v[168:171]
    s_add_u32 s75, s75, 4096
    buffer_load_dwordx4 v[208:211], v5, s[4:7], s75 offen offset:0 sc1
    v_mfma_f32_16x16x32_bf16 v[172:175], a[96:99], v[116:119], v[172:175]
    v_mfma_f32_16x16x32_bf16 v[232:235], a[104:107], v[112:115], v[232:235]
    s_waitcnt lgkmcnt(0)
    s_barrier
    ds_read_b128 v[8:11], v249 offset:0
    ds_read_b128 v[12:15], v249 offset:512
    ds_read_b128 v[16:19], v249 offset:8192
    ds_read_b128 v[20:23], v249 offset:8704
    ds_read_b128 v[24:27], v249 offset:16384
    ds_read_b128 v[28:31], v249 offset:16896
IT_6:
    s_cbranch_execz IT_10
    ds_read_b128 v[32:35], v249 offset:24576
    ds_read_b128 v[36:39], v249 offset:25088
    v_mfma_f32_16x16x32_bf16 v[236:239], a[104:107], v[116:119], v[236:239]
    v_mfma_f32_16x16x32_bf16 v[176:179], a[100:103], v[112:115], v[176:179]
    buffer_load_dwordx4 v[212:215], v5, s[4:7], s75 offen offset:256 sc1
    v_mfma_f32_16x16x32_bf16 v[180:183], a[100:103], v[116:119], v[180:183]
    v_mfma_f32_16x16x32_bf16 v[240:243], a[108:111], v[112:115], v[240:243]
    v_mfma_f32_16x16x32_bf16 v[244:247], a[108:111], v[116:119], v[244:247]
    s_waitcnt vmcnt(10)
    v_mfma_f32_16x16x32_bf16 v[168:171], a[112:115], v[120:123], v[168:171]
    buffer_load_dwordx4 v[216:219], v5, s[4:7], s75 offen offset:2048 sc1
    s_waitcnt lgkmcnt(4)
    v_mfma_f32_16x16x32_bf16 v[172:175], a[112:115], v[124:127], v[172:175]
    v_add_f32 v8, v8, v16
    v_add_f32 v9, v9, v17
    v_mfma_f32_16x16x32_bf16 v[232:235], a[120:123], v[120:123], v[232:235]
    v_add_f32 v10, v10, v18
    v_add_f32 v11, v11, v19
    v_mfma_f32_16x16x32_bf16 v[236:239], a[120:123], v[124:127], v[236:239]
    v_add_f32 v12, v12, v20
    v_mfma_f32_16x16x32_bf16 v[176:179], a[116:119], v[120:123], v[176:179]
    buffer_load_dwordx4 v[220:223], v5, s[4:7], s75 offen offset:2304 sc1
    v_add_f32 v13, v13, v21
    v_mfma_f32_16x16x32_bf16 v[180:183], a[116:119], v[124:127], v[180:183]
    v_add_f32 v14, v14, v22
    v_add_f32 v15, v15, v23
    v_mfma_f32_16x16x32_bf16 v[240:243], a[124:127], v[120:123], v[240:243]
    s_waitcnt lgkmcnt(0)
    v_add_f32 v24, v24, v32
    v_mfma_f32_16x16x32_bf16 v[244:247], a[124:127], v[124:127], v[244:247]
    v_add_f32 v25, v25, v33
    s_waitcnt vmcnt(10)
    v_mfma_f32_16x16x32_bf16 v[168:171], a[128:131], v[128:131], v[168:171]
    s_add_u32 s75, s75, 4096
    buffer_load_dwordx4 v[224:227], v5, s[4:7], s75 offen offset:0 sc1
    v_mfma_f32_16x16x32_bf16 v[172:175], a[128:131], v[132:135], v[172:175]
    v_add_f32 v26, v26, v34
    v_add_f32 v27, v27, v35
    v_add_f32 v28, v28, v36
    v_mfma_f32_16x16x32_bf16 v[232:235], a[136:139], v[128:131], v[232:235]
    v_add_f32 v29, v29, v37
    v_add_f32 v30, v30, v38
    v_mfma_f32_16x16x32_bf16 v[236:239], a[136:139], v[132:135], v[236:239]
    v_add_f32 v31, v31, v39
    v_mfma_f32_16x16x32_bf16 v[176:179], a[132:135], v[128:131], v[176:179]
    buffer_load_dwordx4 v[228:231], v5, s[4:7], s75 offen offset:256 sc1
    v_add_f32 v8, v8, v24
    v_mfma_f32_16x16x32_bf16 v[180:183], a[132:135], v[132:135], v[180:183]
    v_add_f32 v9, v9, v25
    v_add_f32 v10, v10, v26
    v_mfma_f32_16x16x32_bf16 v[240:243], a[140:143], v[128:131], v[240:243]
    v_add_f32 v11, v11, v27
    v_add_f32 v12, v12, v28
    v_mfma_f32_16x16x32_bf16 v[244:247], a[140:143], v[132:135], v[244:247]
    v_add_f32 v13, v13, v29
    s_waitcnt vmcnt(10)
    v_mfma_f32_16x16x32_bf16 v[168:171], a[144:147], v[184:187], v[168:171]
    buffer_load_dwordx4 v[40:43], v0, s[4:7], s51 offen offset:0 sc1
    v_add_f32 v14, v14, v30
    v_mfma_f32_16x16x32_bf16 v[172:175], a[144:147], v[188:191], v[172:175]
    v_add_f32 v15, v15, v31
    v_fma_f32 v72, v8, v254, v72
    v_mfma_f32_16x16x32_bf16 v[232:235], a[152:155], v[184:187], v[232:235]
    v_fma_f32 v73, v9, v254, v73
    v_fma_f32 v74, v10, v254, v74
    v_mfma_f32_16x16x32_bf16 v[236:239], a[152:155], v[188:191], v[236:239]
    v_fma_f32 v75, v11, v254, v75
    v_mfma_f32_16x16x32_bf16 v[176:179], a[148:151], v[184:187], v[176:179]
    s_add_u32 s51, s51, 4096
    buffer_load_dwordx4 v[44:47], v0, s[4:7], s51 offen offset:0 sc1
    v_mfma_f32_16x16x32_bf16 v[180:183], a[148:151], v[188:191], v[180:183]
    v_fma_f32 v76, v12, v254, v76
    v_fma_f32 v77, v13, v254, v77
    v_fma_f32 v78, v14, v254, v78
    v_mfma_f32_16x16x32_bf16 v[240:243], a[156:159], v[184:187], v[240:243]
    v_fma_f32 v79, v15, v254, v79
    v_cvt_pk_bf16_f32 v8, v72, v73
    v_mfma_f32_16x16x32_bf16 v[244:247], a[156:159], v[188:191], v[244:247]
    v_cvt_pk_bf16_f32 v9, v74, v75
    s_waitcnt vmcnt(10)
    v_mfma_f32_16x16x32_bf16 v[168:171], a[160:163], v[192:195], v[168:171]
    s_add_u32 s51, s51, 4096
    buffer_load_dwordx4 v[48:51], v0, s[4:7], s51 offen offset:0 sc1
    v_mfma_f32_16x16x32_bf16 v[172:175], a[160:163], v[196:199], v[172:175]
    v_cvt_pk_bf16_f32 v10, v76, v77
    v_cvt_pk_bf16_f32 v11, v78, v79
    s_barrier
    v_mfma_f32_16x16x32_bf16 v[232:235], a[168:171], v[192:195], v[232:235]
    s_add_u32 s51, s51, 4096
    buffer_load_dwordx4 v[52:55], v0, s[4:7], s51 offen offset:0 sc1
    v_mfma_f32_16x16x32_bf16 v[236:239], a[168:171], v[196:199], v[236:239]
    buffer_store_dwordx4 v[8:11], v250, s[12:15], s42 offen
    v_add_f32 v16, v72, v74
    v_add_f32 v17, v73, v75
    v_mfma_f32_16x16x32_bf16 v[176:179], a[164:167], v[192:195], v[176:179]
    s_add_u32 s51, s51, 4096
    buffer_load_dwordx4 v[56:59], v0, s[4:7], s51 offen offset:0 sc1
    v_mfma_f32_16x16x32_bf16 v[180:183], a[164:167], v[196:199], v[180:183]
    v_mul_f32 v18, v72, v72
    v_mul_f32 v19, v73, v73
    v_add_f32 v16, v16, v76
    v_mfma_f32_16x16x32_bf16 v[240:243], a[172:175], v[192:195], v[240:243]
    s_add_u32 s51, s51, 4096
    buffer_load_dwordx4 v[60:63], v0, s[4:7], s51 offen offset:0 sc1
    v_mfma_f32_16x16x32_bf16 v[244:247], a[172:175], v[196:199], v[244:247]
    v_add_f32 v17, v17, v77
    v_fma_f32 v18, v74, v74, v18
    v_fma_f32 v19, v75, v75, v19
    s_waitcnt vmcnt(13)
    v_mfma_f32_16x16x32_bf16 v[168:171], a[176:179], v[200:203], v[168:171]
    s_add_u32 s51, s51, 4096
    buffer_load_dwordx4 v[64:67], v0, s[4:7], s51 offen offset:0 sc1
    v_mfma_f32_16x16x32_bf16 v[172:175], a[176:179], v[204:207], v[172:175]
    v_add_f32 v16, v16, v78
    v_add_f32 v17, v17, v79
    v_fma_f32 v18, v76, v76, v18
    v_mfma_f32_16x16x32_bf16 v[232:235], a[184:187], v[200:203], v[232:235]
    s_add_u32 s51, s51, 4096
    buffer_load_dwordx4 v[68:71], v0, s[4:7], s51 offen offset:0 sc1
    v_mfma_f32_16x16x32_bf16 v[236:239], a[184:187], v[204:207], v[236:239]
    v_fma_f32 v19, v77, v77, v19
    v_add_f32 v16, v16, v17
    v_fma_f32 v18, v78, v78, v18
    v_mfma_f32_16x16x32_bf16 v[176:179], a[180:183], v[200:203], v[176:179]
    v_fma_f32 v19, v79, v79, v19
    v_add_f32 v18, v18, v19
    v_mfma_f32_16x16x32_bf16 v[180:183], a[180:183], v[204:207], v[180:183]
    s_nop 0
    v_permlane32_swap_b32 v16, v18
    v_mfma_f32_16x16x32_bf16 v[240:243], a[188:191], v[200:203], v[240:243]
    v_add_f32 v16, v16, v18
    s_nop 1
    v_add_f32 v16, v16, v16 row_ror:8 row_mask:0xf bank_mask:0xf
    v_mfma_f32_16x16x32_bf16 v[244:247], a[188:191], v[204:207], v[244:247]
    v_mov_b32 v17, v16
    s_waitcnt vmcnt(13)
    v_mfma_f32_16x16x32_bf16 v[168:171], a[192:195], v[208:211], v[168:171]
    v_permlane16_swap_b32 v16, v17
    v_add_f32 v16, v16, v17
    v_mfma_f32_16x16x32_bf16 v[172:175], a[192:195], v[212:215], v[172:175]
    s_mov_b32 exec_lo, 0xff
    s_mov_b32 exec_hi, 0xff
    buffer_store_dword v16, v251, s[4:7], s45 offen
    s_mov_b64 exec, -1
    v_mfma_f32_16x16x32_bf16 v[176:179], a[196:199], v[208:211], v[176:179]
    v_mfma_f32_16x16x32_bf16 v[180:183], a[196:199], v[212:215], v[180:183]
    s_waitcnt vmcnt(12)
    v_mfma_f32_16x16x32_bf16 v[168:171], a[208:211], v[216:219], v[168:171]
    v_mfma_f32_16x16x32_bf16 v[172:175], a[208:211], v[220:223], v[172:175]
    v_mfma_f32_16x16x32_bf16 v[176:179], a[212:215], v[216:219], v[176:179]
    v_mfma_f32_16x16x32_bf16 v[180:183], a[212:215], v[220:223], v[180:183]
    s_waitcnt vmcnt(0)
    s_mov_b64 exec, 2
    s_cmp_eq_u32 s24, 0
    s_cbranch_scc1 Limp_48
    buffer_store_byte v3, off, s[4:7], s43
Lfl_49:
    s_mov_b64 exec, -1
    s_cmp_eq_u32 s3, 3
    s_cbranch_scc1 Lk3_47
    v_mfma_f32_16x16x32_bf16 v[232:235], a[232:235], v[224:227], v[232:235]
    v_mfma_f32_16x16x32_bf16 v[236:239], a[232:235], v[228:231], v[236:239]
    v_mfma_f32_16x16x32_bf16 v[168:171], a[224:227], v[224:227], v[168:171]
    v_mfma_f32_16x16x32_bf16 v[172:175], a[224:227], v[228:231], v[172:175]
    v_mfma_f32_16x16x32_bf16 v[240:243], a[236:239], v[224:227], v[240:243]
    v_mfma_f32_16x16x32_bf16 v[244:247], a[236:239], v[228:231], v[244:247]
    v_mfma_f32_16x16x32_bf16 v[176:179], a[228:231], v[224:227], v[176:179]
    v_mfma_f32_16x16x32_bf16 v[180:183], a[228:231], v[228:231], v[180:183]
Lk3_47:
    v_mfma_f32_16x16x32_bf16 v[232:235], a[200:203], v[208:211], v[232:235]
    s_add_u32 s42, s42, 131072
    s_add_u32 s45, s45, 8192
    v_mfma_f32_16x16x32_bf16 v[236:239], a[200:203], v[212:215], v[236:239]
    v_mfma_f32_16x16x32_bf16 v[240:243], a[204:207], v[208:211], v[240:243]
    s_add_u32 s43, s43, 512
    ds_write_b128 v248, v[168:171] offset:0
    v_mfma_f32_16x16x32_bf16 v[244:247], a[204:207], v[212:215], v[244:247]
    v_mfma_f32_16x16x32_bf16 v[232:235], a[216:219], v[216:219], v[232:235]
    ds_write_b128 v248, v[172:175] offset:256
    v_mfma_f32_16x16x32_bf16 v[236:239], a[216:219], v[220:223], v[236:239]
    v_mfma_f32_16x16x32_bf16 v[240:243], a[220:223], v[216:219], v[240:243]
    ds_write_b128 v248, v[176:179] offset:2048
    v_mfma_f32_16x16x32_bf16 v[244:247], a[220:223], v[220:223], v[244:247]
    ds_write_b128 v248, v[180:183] offset:2304
    s_nop 1
    ds_write_b128 v248, v[232:235] offset:4096
    s_nop 0
    ds_write_b128 v248, v[236:239] offset:4352
    ds_write_b128 v248, v[240:243] offset:6144
    s_nop 0
    ds_write_b128 v248, v[244:247] offset:6400
    s_waitcnt lgkmcnt(0)
    s_barrier
    ds_read_b128 v[8:11], v249 offset:0
    ds_read_b128 v[12:15], v249 offset:512
    ds_read_b128 v[16:19], v249 offset:8192
    ds_read_b128 v[20:23], v249 offset:8704
    ds_read_b128 v[24:27], v249 offset:16384
    ds_read_b128 v[28:31], v249 offset:16896
    ds_read_b128 v[32:35], v249 offset:24576
    ds_read_b128 v[36:39], v249 offset:25088
    s_waitcnt lgkmcnt(4)
    v_pk_add_f32 v[8:9], v[8:9], v[16:17]
    v_pk_add_f32 v[10:11], v[10:11], v[18:19]
    v_pk_add_f32 v[12:13], v[12:13], v[20:21]
    v_pk_add_f32 v[14:15], v[14:15], v[22:23]
    s_waitcnt lgkmcnt(0)
    v_pk_add_f32 v[24:25], v[24:25], v[32:33]
    v_pk_add_f32 v[26:27], v[26:27], v[34:35]
    v_pk_add_f32 v[28:29], v[28:29], v[36:37]
    v_pk_add_f32 v[30:31], v[30:31], v[38:39]
    v_pk_add_f32 v[8:9], v[8:9], v[24:25]
    v_pk_add_f32 v[10:11], v[10:11], v[26:27]
    v_pk_add_f32 v[12:13], v[12:13], v[28:29]
    v_pk_add_f32 v[14:15], v[14:15], v[30:31]
    v_pk_fma_f32 v[80:81], v[8:9], v[254:255], v[80:81] op_sel:[0,1,0] op_sel_hi:[1,1,1]
    v_pk_fma_f32 v[82:83], v[10:11], v[254:255], v[82:83] op_sel:[0,1,0] op_sel_hi:[1,1,1]
    v_pk_fma_f32 v[84:85], v[12:13], v[254:255], v[84:85] op_sel:[0,1,0] op_sel_hi:[1,1,1]
    v_pk_fma_f32 v[86:87], v[14:15], v[254:255], v[86:87] op_sel:[0,1,0] op_sel_hi:[1,1,1]
    v_cvt_pk_bf16_f32 v8, v80, v81
    v_cvt_pk_bf16_f32 v9, v82, v83
    v_cvt_pk_bf16_f32 v10, v84, v85
    v_cvt_pk_bf16_f32 v11, v86, v87
    buffer_store_dwordx4 v[8:11], v250, s[12:15], s42 offen
    v_pk_add_f32 v[16:17], v[80:81], v[82:83]
    v_pk_mul_f32 v[18:19], v[80:81], v[80:81]
    v_pk_add_f32 v[16:17], v[16:17], v[84:85]
    v_pk_fma_f32 v[18:19], v[82:83], v[82:83], v[18:19]
    v_pk_add_f32 v[16:17], v[16:17], v[86:87]
    v_pk_fma_f32 v[18:19], v[84:85], v[84:85], v[18:19]
    v_add_f32 v16, v16, v17
    v_pk_fma_f32 v[18:19], v[86:87], v[86:87], v[18:19]
    v_add_f32 v18, v18, v19
    s_nop 1
    v_permlane32_swap_b32 v16, v18
    v_add_f32 v16, v16, v18
    s_nop 1
    v_add_f32 v16, v16, v16 row_ror:8 row_mask:0xf bank_mask:0xf
    v_mov_b32 v17, v16
    s_nop 1
    v_permlane16_swap_b32 v16, v17
    v_add_f32 v16, v16, v17
    s_mov_b32 exec_lo, 0xff
    s_mov_b32 exec_hi, 0xff
    buffer_store_dword v16, v251, s[4:7], s45 offen
    s_mov_b64 exec, -1
    s_barrier
    v_add_u32 v6, s28, v2
    s_lshl_b32 s44, s25, 7
    s_add_u32 s44, s44, 16515168
    ds_write_b128 v6, v[40:43] offset:0
    ds_write_b128 v6, v[44:47] offset:4096
    v_accvgpr_write_b32 a240, v72
    v_accvgpr_write_b32 a241, v73
    v_accvgpr_write_b32 a242, v74
    v_accvgpr_write_b32 a243, v75
    v_accvgpr_write_b32 a244, v76
    v_accvgpr_write_b32 a245, v77
    v_accvgpr_write_b32 a246, v78
    v_accvgpr_write_b32 a247, v79
    v_accvgpr_write_b32 a248, v80
    v_accvgpr_write_b32 a249, v81
    v_accvgpr_write_b32 a250, v82
    v_accvgpr_write_b32 a251, v83
    v_accvgpr_write_b32 a252, v84
    v_accvgpr_write_b32 a253, v85
    v_accvgpr_write_b32 a254, v86
    v_accvgpr_write_b32 a255, v87
    s_waitcnt vmcnt(0)
    s_mov_b64 exec, 2
    s_cmp_eq_u32 s24, 0
    s_cbranch_scc1 Limp_50
    buffer_store_byte v3, off, s[4:7], s43
Lfl_51:
    s_mov_b64 exec, -1
    buffer_load_ubyte v4, v3, s[4:7], s44 offen sc1
    ds_write_b128 v6, v[48:51] offset:8192
    ds_write_b128 v6, v[52:55] offset:12288
    ds_write_b128 v6, v[56:59] offset:16384
    ds_write_b128 v6, v[60:63] offset:20480
    ds_write_b128 v6, v[64:67] offset:24576
    ds_write_b128 v6, v[68:71] offset:28672
    s_lshl_b32 s42, s25, 15
    s_lshl_b32 s43, s25, 11
    s_add_u32 s43, s43, 8126464
    v_lshrrev_b32 v217, 9, v0
    v_lshl_add_u32 v217, v217, 9, v0
    s_add_u32 s98, s98, 655360
    s_add_u32 s99, s99, 655360
    s_add_u32 s101, s101, 655360
    s_add_u32 s82, s82, 655360
    s_waitcnt vmcnt(0)
    v_cmp_gt_u32 vcc, 1, v4
    s_nop 0
    s_cbranch_vccz Lspin_52_r
Lspin_52:
    buffer_load_ubyte v4, v3, s[4:7], s44 offen sc1
    s_sub_u32 s60, s60, 1
    s_cbranch_scc1 K1_fail
    s_waitcnt vmcnt(0)
    v_cmp_gt_u32 vcc, 1, v4
    s_nop 0
    s_cbranch_vccnz Lspin_52
Lspin_52_r:
    s_cmp_eq_u32 s24, 0
    s_cbranch_scc1 Linv_54
Lok_53:
    buffer_load_dwordx4 v[8:11], v0, s[12:15], s42 offen offset:0 sc1
    buffer_load_dwordx4 v[12:15], v0, s[12:15], s42 offen offset:1024 sc1
    buffer_load_dwordx4 v[16:19], v0, s[12:15], s42 offen offset:2048 sc1
    buffer_load_dwordx4 v[20:23], v0, s[12:15], s42 offen offset:3072 sc1
    s_add_u32 s42, s42, 4096
    buffer_load_dwordx4 v[24:27], v0, s[12:15], s42 offen offset:0 sc1
    buffer_load_dwordx4 v[28:31], v0, s[12:15], s42 offen offset:1024 sc1
    buffer_load_dwordx4 v[32:35], v0, s[12:15], s42 offen offset:2048 sc1
    buffer_load_dwordx4 v[36:39], v0, s[12:15], s42 offen offset:3072 sc1
    s_waitcnt lgkmcnt(0)
    s_add_u32 s42, s42, 4096
    buffer_load_dwordx4 v[40:43], v0, s[12:15], s42 offen offset:0 sc1
    buffer_load_dwordx4 v[44:47], v0, s[12:15], s42 offen offset:1024 sc1
    buffer_load_dwordx4 v[48:51], v0, s[12:15], s42 offen offset:2048 sc1
    buffer_load_dwordx4 v[52:55], v0, s[12:15], s42 offen offset:3072 sc1
    s_barrier
    ds_read_b128 v[232:235], v1 offset:32768
    ds_read_b128 v[236:239], v2 offset:0
    ds_read_b128 v[240:243], v1 offset:33792
    ds_read_b128 v[244:247], v2 offset:1024
    ds_read_b128 v[248:251], v1 offset:34816
    ds_read_b128 v[252:255], v2 offset:2048
    s_waitcnt vmcnt(11) lgkmcnt(5)
    v_mfma_f32_32x32x16_bf16 v[136:151], v[232:235], v[8:11], 0
    s_add_u32 s42, s42, 4096
    buffer_load_dwordx4 v[56:59], v0, s[12:15], s42 offen offset:0 sc1
    ds_read_b128 v[232:235], v1 offset:35840
    s_waitcnt lgkmcnt(5)
    v_mfma_f32_32x32x16_bf16 v[152:167], v[236:239], v[8:11], 0
    ds_read_b128 v[236:239], v2 offset:3072
    s_waitcnt vmcnt(11) lgkmcnt(5)
    v_mfma_f32_32x32x16_bf16 v[136:151], v[240:243], v[12:15], v[136:151]
    buffer_load_dwordx4 v[60:63], v0, s[12:15], s42 offen offset:1024 sc1
    ds_read_b128 v[240:243], v1 offset:36864
    s_waitcnt lgkmcnt(5)
    v_mfma_f32_32x32x16_bf16 v[152:167], v[244:247], v[12:15], v[152:167]
    ds_read_b128 v[244:247], v2 offset:4096
    s_waitcnt vmcnt(11) lgkmcnt(5)
    v_mfma_f32_32x32x16_bf16 v[136:151], v[248:251], v[16:19], v[136:151]
    buffer_load_dwordx4 v[64:67], v0, s[12:15], s42 offen offset:2048 sc1
    ds_read_b128 v[248:251], v1 offset:37888
    s_waitcnt lgkmcnt(5)
    v_mfma_f32_32x32x16_bf16 v[152:167], v[252:255], v[16:19], v[152:167]
    ds_read_b128 v[252:255], v2 offset:5120
    s_waitcnt vmcnt(11) lgkmcnt(5)
    v_mfma_f32_32x32x16_bf16 v[136:151], v[232:235], v[20:23], v[136:151]
    buffer_load_dwordx4 v[68:71], v0, s[12:15], s42 offen offset:3072 sc1
    ds_read_b128 v[232:235], v1 offset:38912
    s_waitcnt lgkmcnt(5)
    v_mfma_f32_32x32x16_bf16 v[152:167], v[236:239], v[20:23], v[152:167]
    ds_read_b128 v[236:239], v2 offset:6144
    s_waitcnt vmcnt(11) lgkmcnt(5)
    v_mfma_f32_32x32x16_bf16 v[136:151], v[240:243], v[24:27], v[136:151]
    s_add_u32 s42, s42, 4096
    buffer_load_dwordx4 v[72:75], v0, s[12:15], s42 offen offset:0 sc1
    ds_read_b128 v[240:243], v1 offset:39936
    s_waitcnt lgkmcnt(5)
    v_mfma_f32_32x32x16_bf16 v[152:167], v[244:247], v[24:27], v[152:167]
    ds_read_b128 v[244:247], v2 offset:7168
    s_waitcnt vmcnt(11) lgkmcnt(5)
    v_mfma_f32_32x32x16_bf16 v[136:151], v[248:251], v[28:31], v[136:151]
    buffer_load_dwordx4 v[76:79], v0, s[12:15], s42 offen offset:1024 sc1
    ds_read_b128 v[248:251], v1 offset:40960
    s_waitcnt lgkmcnt(5)
    v_mfma_f32_32x32x16_bf16 v[152:167], v[252:255], v[28:31], v[152:167]
    ds_read_b128 v[252:255], v2 offset:8192
    s_waitcnt vmcnt(11) lgkmcnt(5)
    v_mfma_f32_32x32x16_bf16 v[136:151], v[232:235], v[32:35], v[136:151]
    buffer_load_dwordx4 v[80:83], v0, s[12:15], s42 offen offset:2048 sc1
    ds_read_b128 v[232:235], v1 offset:41984
    s_waitcnt lgkmcnt(5)
    v_mfma_f32_32x32x16_bf16 v[152:167], v[236:239], v[32:35], v[152:167]
    ds_read_b128 v[236:239], v2 offset:9216
    s_waitcnt vmcnt(11) lgkmcnt(5)
    v_mfma_f32_32x32x16_bf16 v[136:151], v[240:243], v[36:39], v[136:151]
    buffer_load_dwordx4 v[84:87], v0, s[12:15], s42 offen offset:3072 sc1
    ds_read_b128 v[240:243], v1 offset:43008
    s_waitcnt lgkmcnt(5)
    v_mfma_f32_32x32x16_bf16 v[152:167], v[244:247], v[36:39], v[152:167]
    ds_read_b128 v[244:247], v2 offset:10240
    s_waitcnt vmcnt(11) lgkmcnt(5)
    v_mfma_f32_32x32x16_bf16 v[136:151], v[248:251], v[40:43], v[136:151]
    buffer_load_dwordx4 v[220:223], v217, s[4:7], s43 offen sc1
    buffer_load_dwordx4 v[224:227], v217, s[4:7], s43 offen offset:512 sc1
    ds_read_b128 v[248:251], v1 offset:44032
    s_waitcnt lgkmcnt(5)
    v_mfma_f32_32x32x16_bf16 v[152:167], v[252:255], v[40:43], v[152:167]
    ds_read_b128 v[252:255], v2 offset:11264
    s_waitcnt vmcnt(12) lgkmcnt(5)
    v_mfma_f32_32x32x16_bf16 v[136:151], v[232:235], v[44:47], v[136:151]
    s_add_u32 s42, s42, 4096
    buffer_load_dwordx4 v[88:91], v0, s[12:15], s42 offen offset:0 sc1
    ds_read_b128 v[232:235], v1 offset:45056
    s_waitcnt lgkmcnt(5)
    v_mfma_f32_32x32x16_bf16 v[152:167], v[236:239], v[44:47], v[152:167]
    ds_read_b128 v[236:239], v2 offset:12288
    s_waitcnt vmcnt(12) lgkmcnt(5)
    v_mfma_f32_32x32x16_bf16 v[136:151], v[240:243], v[48:51], v[136:151]
    buffer_load_dwordx4 v[92:95], v0, s[12:15], s42 offen offset:1024 sc1
    ds_read_b128 v[240:243], v1 offset:46080
    s_waitcnt lgkmcnt(5)
    v_mfma_f32_32x32x16_bf16 v[152:167], v[244:247], v[48:51], v[152:167]
    ds_read_b128 v[244:247], v2 offset:13312
    s_waitcnt vmcnt(12) lgkmcnt(5)
    v_mfma_f32_32x32x16_bf16 v[136:151], v[248:251], v[52:55], v[136:151]
    buffer_load_dwordx4 v[96:99], v0, s[12:15], s42 offen offset:2048 sc1
    ds_read_b128 v[248:251], v1 offset:47104
    s_waitcnt lgkmcnt(5)
    v_mfma_f32_32x32x16_bf16 v[152:167], v[252:255], v[52:55], v[152:167]
    ds_read_b128 v[252:255], v2 offset:14336
    s_waitcnt vmcnt(12) lgkmcnt(5)
    v_mfma_f32_32x32x16_bf16 v[136:151], v[232:235], v[56:59], v[136:151]
    buffer_load_dwordx4 v[100:103], v0, s[12:15], s42 offen offset:3072 sc1
    ds_read_b128 v[232:235], v1 offset:48128
    s_waitcnt lgkmcnt(5)
    v_mfma_f32_32x32x16_bf16 v[152:167], v[236:239], v[56:59], v[152:167]
    ds_read_b128 v[236:239], v2 offset:15360
    s_waitcnt vmcnt(12) lgkmcnt(5)
    v_mfma_f32_32x32x16_bf16 v[136:151], v[240:243], v[60:63], v[136:151]
    s_add_u32 s42, s42, 4096
    buffer_load_dwordx4 v[104:107], v0, s[12:15], s42 offen offset:0 sc1
    ds_read_b128 v[240:243], v1 offset:49152
    s_waitcnt lgkmcnt(5)
    v_mfma_f32_32x32x16_bf16 v[152:167], v[244:247], v[60:63], v[152:167]
    ds_read_b128 v[244:247], v2 offset:16384
    s_waitcnt vmcnt(12) lgkmcnt(5)
    v_mfma_f32_32x32x16_bf16 v[136:151], v[248:251], v[64:67], v[136:151]
    buffer_load_dwordx4 v[108:111], v0, s[12:15], s42 offen offset:1024 sc1
    ds_read_b128 v[248:251], v1 offset:50176
    s_waitcnt lgkmcnt(5)
    v_mfma_f32_32x32x16_bf16 v[152:167], v[252:255], v[64:67], v[152:167]
    ds_read_b128 v[252:255], v2 offset:17408
    s_waitcnt vmcnt(12) lgkmcnt(5)
    v_mfma_f32_32x32x16_bf16 v[136:151], v[232:235], v[68:71], v[136:151]
    buffer_load_dwordx4 v[112:115], v0, s[12:15], s42 offen offset:2048 sc1
    ds_read_b128 v[232:235], v1 offset:51200
    s_waitcnt lgkmcnt(5)
    v_mfma_f32_32x32x16_bf16 v[152:167], v[236:239], v[68:71], v[152:167]
    ds_read_b128 v[236:239], v2 offset:18432
    s_waitcnt vmcnt(12) lgkmcnt(5)
    v_mfma_f32_32x32x16_bf16 v[136:151], v[240:243], v[72:75], v[136:151]
    buffer_load_dwordx4 v[116:119], v0, s[12:15], s42 offen offset:3072 sc1
    ds_read_b128 v[240:243], v1 offset:52224
    s_waitcnt lgkmcnt(5)
    v_mfma_f32_32x32x16_bf16 v[152:167], v[244:247], v[72:75], v[152:167]
    ds_read_b128 v[244:247], v2 offset:19456
    s_waitcnt vmcnt(12) lgkmcnt(5)
    v_mfma_f32_32x32x16_bf16 v[136:151], v[248:251], v[76:79], v[136:151]
    s_add_u32 s42, s42, 4096
    buffer_load_dwordx4 v[120:123], v0, s[12:15], s42 offen offset:0 sc1
    ds_read_b128 v[248:251], v1 offset:53248
    s_waitcnt lgkmcnt(5)
    v_mfma_f32_32x32x16_bf16 v[152:167], v[252:255], v[76:79], v[152:167]
    ds_read_b128 v[252:255], v2 offset:20480
    s_waitcnt vmcnt(12) lgkmcnt(5)
    v_mfma_f32_32x32x16_bf16 v[136:151], v[232:235], v[80:83], v[136:151]
    buffer_load_dwordx4 v[124:127], v0, s[12:15], s42 offen offset:1024 sc1
    ds_read_b128 v[232:235], v1 offset:54272
    s_waitcnt lgkmcnt(5)
    v_mfma_f32_32x32x16_bf16 v[152:167], v[236:239], v[80:83], v[152:167]
    ds_read_b128 v[236:239], v2 offset:21504
    s_waitcnt vmcnt(12) lgkmcnt(5)
    v_mfma_f32_32x32x16_bf16 v[136:151], v[240:243], v[84:87], v[136:151]
    buffer_load_dwordx4 v[128:131], v0, s[12:15], s42 offen offset:2048 sc1
    ds_read_b128 v[240:243], v1 offset:55296
    s_waitcnt lgkmcnt(5)
    v_mfma_f32_32x32x16_bf16 v[152:167], v[244:247], v[84:87], v[152:167]
    ds_read_b128 v[244:247], v2 offset:22528
    s_waitcnt vmcnt(10) lgkmcnt(5)
    v_mfma_f32_32x32x16_bf16 v[136:151], v[248:251], v[88:91], v[136:151]
    buffer_load_dwordx4 v[132:135], v0, s[12:15], s42 offen offset:3072 sc1
    v_and_b32 v218, 0x1f0, v0
    v_lshlrev_b32 v218, 1, v218
    v_bfe_u32 v6, v0, 6, 1
    ds_read_b128 v[248:251], v1 offset:56320
    s_waitcnt lgkmcnt(5)
    v_mfma_f32_32x32x16_bf16 v[152:167], v[252:255], v[88:91], v[152:167]
    v_lshl_add_u32 v218, v6, 4, v218
    v_lshrrev_b32 v6, 9, v0
    v_lshl_add_u32 v218, v6, 12, v218
    ds_read_b128 v[252:255], v2 offset:23552
    s_waitcnt vmcnt(10) lgkmcnt(5)
    v_mfma_f32_32x32x16_bf16 v[136:151], v[232:235], v[92:95], v[136:151]
    s_add_u32 s68, s28, 131072
    v_add_u32 v218, s68, v218
    v_xor_b32 v219, 16, v218
    ds_read_b128 v[232:235], v1 offset:57344
    s_waitcnt lgkmcnt(5)
    v_mfma_f32_32x32x16_bf16 v[152:167], v[236:239], v[92:95], v[152:167]
    v_lshrrev_b32 v6, 1, v0
    v_bfe_u32 v216, v0, 8, 1
    v_lshlrev_b32 v216, 4, v216
    ds_read_b128 v[236:239], v2 offset:24576
    s_waitcnt vmcnt(9) lgkmcnt(5)
    v_mfma_f32_32x32x16_bf16 v[136:151], v[240:243], v[96:99], v[136:151]
    v_xor_b32 v6, v6, v216
    s_lshr_b32 s68, s3, 1
    s_and_b32 s69, s3, 1
    ds_read_b128 v[240:243], v1 offset:58368
    s_waitcnt lgkmcnt(5)
    v_mfma_f32_32x32x16_bf16 v[152:167], v[244:247], v[96:99], v[152:167]
    s_lshl_b32 s68, s68, 12
    s_lshl_b32 s69, s69, 13
    s_add_u32 s68, s68, 131072
    ds_read_b128 v[244:247], v2 offset:25600
    s_waitcnt vmcnt(8) lgkmcnt(5)
    v_mfma_f32_32x32x16_bf16 v[136:151], v[248:251], v[100:103], v[136:151]
    s_add_u32 s69, s69, s68
    s_add_u32 s68, s68, 16384
    v_add_u32 v216, s69, v6
    ds_read_b128 v[248:251], v1 offset:59392
    s_waitcnt lgkmcnt(5)
    v_mfma_f32_32x32x16_bf16 v[152:167], v[252:255], v[100:103], v[152:167]
    v_add_u32 v217, s68, v6
    s_mul_i32 s40, s21, 98304
    s_add_u32 s40, s40, s28
    ds_read_b128 v[252:255], v2 offset:26624
    s_waitcnt vmcnt(7) lgkmcnt(5)
    v_mfma_f32_32x32x16_bf16 v[136:151], v[232:235], v[104:107], v[136:151]
    s_add_u32 s40, s40, 65536
    s_add_u32 s41, s28, 98304
    ds_read_b128 v[232:235], v1 offset:60416
    s_waitcnt lgkmcnt(5)
    v_mfma_f32_32x32x16_bf16 v[152:167], v[236:239], v[104:107], v[152:167]
    v_add_f32 v220, v220, v222
    v_add_f32 v221, v221, v223
    v_add_f32 v224, v224, v226
    ds_read_b128 v[236:239], v2 offset:27648
    s_waitcnt vmcnt(6) lgkmcnt(5)
    v_mfma_f32_32x32x16_bf16 v[136:151], v[240:243], v[108:111], v[136:151]
    v_add_f32 v225, v225, v227
    v_add_f32 v220, v220, v224
    v_add_f32 v221, v221, v225
    ds_read_b128 v[240:243], v1 offset:61440
    s_waitcnt lgkmcnt(5)
    v_mfma_f32_32x32x16_bf16 v[152:167], v[244:247], v[108:111], v[152:167]
    v_add_f32 v220, v220, v221
    v_mul_f32 v220, 0x3b000000, v220
    v_mov_b32 v221, v220
    ds_read_b128 v[244:247], v2 offset:28672
    s_waitcnt vmcnt(5) lgkmcnt(5)
    v_mfma_f32_32x32x16_bf16 v[136:151], v[248:251], v[112:115], v[136:151]
    v_permlane32_swap_b32 v220, v221
    v_fma_f32 v220, -v220, v220, v221
    v_max_f32 v220, 0, v220
    ds_read_b128 v[248:251], v1 offset:62464
    s_waitcnt lgkmcnt(5)
    v_mfma_f32_32x32x16_bf16 v[152:167], v[252:255], v[112:115], v[152:167]
    v_add_f32 v220, 0x3727c5ac, v220
    v_rsq_f32 v228, v220
    s_nop 0
    v_mul_f32 v229, 1069066811, v228
    ds_read_b128 v[252:255], v2 offset:29696
    s_waitcnt vmcnt(4) lgkmcnt(5)
    v_mfma_f32_32x32x16_bf16 v[136:151], v[232:235], v[116:119], v[136:151]
    ds_read_b128 v[232:235], v1 offset:63488
    s_waitcnt lgkmcnt(5)
    v_mfma_f32_32x32x16_bf16 v[152:167], v[236:239], v[116:119], v[152:167]
    ds_read_b128 v[236:239], v2 offset:30720
    s_waitcnt vmcnt(3) lgkmcnt(5)
    v_mfma_f32_32x32x16_bf16 v[136:151], v[240:243], v[120:123], v[136:151]
    ds_read_b128 v[240:243], v1 offset:64512
    s_waitcnt lgkmcnt(5)
    v_mfma_f32_32x32x16_bf16 v[152:167], v[244:247], v[120:123], v[152:167]
    ds_read_b128 v[244:247], v2 offset:31744
    s_waitcnt vmcnt(2) lgkmcnt(5)
    v_mfma_f32_32x32x16_bf16 v[136:151], v[248:251], v[124:127], v[136:151]
    s_waitcnt lgkmcnt(4)
    v_mfma_f32_32x32x16_bf16 v[152:167], v[252:255], v[124:127], v[152:167]
    s_waitcnt vmcnt(1) lgkmcnt(3)
    v_mfma_f32_32x32x16_bf16 v[136:151], v[232:235], v[128:131], v[136:151]
    s_waitcnt lgkmcnt(2)
    v_mfma_f32_32x32x16_bf16 v[152:167], v[236:239], v[128:131], v[152:167]
    s_waitcnt vmcnt(0) lgkmcnt(1)
    v_mfma_f32_32x32x16_bf16 v[136:151], v[240:243], v[132:135], v[136:151]
    s_waitcnt lgkmcnt(0)
    v_mfma_f32_32x32x16_bf16 v[152:167], v[244:247], v[132:135], v[152:167]
    s_nop 9
    v_max3_f32 v230, v136, v137, v138
    v_min3_f32 v231, v136, v137, v138
    v_max3_f32 v230, v230, v139, v140
    v_min3_f32 v231, v231, v139, v140
    v_max3_f32 v230, v230, v141, v142
    v_min3_f32 v231, v231, v141, v142
    v_max3_f32 v230, v230, v143, v144
    v_min3_f32 v231, v231, v143, v144
    v_max3_f32 v230, v230, v145, v146
    v_min3_f32 v231, v231, v145, v146
    v_max3_f32 v230, v230, v147, v148
    v_min3_f32 v231, v231, v147, v148
    v_max3_f32 v230, v230, v149, v150
    v_min3_f32 v231, v231, v149, v150
    v_max_f32 v230, v230, v151
    v_min_f32 v231, v231, v151
    v_pk_mul_f32 v[230:231], v[230:231], v[228:229] op_sel:[0,1] op_sel_hi:[1,1]
    v_pk_fma_f32 v[184:185], v[136:137], v[228:229], v[230:231] op_sel:[0,1,0] op_sel_hi:[1,1,0] neg_lo:[0,0,1] neg_hi:[0,0,1]
    v_pk_fma_f32 v[186:187], v[138:139], v[228:229], v[230:231] op_sel:[0,1,0] op_sel_hi:[1,1,0] neg_lo:[0,0,1] neg_hi:[0,0,1]
    v_pk_fma_f32 v[188:189], v[140:141], v[228:229], v[230:231] op_sel:[0,1,0] op_sel_hi:[1,1,0] neg_lo:[0,0,1] neg_hi:[0,0,1]
    v_pk_fma_f32 v[190:191], v[142:143], v[228:229], v[230:231] op_sel:[0,1,0] op_sel_hi:[1,1,0] neg_lo:[0,0,1] neg_hi:[0,0,1]
    v_pk_fma_f32 v[192:193], v[144:145], v[228:229], v[230:231] op_sel:[0,1,0] op_sel_hi:[1,1,0] neg_lo:[0,0,1] neg_hi:[0,0,1]
    v_pk_fma_f32 v[194:195], v[146:147], v[228:229], v[230:231] op_sel:[0,1,0] op_sel_hi:[1,1,0] neg_lo:[0,0,1] neg_hi:[0,0,1]
    v_pk_fma_f32 v[196:197], v[148:149], v[228:229], v[230:231] op_sel:[0,1,0] op_sel_hi:[1,1,0] neg_lo:[0,0,1] neg_hi:[0,0,1]
    v_pk_fma_f32 v[198:199], v[150:151], v[228:229], v[230:231] op_sel:[0,1,0] op_sel_hi:[1,1,0] neg_lo:[0,0,1] neg_hi:[0,0,1]
    s_barrier
    s_add_u32 m0, s41, 0
    s_nop 0
    buffer_load_dwordx4 v0, s[4:7], s40 offen sc1 lds
    v_exp_f32 v184, v184
    v_exp_f32 v185, v185
    v_exp_f32 v186, v186
    v_exp_f32 v187, v187
    v_pk_mul_f32 v[152:153], v[152:153], v[228:229] op_sel:[0,0] op_sel_hi:[1,0]
IT_7:
    s_cbranch_execz IT_11
    v_pk_mul_f32 v[154:155], v[154:155], v[228:229] op_sel:[0,0] op_sel_hi:[1,0]
    v_pk_mul_f32 v[156:157], v[156:157], v[228:229] op_sel:[0,0] op_sel_hi:[1,0]
    v_pk_mul_f32 v[158:159], v[158:159], v[228:229] op_sel:[0,0] op_sel_hi:[1,0]
    v_cvt_pk_bf16_f32 v152, v152, v153
    v_cvt_pk_bf16_f32 v153, v154, v155
    v_cvt_pk_bf16_f32 v154, v156, v157
    v_cvt_pk_bf16_f32 v155, v158, v159
    ds_write_b128 v218, v[152:155] offset:16384
    v_exp_f32 v188, v188
    v_exp_f32 v189, v189
    v_exp_f32 v190, v190
    v_exp_f32 v191, v191
    s_add_u32 m0, s41, 4096
    s_add_u32 s40, s40, 4096
    buffer_load_dwordx4 v0, s[4:7], s40 offen sc1 lds
    v_exp_f32 v192, v192
    v_exp_f32 v193, v193
    v_exp_f32 v194, v194
    v_exp_f32 v195, v195
    v_pk_mul_f32 v[160:161], v[160:161], v[228:229] op_sel:[0,0] op_sel_hi:[1,0]
    v_pk_mul_f32 v[162:163], v[162:163], v[228:229] op_sel:[0,0] op_sel_hi:[1,0]
    v_pk_mul_f32 v[164:165], v[164:165], v[228:229] op_sel:[0,0] op_sel_hi:[1,0]
    v_pk_mul_f32 v[166:167], v[166:167], v[228:229] op_sel:[0,0] op_sel_hi:[1,0]
    v_cvt_pk_bf16_f32 v156, v160, v161
    v_cvt_pk_bf16_f32 v157, v162, v163
    v_cvt_pk_bf16_f32 v158, v164, v165
    v_cvt_pk_bf16_f32 v159, v166, v167
    ds_write_b128 v219, v[156:159] offset:16384
    v_exp_f32 v196, v196
    v_exp_f32 v197, v197
    v_exp_f32 v198, v198
    v_exp_f32 v199, v199
    s_add_u32 m0, s41, 8192
    s_add_u32 s40, s40, 4096
    buffer_load_dwordx4 v0, s[4:7], s40 offen sc1 lds
    v_pk_fma_f32 v[200:201], v[136:137], v[228:229], v[230:231] op_sel:[0,1,1] op_sel_hi:[1,1,1] neg_lo:[1,0,0] neg_hi:[1,0,0]
    v_pk_fma_f32 v[202:203], v[138:139], v[228:229], v[230:231] op_sel:[0,1,1] op_sel_hi:[1,1,1] neg_lo:[1,0,0] neg_hi:[1,0,0]
    v_pk_fma_f32 v[204:205], v[140:141], v[228:229], v[230:231] op_sel:[0,1,1] op_sel_hi:[1,1,1] neg_lo:[1,0,0] neg_hi:[1,0,0]
    v_pk_fma_f32 v[206:207], v[142:143], v[228:229], v[230:231] op_sel:[0,1,1] op_sel_hi:[1,1,1] neg_lo:[1,0,0] neg_hi:[1,0,0]
    v_pk_fma_f32 v[208:209], v[144:145], v[228:229], v[230:231] op_sel:[0,1,1] op_sel_hi:[1,1,1] neg_lo:[1,0,0] neg_hi:[1,0,0]
    v_pk_fma_f32 v[210:211], v[146:147], v[228:229], v[230:231] op_sel:[0,1,1] op_sel_hi:[1,1,1] neg_lo:[1,0,0] neg_hi:[1,0,0]
    v_pk_fma_f32 v[212:213], v[148:149], v[228:229], v[230:231] op_sel:[0,1,1] op_sel_hi:[1,1,1] neg_lo:[1,0,0] neg_hi:[1,0,0]
    v_pk_fma_f32 v[214:215], v[150:151], v[228:229], v[230:231] op_sel:[0,1,1] op_sel_hi:[1,1,1] neg_lo:[1,0,0] neg_hi:[1,0,0]
    v_pk_add_f32 v[220:221], v[184:185], v[186:187]
    v_pk_add_f32 v[222:223], v[188:189], v[190:191]
    v_pk_add_f32 v[220:221], v[220:221], v[192:193]
    v_pk_add_f32 v[222:223], v[222:223], v[194:195]
    v_pk_add_f32 v[220:221], v[220:221], v[196:197]
    v_pk_add_f32 v[222:223], v[222:223], v[198:199]
    v_pk_add_f32 v[220:221], v[220:221], v[222:223]
    v_add_f32 v220, v220, v221
    v_rcp_f32 v224, v220
    s_add_u32 m0, s41, 12288
    s_add_u32 s40, s40, 4096
    buffer_load_dwordx4 v0, s[4:7], s40 offen sc1 lds
    v_exp_f32 v200, v200
    v_exp_f32 v201, v201
    v_exp_f32 v202, v202
    v_exp_f32 v203, v203
    v_pk_mul_f32 v[184:185], v[184:185], v[224:225] op_sel:[0,0] op_sel_hi:[1,0]
    v_pk_mul_f32 v[186:187], v[186:187], v[224:225] op_sel:[0,0] op_sel_hi:[1,0]
    v_pk_mul_f32 v[188:189], v[188:189], v[224:225] op_sel:[0,0] op_sel_hi:[1,0]
    v_pk_mul_f32 v[190:191], v[190:191], v[224:225] op_sel:[0,0] op_sel_hi:[1,0]
    v_cvt_pk_bf16_f32 v184, v184, v185
    v_cvt_pk_bf16_f32 v185, v186, v187
    v_cvt_pk_bf16_f32 v186, v188, v189
    v_cvt_pk_bf16_f32 v187, v190, v191
    ds_write_b128 v218, v[184:187] offset:0
    v_exp_f32 v204, v204
    v_exp_f32 v205, v205
    v_exp_f32 v206, v206
    v_exp_f32 v207, v207
    s_add_u32 m0, s41, 16384
    s_add_u32 s40, s40, 4096
    buffer_load_dwordx4 v0, s[4:7], s40 offen sc1 lds
    v_exp_f32 v208, v208
    v_exp_f32 v209, v209
    v_exp_f32 v210, v210
    v_exp_f32 v211, v211
    v_pk_mul_f32 v[192:193], v[192:193], v[224:225] op_sel:[0,0] op_sel_hi:[1,0]
    v_pk_mul_f32 v[194:195], v[194:195], v[224:225] op_sel:[0,0] op_sel_hi:[1,0]
    v_pk_mul_f32 v[196:197], v[196:197], v[224:225] op_sel:[0,0] op_sel_hi:[1,0]
    v_pk_mul_f32 v[198:199], v[198:199], v[224:225] op_sel:[0,0] op_sel_hi:[1,0]
    v_cvt_pk_bf16_f32 v188, v192, v193
    v_cvt_pk_bf16_f32 v189, v194, v195
    v_cvt_pk_bf16_f32 v190, v196, v197
    v_cvt_pk_bf16_f32 v191, v198, v199
    ds_write_b128 v219, v[188:191] offset:0
    v_exp_f32 v212, v212
    v_exp_f32 v213, v213
    v_exp_f32 v214, v214
    v_exp_f32 v215, v215
    s_add_u32 m0, s41, 20480
    s_add_u32 s40, s40, 4096
    buffer_load_dwordx4 v0, s[4:7], s40 offen sc1 lds
    v_pk_add_f32 v[220:221], v[200:201], v[202:203]
    v_pk_add_f32 v[222:223], v[204:205], v[206:207]
    v_pk_add_f32 v[220:221], v[220:221], v[208:209]
    v_pk_add_f32 v[222:223], v[222:223], v[210:211]
    v_pk_add_f32 v[220:221], v[220:221], v[212:213]
    v_pk_add_f32 v[222:223], v[222:223], v[214:215]
    v_pk_add_f32 v[220:221], v[220:221], v[222:223]
    v_add_f32 v220, v220, v221
    v_rcp_f32 v225, v220
    s_nop 0
    v_pk_mul_f32 v[200:201], v[200:201], v[224:225] op_sel:[0,1] op_sel_hi:[1,1]
    v_pk_mul_f32 v[202:203], v[202:203], v[224:225] op_sel:[0,1] op_sel_hi:[1,1]
    v_pk_mul_f32 v[204:205], v[204:205], v[224:225] op_sel:[0,1] op_sel_hi:[1,1]
    v_pk_mul_f32 v[206:207], v[206:207], v[224:225] op_sel:[0,1] op_sel_hi:[1,1]
    v_cvt_pk_bf16_f32 v200, v200, v201
    v_cvt_pk_bf16_f32 v201, v202, v203
    v_cvt_pk_bf16_f32 v202, v204, v205
    v_cvt_pk_bf16_f32 v203, v206, v207
    ds_write_b128 v218, v[200:203] offset:8192
    v_pk_mul_f32 v[208:209], v[208:209], v[224:225] op_sel:[0,1] op_sel_hi:[1,1]
    v_pk_mul_f32 v[210:211], v[210:211], v[224:225] op_sel:[0,1] op_sel_hi:[1,1]
    v_pk_mul_f32 v[212:213], v[212:213], v[224:225] op_sel:[0,1] op_sel_hi:[1,1]
    v_pk_mul_f32 v[214:215], v[214:215], v[224:225] op_sel:[0,1] op_sel_hi:[1,1]
    v_cvt_pk_bf16_f32 v204, v208, v209
    v_cvt_pk_bf16_f32 v205, v210, v211
    v_cvt_pk_bf16_f32 v206, v212, v213
    v_cvt_pk_bf16_f32 v207, v214, v215
    ds_write_b128 v219, v[204:207] offset:8192
    s_add_u32 m0, s41, 24576
    s_add_u32 s40, s40, 4096
    buffer_load_dwordx4 v0, s[4:7], s40 offen sc1 lds
    s_add_u32 m0, s41, 28672
    s_add_u32 s40, s40, 4096
    buffer_load_dwordx4 v0, s[4:7], s40 offen sc1 lds
    s_waitcnt lgkmcnt(0)
    s_barrier
    ds_read_b64_tr_b16 v[152:153], v216 offset:0
    ds_read_b64_tr_b16 v[154:155], v216 offset:512
    ds_read_b64_tr_b16 v[156:157], v217 offset:0
    ds_read_b64_tr_b16 v[158:159], v217 offset:512
    ds_read_b64_tr_b16 v[160:161], v216 offset:1024
    ds_read_b64_tr_b16 v[162:163], v216 offset:1536
    ds_read_b64_tr_b16 v[164:165], v217 offset:1024
    ds_read_b64_tr_b16 v[166:167], v217 offset:1536
    ds_read_b64_tr_b16 v[168:169], v216 offset:2048
    ds_read_b64_tr_b16 v[170:171], v216 offset:2560
    ds_read_b64_tr_b16 v[172:173], v217 offset:2048
    ds_read_b64_tr_b16 v[174:175], v217 offset:2560
    v_mov_b32 v184, 0x3f803f80
    v_mov_b32 v185, 0x3f803f80
    v_mov_b32 v186, 0x3f803f80
    v_mov_b32 v187, 0x3f803f80
    ds_read_b64_tr_b16 v[176:177], v216 offset:3072
    ds_read_b64_tr_b16 v[178:179], v216 offset:3584
    ds_read_b64_tr_b16 v[180:181], v217 offset:3072
    ds_read_b64_tr_b16 v[182:183], v217 offset:3584
    s_waitcnt lgkmcnt(12)
    v_mfma_f32_16x16x32_bf16 v[188:191], v[152:155], v[156:159], 0
    v_mfma_f32_16x16x32_bf16 v[192:195], v[152:155], v[184:187], 0
    s_waitcnt lgkmcnt(8)
    v_mfma_f32_16x16x32_bf16 v[188:191], v[160:163], v[164:167], v[188:191]
    v_mfma_f32_16x16x32_bf16 v[192:195], v[160:163], v[184:187], v[192:195]
    s_waitcnt lgkmcnt(4)
    v_mfma_f32_16x16x32_bf16 v[188:191], v[168:171], v[172:175], v[188:191]
    v_mfma_f32_16x16x32_bf16 v[192:195], v[168:171], v[184:187], v[192:195]
    s_waitcnt lgkmcnt(0)
    v_mfma_f32_16x16x32_bf16 v[188:191], v[176:179], v[180:183], v[188:191]
    v_mfma_f32_16x16x32_bf16 v[192:195], v[176:179], v[184:187], v[192:195]
    v_lshrrev_b32 v6, 4, v0
    v_lshrrev_b32 v216, 9, v0
    v_lshlrev_b32 v217, 8, v216
    v_sub_u32 v217, v0, v217
    s_mov_b32 s30, 0x00010001
    s_mov_b32 s31, 0x00010001
    s_nop 0
    v_cvt_pk_bf16_f32 v188, v188, v189
    v_cvt_pk_bf16_f32 v189, v190, v191
    s_nop 0
    v_permlane16_swap_b32 v188, v190
    v_permlane16_swap_b32 v189, v191
    s_mov_b32 exec_lo, 0xffff
    s_mov_b32 exec_hi, 0xffff
    buffer_store_dwordx4 v[188:191], v217, s[4:7], s99 offen sc1
    s_mov_b64 exec, s[30:31]
    buffer_store_dwordx4 v[192:195], v6, s[4:7], s82 offen sc1
    s_mov_b64 exec, -1
    v_and_b32 v216, 15, v6
    v_and_b32 v217, 0x30, v6
    v_lshl_add_u32 v216, v216, 8, v217
    s_mov_b32 s47, s98
    s_waitcnt vmcnt(6)
    s_barrier
    ds_read_b128 v[232:235], v1 offset:32768
    ds_read_b128 v[236:239], v1 offset:33792
    ds_read_b128 v[240:243], v1 offset:34816
    ds_read_b128 v[244:247], v1 offset:35840
    ds_read_b128 v[248:251], v1 offset:36864
    ds_read_b128 v[252:255], v1 offset:37888
    s_waitcnt lgkmcnt(5)
    v_mfma_f32_32x32x16_bf16 v[168:183], v[232:235], v[8:11], 0
    ds_read_b128 v[232:235], v1 offset:38912
    s_waitcnt lgkmcnt(5)
    v_mfma_f32_32x32x16_bf16 v[168:183], v[236:239], v[12:15], v[168:183]
    ds_read_b128 v[236:239], v1 offset:39936
    s_waitcnt lgkmcnt(5)
    v_mfma_f32_32x32x16_bf16 v[168:183], v[240:243], v[16:19], v[168:183]
    ds_read_b128 v[240:243], v1 offset:40960
    s_waitcnt lgkmcnt(5)
    v_mfma_f32_32x32x16_bf16 v[168:183], v[244:247], v[20:23], v[168:183]
    ds_read_b128 v[244:247], v1 offset:41984
    s_waitcnt lgkmcnt(5)
    v_mfma_f32_32x32x16_bf16 v[168:183], v[248:251], v[24:27], v[168:183]
    v_bfe_u32 v16, v0, 4, 1
    v_lshlrev_b32 v16, 4, v16
    v_mov_b32 v17, 0x3f80
    ds_read_b128 v[248:251], v1 offset:43008
    s_waitcnt lgkmcnt(5)
    v_mfma_f32_32x32x16_bf16 v[168:183], v[252:255], v[28:31], v[168:183]
    v_lshlrev_b32 v16, v16, v17
    v_bfe_u32 v17, v0, 7, 1
    v_bfe_u32 v18, v0, 8, 1
    ds_read_b128 v[252:255], v1 offset:44032
    s_waitcnt lgkmcnt(5)
    v_mfma_f32_32x32x16_bf16 v[168:183], v[232:235], v[32:35], v[168:183]
    v_cmp_eq_u32 vcc, v17, v18
    v_bfe_u32 v17, v0, 5, 2
    s_nop 0
    v_cndmask_b32 v16, 0, v16, vcc
    ds_read_b128 v[232:235], v1 offset:45056
    s_waitcnt lgkmcnt(5)
    v_mfma_f32_32x32x16_bf16 v[168:183], v[236:239], v[36:39], v[168:183]
    v_cmp_eq_u32 vcc, 0, v17
    s_nop 1
    v_cndmask_b32 v12, 0, v16, vcc
    v_cmp_eq_u32 vcc, 1, v17
    ds_read_b128 v[236:239], v1 offset:46080
    s_waitcnt lgkmcnt(5)
    v_mfma_f32_32x32x16_bf16 v[168:183], v[240:243], v[40:43], v[168:183]
    v_cndmask_b32 v13, 0, v16, vcc
    v_cmp_eq_u32 vcc, 2, v17
    s_nop 1
    v_cndmask_b32 v14, 0, v16, vcc
    ds_read_b128 v[240:243], v1 offset:47104
    s_waitcnt lgkmcnt(5)
    v_mfma_f32_32x32x16_bf16 v[168:183], v[244:247], v[44:47], v[168:183]
    v_cmp_eq_u32 vcc, 3, v17
    s_nop 1
    v_cndmask_b32 v15, 0, v16, vcc
    v_and_b32 v218, 0xf0, v0
    ds_read_b128 v[244:247], v1 offset:48128
    s_waitcnt lgkmcnt(5)
    v_mfma_f32_32x32x16_bf16 v[168:183], v[248:251], v[48:51], v[168:183]
    v_lshlrev_b32 v218, 1, v218
    v_lshrrev_b32 v219, 8, v0
    v_lshlrev_b32 v219, 3, v219
    s_waitcnt vmcnt(2)
    s_barrier
    ds_read_b128 v[248:251], v1 offset:49152
    s_waitcnt lgkmcnt(5)
    v_mfma_f32_32x32x16_bf16 v[168:183], v[252:255], v[52:55], v[168:183]
    v_add_u32 v218, v218, v219
    s_lshl_b32 s30, s3, 9
    s_add_u32 s30, s30, 155648
    ds_read_b128 v[252:255], v1 offset:50176
    s_waitcnt lgkmcnt(5)
    v_mfma_f32_32x32x16_bf16 v[168:183], v[232:235], v[56:59], v[168:183]
    v_add_u32 v218, s30, v218
    s_lshl_b32 s30, s3, 5
    s_add_u32 s30, s30, 157696
    ds_read_b128 v[232:235], v1 offset:51200
    s_waitcnt lgkmcnt(5)
    v_mfma_f32_32x32x16_bf16 v[168:183], v[236:239], v[60:63], v[168:183]
    v_add_u32 v219, s30, v219
    v_bfe_u32 v20, v0, 7, 2
    v_bfe_u32 v21, v0, 4, 2
    ds_read_b128 v[236:239], v1 offset:52224
    s_waitcnt lgkmcnt(5)
    v_mfma_f32_32x32x16_bf16 v[168:183], v[240:243], v[64:67], v[168:183]
    v_lshl_add_u32 v20, v20, 2, v21
    v_lshlrev_b32 v20, 5, v20
    v_lshrrev_b32 v21, 9, v0
    ds_read_b128 v[240:243], v1 offset:53248
    s_waitcnt lgkmcnt(5)
    v_mfma_f32_32x32x16_bf16 v[168:183], v[244:247], v[68:71], v[168:183]
    v_lshl_add_u32 v20, v21, 10, v20
    v_add_u32 v20, 155648, v20
    v_lshlrev_b32 v21, 6, v21
    ds_read_b128 v[244:247], v1 offset:54272
    s_waitcnt lgkmcnt(5)
    v_mfma_f32_32x32x16_bf16 v[168:183], v[248:251], v[72:75], v[168:183]
    v_add_u32 v21, 157696, v21
    v_mov_b64 v[24:25], 0
    v_mov_b64 v[26:27], 0
    ds_read_b128 v[248:251], v1 offset:55296
    s_waitcnt lgkmcnt(5)
    v_mfma_f32_32x32x16_bf16 v[168:183], v[252:255], v[76:79], v[168:183]
    v_mov_b64 v[28:29], 0
    v_mov_b64 v[30:31], 0
    v_mov_b64 v[32:33], 0
    ds_read_b128 v[252:255], v1 offset:56320
    s_waitcnt lgkmcnt(5)
    v_mfma_f32_32x32x16_bf16 v[168:183], v[232:235], v[80:83], v[168:183]
    v_mov_b64 v[34:35], 0
    v_mov_b64 v[36:37], 0
    v_mov_b64 v[38:39], 0
    ds_read_b128 v[232:235], v1 offset:57344
    s_waitcnt lgkmcnt(5)
    v_mfma_f32_32x32x16_bf16 v[168:183], v[236:239], v[84:87], v[168:183]
    s_mul_i32 s42, s25, 90112
    s_lshl_b32 s31, s21, 11
    s_add_u32 s42, s42, s31
    ds_read_b128 v[236:239], v1 offset:58368
    s_waitcnt lgkmcnt(5)
    v_mfma_f32_32x32x16_bf16 v[168:183], v[240:243], v[88:91], v[168:183]
    s_add_u32 s42, s42, 10485760
    s_lshl_b32 s43, s25, 7
    s_add_u32 s43, s43, s21
    ds_read_b128 v[240:243], v1 offset:59392
    s_waitcnt lgkmcnt(5)
    v_mfma_f32_32x32x16_bf16 v[168:183], v[244:247], v[92:95], v[168:183]
    s_add_u32 s43, s43, 16515072
    s_lshl_b32 s44, s26, 7
    s_add_u32 s44, s44, 16515072
    ds_read_b128 v[244:247], v1 offset:60416
    s_waitcnt lgkmcnt(5)
    v_mfma_f32_32x32x16_bf16 v[168:183], v[248:251], v[96:99], v[168:183]
    buffer_load_dwordx4 v[136:139], v0, s[4:7], s47 offen offset:0 sc1
    s_lshl_b32 s31, s3, 2
    s_lshl_b32 s54, 15, s31
    s_mov_b32 s55, s54
    ds_read_b128 v[248:251], v1 offset:61440
    s_waitcnt lgkmcnt(5)
    v_mfma_f32_32x32x16_bf16 v[168:183], v[252:255], v[100:103], v[168:183]
    buffer_load_dwordx4 v[140:143], v0, s[4:7], s47 offen offset:1024 sc1
    s_mul_i32 s56, s26, 90112
    s_lshl_b32 s31, s3, 13
    s_add_u32 s56, s56, s31
    ds_read_b128 v[252:255], v1 offset:62464
    s_waitcnt lgkmcnt(5)
    v_mfma_f32_32x32x16_bf16 v[168:183], v[232:235], v[104:107], v[168:183]
    buffer_load_dwordx4 v[144:147], v0, s[4:7], s47 offen offset:2048 sc1
    s_add_u32 s56, s56, 10485760
    s_add_u32 s57, s56, 360448
    ds_read_b128 v[232:235], v1 offset:63488
    s_waitcnt lgkmcnt(5)
    v_mfma_f32_32x32x16_bf16 v[168:183], v[236:239], v[108:111], v[168:183]
    buffer_load_dwordx4 v[148:151], v0, s[4:7], s47 offen offset:3072 sc1
    ds_read_b128 v[236:239], v1 offset:64512
    s_waitcnt lgkmcnt(5)
    v_mfma_f32_32x32x16_bf16 v[168:183], v[240:243], v[112:115], v[168:183]
    buffer_load_dwordx4 v[8:11], v216, s[4:7], s101 offen sc1
    s_waitcnt lgkmcnt(4)
    v_mfma_f32_32x32x16_bf16 v[168:183], v[244:247], v[116:119], v[168:183]
    s_add_u32 s47, s47, 4096
    buffer_load_dwordx4 v[152:155], v0, s[4:7], s47 offen offset:0 sc1
    s_waitcnt lgkmcnt(3)
    v_mfma_f32_32x32x16_bf16 v[168:183], v[248:251], v[120:123], v[168:183]
    buffer_load_dwordx4 v[156:159], v0, s[4:7], s47 offen offset:1024 sc1
    s_waitcnt lgkmcnt(2)
    v_mfma_f32_32x32x16_bf16 v[168:183], v[252:255], v[124:127], v[168:183]
    buffer_load_dwordx4 v[160:163], v0, s[4:7], s47 offen offset:2048 sc1
    s_waitcnt lgkmcnt(1)
    v_mfma_f32_32x32x16_bf16 v[168:183], v[232:235], v[128:131], v[168:183]
    buffer_load_dwordx4 v[164:167], v0, s[4:7], s47 offen offset:3072 sc1
    s_waitcnt lgkmcnt(0)
    v_mfma_f32_32x32x16_bf16 v[168:183], v[236:239], v[132:135], v[168:183]
    v_bfe_u32 v253, v0, 8, 1
    v_and_b32 v248, 0xf0, v0
    v_lshlrev_b32 v249, 7, v253
    v_xor_b32 v248, v248, v249
    v_lshl_add_u32 v248, v253, 10, v248
    v_lshrrev_b32 v253, 9, v0
    v_lshl_add_u32 v248, v253, 9, v248
    s_lshl_b32 s30, s3, 13
    s_add_u32 s30, s30, 98304
    v_add_u32 v248, s30, v248
    v_lshl_add_u32 v252, v253, 9, v3
    v_and_b32 v250, 0x70, v0
    s_lshl_b32 s30, s3, 7
    v_add_u32 v250, s30, v250
    v_lshl_add_u32 v251, v253, 10, v250
    v_and_b32 v249, 0x80, v0
    v_xor_b32 v249, v249, v250
    v_lshrrev_b32 v253, 7, v0
    v_lshl_add_u32 v249, v253, 10, v249
    v_add_u32 v249, 98304, v249
    v_lshl_add_u32 v250, v253, 9, v250
    v_max3_f32 v230, v168, v169, v170
    v_min3_f32 v231, v168, v169, v170
    v_max3_f32 v230, v230, v171, v172
    v_min3_f32 v231, v231, v171, v172
    v_max3_f32 v230, v230, v173, v174
    v_min3_f32 v231, v231, v173, v174
    v_max3_f32 v230, v230, v175, v176
    v_min3_f32 v231, v231, v175, v176
    v_max3_f32 v230, v230, v177, v178
    v_min3_f32 v231, v231, v177, v178
    v_max3_f32 v230, v230, v179, v180
    v_min3_f32 v231, v231, v179, v180
    v_max3_f32 v230, v230, v181, v182
    v_min3_f32 v231, v231, v181, v182
    v_max_f32 v230, v230, v183
    v_min_f32 v231, v231, v183
    v_pk_mul_f32 v[230:231], v[230:231], v[228:229] op_sel:[0,1] op_sel_hi:[1,1]
    v_pk_fma_f32 v[184:185], v[168:169], v[228:229], v[230:231] op_sel:[0,1,0] op_sel_hi:[1,1,0] neg_lo:[0,0,1] neg_hi:[0,0,1]
    v_pk_fma_f32 v[186:187], v[170:171], v[228:229], v[230:231] op_sel:[0,1,0] op_sel_hi:[1,1,0] neg_lo:[0,0,1] neg_hi:[0,0,1]
    v_pk_fma_f32 v[188:189], v[172:173], v[228:229], v[230:231] op_sel:[0,1,0] op_sel_hi:[1,1,0] neg_lo:[0,0,1] neg_hi:[0,0,1]
    v_pk_fma_f32 v[190:191], v[174:175], v[228:229], v[230:231] op_sel:[0,1,0] op_sel_hi:[1,1,0] neg_lo:[0,0,1] neg_hi:[0,0,1]
    v_pk_fma_f32 v[192:193], v[176:177], v[228:229], v[230:231] op_sel:[0,1,0] op_sel_hi:[1,1,0] neg_lo:[0,0,1] neg_hi:[0,0,1]
    v_pk_fma_f32 v[194:195], v[178:179], v[228:229], v[230:231] op_sel:[0,1,0] op_sel_hi:[1,1,0] neg_lo:[0,0,1] neg_hi:[0,0,1]
    v_pk_fma_f32 v[196:197], v[180:181], v[228:229], v[230:231] op_sel:[0,1,0] op_sel_hi:[1,1,0] neg_lo:[0,0,1] neg_hi:[0,0,1]
    v_pk_fma_f32 v[198:199], v[182:183], v[228:229], v[230:231] op_sel:[0,1,0] op_sel_hi:[1,1,0] neg_lo:[0,0,1] neg_hi:[0,0,1]
    v_pk_fma_f32 v[200:201], v[168:169], v[228:229], v[230:231] op_sel:[0,1,1] op_sel_hi:[1,1,1] neg_lo:[1,0,0] neg_hi:[1,0,0]
    v_pk_fma_f32 v[202:203], v[170:171], v[228:229], v[230:231] op_sel:[0,1,1] op_sel_hi:[1,1,1] neg_lo:[1,0,0] neg_hi:[1,0,0]
    v_pk_fma_f32 v[204:205], v[172:173], v[228:229], v[230:231] op_sel:[0,1,1] op_sel_hi:[1,1,1] neg_lo:[1,0,0] neg_hi:[1,0,0]
    v_pk_fma_f32 v[206:207], v[174:175], v[228:229], v[230:231] op_sel:[0,1,1] op_sel_hi:[1,1,1] neg_lo:[1,0,0] neg_hi:[1,0,0]
    v_pk_fma_f32 v[208:209], v[176:177], v[228:229], v[230:231] op_sel:[0,1,1] op_sel_hi:[1,1,1] neg_lo:[1,0,0] neg_hi:[1,0,0]
    v_pk_fma_f32 v[210:211], v[178:179], v[228:229], v[230:231] op_sel:[0,1,1] op_sel_hi:[1,1,1] neg_lo:[1,0,0] neg_hi:[1,0,0]
    v_pk_fma_f32 v[212:213], v[180:181], v[228:229], v[230:231] op_sel:[0,1,1] op_sel_hi:[1,1,1] neg_lo:[1,0,0] neg_hi:[1,0,0]
    v_pk_fma_f32 v[214:215], v[182:183], v[228:229], v[230:231] op_sel:[0,1,1] op_sel_hi:[1,1,1] neg_lo:[1,0,0] neg_hi:[1,0,0]
    v_exp_f32 v184, v184
    v_exp_f32 v185, v185
    v_exp_f32 v186, v186
    v_exp_f32 v187, v187
    v_exp_f32 v188, v188
    v_exp_f32 v189, v189
    v_exp_f32 v190, v190
    v_exp_f32 v191, v191
    v_exp_f32 v192, v192
    v_exp_f32 v193, v193
    v_exp_f32 v194, v194
    v_exp_f32 v195, v195
    v_exp_f32 v196, v196
    v_exp_f32 v197, v197
    v_exp_f32 v198, v198
    v_exp_f32 v199, v199
    v_exp_f32 v200, v200
    v_exp_f32 v201, v201
    v_exp_f32 v202, v202
    v_exp_f32 v203, v203
    v_exp_f32 v204, v204
    v_exp_f32 v205, v205
    v_exp_f32 v206, v206
    v_exp_f32 v207, v207
    v_exp_f32 v208, v208
    v_exp_f32 v209, v209
    v_exp_f32 v210, v210
    v_exp_f32 v211, v211
    v_exp_f32 v212, v212
    v_exp_f32 v213, v213
    v_exp_f32 v214, v214
    v_exp_f32 v215, v215
    v_pk_add_f32 v[220:221], v[184:185], v[186:187]
    v_pk_add_f32 v[222:223], v[200:201], v[202:203]
    v_pk_add_f32 v[220:221], v[220:221], v[188:189]
    v_pk_add_f32 v[222:223], v[222:223], v[204:205]
    v_pk_add_f32 v[220:221], v[220:221], v[190:191]
    v_pk_add_f32 v[222:223], v[222:223], v[206:207]
    v_pk_add_f32 v[220:221], v[220:221], v[192:193]
    v_pk_add_f32 v[222:223], v[222:223], v[208:209]
    v_pk_add_f32 v[220:221], v[220:221], v[194:195]
    v_pk_add_f32 v[222:223], v[222:223], v[210:211]
    v_pk_add_f32 v[220:221], v[220:221], v[196:197]
    v_pk_add_f32 v[222:223], v[222:223], v[212:213]
    v_pk_add_f32 v[220:221], v[220:221], v[198:199]
    v_pk_add_f32 v[222:223], v[222:223], v[214:215]
    v_add_f32 v220, v220, v221
    v_add_f32 v222, v222, v223
    v_rcp_f32 v225, v222
    v_cvt_pk_bf16_f32 v184, v184, v185
    v_cvt_pk_bf16_f32 v185, v186, v187
    v_cvt_pk_bf16_f32 v186, v188, v189
    v_cvt_pk_bf16_f32 v187, v190, v191
    v_cvt_pk_bf16_f32 v188, v192, v193
    v_cvt_pk_bf16_f32 v189, v194, v195
    v_cvt_pk_bf16_f32 v190, v196, v197
    v_cvt_pk_bf16_f32 v191, v198, v199
    v_mul_f32 v225, v225, v220
    v_pk_mul_f32 v[200:201], v[200:201], v[224:225] op_sel:[0,1] op_sel_hi:[1,1]
    v_pk_mul_f32 v[202:203], v[202:203], v[224:225] op_sel:[0,1] op_sel_hi:[1,1]
    v_pk_mul_f32 v[204:205], v[204:205], v[224:225] op_sel:[0,1] op_sel_hi:[1,1]
    v_pk_mul_f32 v[206:207], v[206:207], v[224:225] op_sel:[0,1] op_sel_hi:[1,1]
    v_pk_mul_f32 v[208:209], v[208:209], v[224:225] op_sel:[0,1] op_sel_hi:[1,1]
    v_pk_mul_f32 v[210:211], v[210:211], v[224:225] op_sel:[0,1] op_sel_hi:[1,1]
    v_pk_mul_f32 v[212:213], v[212:213], v[224:225] op_sel:[0,1] op_sel_hi:[1,1]
    v_pk_mul_f32 v[214:215], v[214:215], v[224:225] op_sel:[0,1] op_sel_hi:[1,1]
    v_cvt_pk_bf16_f32 v200, v200, v201
    v_cvt_pk_bf16_f32 v201, v202, v203
    v_cvt_pk_bf16_f32 v202, v204, v205
    v_cvt_pk_bf16_f32 v203, v206, v207
    v_cvt_pk_bf16_f32 v204, v208, v209
    v_cvt_pk_bf16_f32 v205, v210, v211
    v_cvt_pk_bf16_f32 v206, v212, v213
    v_cvt_pk_bf16_f32 v207, v214, v215
    v_mul_f32 v226, 0x358637bd, v220
    s_branch Lre_55
Lre_55_l:
    s_add_u32 s61, s61, 1
    s_sub_u32 s60, s60, 1
    s_cbranch_scc1 K1_fail
    s_add_u32 s47, s98, 4096
    buffer_load_dwordx4 v[136:139], v0, s[4:7], s98 offen offset:0 sc1
    buffer_load_dwordx4 v[140:143], v0, s[4:7], s98 offen offset:1024 sc1
    buffer_load_dwordx4 v[144:147], v0, s[4:7], s98 offen offset:2048 sc1
    buffer_load_dwordx4 v[148:151], v0, s[4:7], s98 offen offset:3072 sc1
    buffer_load_dwordx4 v[8:11], v216, s[4:7], s101 offen sc1
    buffer_load_dwordx4 v[152:155], v0, s[4:7], s47 offen offset:0 sc1
    buffer_load_dwordx4 v[156:159], v0, s[4:7], s47 offen offset:1024 sc1
    buffer_load_dwordx4 v[160:163], v0, s[4:7], s47 offen offset:2048 sc1
    buffer_load_dwordx4 v[164:167], v0, s[4:7], s47 offen offset:3072 sc1
Lre_55:
    s_waitcnt vmcnt(8)
    v_mfma_f32_16x16x32_bf16 v[112:115], v[12:15], v[136:139], 0
    s_waitcnt vmcnt(7)
    v_mfma_f32_16x16x32_bf16 v[112:115], v[12:15], v[140:143], v[112:115]
    s_waitcnt vmcnt(6)
    v_mfma_f32_16x16x32_bf16 v[112:115], v[12:15], v[144:147], v[112:115]
    s_waitcnt vmcnt(5)
    v_mfma_f32_16x16x32_bf16 v[112:115], v[12:15], v[148:151], v[112:115]
    s_waitcnt vmcnt(4)
    v_cmp_eq_u32 vcc, -1, v8
    v_add_f32 v116, v8, v8 row_ror:8 row_mask:0xf bank_mask:0xf
    v_add_f32 v117, v9, v9 row_ror:8 row_mask:0xf bank_mask:0xf
    s_cbranch_vccnz Lre_55_l
    v_add_f32 v118, v10, v10 row_ror:8 row_mask:0xf bank_mask:0xf
    v_add_f32 v119, v11, v11 row_ror:8 row_mask:0xf bank_mask:0xf
    v_add_f32 v116, v116, v116 row_ror:4 row_mask:0xf bank_mask:0xf
    v_add_f32 v117, v117, v117 row_ror:4 row_mask:0xf bank_mask:0xf
    v_add_f32 v118, v118, v118 row_ror:4 row_mask:0xf bank_mask:0xf
    v_add_f32 v119, v119, v119 row_ror:4 row_mask:0xf bank_mask:0xf
    v_add_f32 v116, v116, v116 row_ror:2 row_mask:0xf bank_mask:0xf
    v_add_f32 v117, v117, v117 row_ror:2 row_mask:0xf bank_mask:0xf
    v_add_f32 v118, v118, v118 row_ror:2 row_mask:0xf bank_mask:0xf
    v_add_f32 v119, v119, v119 row_ror:2 row_mask:0xf bank_mask:0xf
    v_add_f32 v116, v116, v116 row_ror:1 row_mask:0xf bank_mask:0xf
    v_add_f32 v117, v117, v117 row_ror:1 row_mask:0xf bank_mask:0xf
    v_add_f32 v118, v118, v118 row_ror:1 row_mask:0xf bank_mask:0xf
    v_add_f32 v119, v119, v119 row_ror:1 row_mask:0xf bank_mask:0xf
    v_add_f32 v120, v116, v117
    v_add_f32 v121, v118, v119
    v_cvt_pk_bf16_f32 v116, v116, v117
    v_add_f32 v120, v120, v121
    v_cvt_pk_bf16_f32 v117, v118, v119
    s_waitcnt vmcnt(3)
    v_mfma_f32_16x16x32_bf16 v[112:115], v[12:15], v[152:155], v[112:115]
    s_waitcnt vmcnt(2)
    v_mfma_f32_16x16x32_bf16 v[112:115], v[12:15], v[156:159], v[112:115]
    s_waitcnt vmcnt(1)
    v_mfma_f32_16x16x32_bf16 v[112:115], v[12:15], v[160:163], v[112:115]
    s_waitcnt vmcnt(0)
    v_mfma_f32_16x16x32_bf16 v[112:115], v[12:15], v[164:167], v[112:115]
    s_nop 7
    v_cmp_u_f32 vcc, v120, v112
    v_cvt_pk_bf16_f32 v122, v112, v113
    v_cvt_pk_bf16_f32 v123, v114, v115
    s_cbranch_vccnz Lchk_56
Lgo_57:
    ds_write_b64 v218, v[122:123]
    ds_write_b64 v219, v[116:117]
    s_mov_b32 s30, 0x0f0f0f0f
    s_mov_b32 s31, 0xf0f0f0f0
    s_waitcnt lgkmcnt(0)
    s_barrier
    ds_read_b128 v[40:43], v21 offset:0
    ds_read_b128 v[44:47], v21 offset:16
    ds_read_b128 v[48:51], v21 offset:32
    ds_read_b128 v[52:55], v21 offset:48
    s_mov_b64 exec, s[30:31]
    ds_read_b128 v[24:27], v20 offset:0
    ds_read_b128 v[28:31], v20 offset:16
    ds_read_b128 v[32:35], v20 offset:512
    ds_read_b128 v[36:39], v20 offset:528
    s_mov_b64 exec, -1
    s_waitcnt lgkmcnt(7)
    v_dot2_f32_bf16 v226, v184, v40, v226
    v_dot2_f32_bf16 v227, v185, v41, 0
    v_dot2_f32_bf16 v226, v186, v42, v226
    v_dot2_f32_bf16 v227, v187, v43, v227
    s_waitcnt lgkmcnt(6)
    v_dot2_f32_bf16 v226, v188, v44, v226
    v_dot2_f32_bf16 v227, v189, v45, v227
    v_dot2_f32_bf16 v226, v190, v46, v226
    v_dot2_f32_bf16 v227, v191, v47, v227
    s_waitcnt lgkmcnt(5)
    v_dot2_f32_bf16 v226, v200, v48, v226
    v_dot2_f32_bf16 v227, v201, v49, v227
    v_dot2_f32_bf16 v226, v202, v50, v226
    v_dot2_f32_bf16 v227, v203, v51, v227
    s_waitcnt lgkmcnt(4)
    v_dot2_f32_bf16 v226, v204, v52, v226
    v_dot2_f32_bf16 v227, v205, v53, v227
    v_dot2_f32_bf16 v226, v206, v54, v226
    v_dot2_f32_bf16 v227, v207, v55, v227
    s_waitcnt lgkmcnt(3)
    v_mfma_f32_32x32x16_bf16 v[136:151], v[24:27], v[184:187], 0
    s_mov_b32 s59, s43
    s_mov_b32 s76, s42
    v_add_f32 v226, v226, v227
    v_rcp_f32 v226, v226
    s_lshl_b32 s42, s26, 15
    s_waitcnt lgkmcnt(2)
    v_mfma_f32_32x32x16_bf16 v[136:151], v[28:31], v[188:191], v[136:151]
    s_lshl_b32 s31, s23, 12
    s_add_u32 s42, s42, s31
    s_lshl_b32 s43, s26, 7
    s_lshl_b32 s31, s23, 2
    s_add_u32 s43, s43, s31
    s_waitcnt lgkmcnt(1)
    v_mfma_f32_32x32x16_bf16 v[136:151], v[32:35], v[200:203], v[136:151]
    s_add_u32 s43, s43, s3
    s_add_u32 s43, s43, 16515104
    s_lshl_b32 s45, s26, 11
    s_add_u32 s45, s45, s31
    s_lshr_b32 s31, s23, 2
    s_waitcnt lgkmcnt(0)
    v_mfma_f32_32x32x16_bf16 v[136:151], v[36:39], v[204:207], v[136:151]
    s_mul_i32 s31, s31, 496
    s_add_u32 s45, s45, s31
    s_add_u32 s45, s45, 8257536
    v_accvgpr_read_b32 v104, a240
    v_accvgpr_read_b32 v105, a241
    v_accvgpr_read_b32 v106, a242
    v_accvgpr_read_b32 v107, a243
    v_accvgpr_read_b32 v108, a244
    v_accvgpr_read_b32 v109, a245
    v_accvgpr_read_b32 v110, a246
    v_accvgpr_read_b32 v111, a247
    v_accvgpr_read_b32 v112, a248
    v_pk_mul_f32 v[136:137], v[136:137], v[226:227] op_sel:[0,0] op_sel_hi:[1,0]
    v_pk_mul_f32 v[138:139], v[138:139], v[226:227] op_sel:[0,0] op_sel_hi:[1,0]
    v_pk_mul_f32 v[140:141], v[140:141], v[226:227] op_sel:[0,0] op_sel_hi:[1,0]
    v_pk_mul_f32 v[142:143], v[142:143], v[226:227] op_sel:[0,0] op_sel_hi:[1,0]
    v_cvt_pk_bf16_f32 v136, v136, v137
    v_cvt_pk_bf16_f32 v137, v138, v139
IT_8:
    s_cbranch_execz IT_ret
    v_cvt_pk_bf16_f32 v138, v140, v141
    v_cvt_pk_bf16_f32 v139, v142, v143
    buffer_store_dwordx4 v[136:139], v0, s[4:7], s76 offen offset:0
    v_pk_mul_f32 v[144:145], v[144:145], v[226:227] op_sel:[0,0] op_sel_hi:[1,0]
    v_pk_mul_f32 v[146:147], v[146:147], v[226:227] op_sel:[0,0] op_sel_hi:[1,0]
    v_pk_mul_f32 v[148:149], v[148:149], v[226:227] op_sel:[0,0] op_sel_hi:[1,0]
    v_pk_mul_f32 v[150:151], v[150:151], v[226:227] op_sel:[0,0] op_sel_hi:[1,0]
    v_cvt_pk_bf16_f32 v144, v144, v145
    v_cvt_pk_bf16_f32 v145, v146, v147
    v_cvt_pk_bf16_f32 v146, v148, v149
    v_cvt_pk_bf16_f32 v147, v150, v151
    buffer_store_dwordx4 v[144:147], v0, s[4:7], s76 offen offset:1024
    v_accvgpr_read_b32 v113, a249
    v_accvgpr_read_b32 v114, a250
    v_accvgpr_read_b32 v115, a251
    v_accvgpr_read_b32 v116, a252
    v_accvgpr_read_b32 v117, a253
    v_accvgpr_read_b32 v118, a254
    v_accvgpr_read_b32 v119, a255
    s_waitcnt vmcnt(0)
    s_mov_b64 exec, 4
    s_cmp_eq_u32 s24, 0
    s_cbranch_scc1 Limp_58
    buffer_store_byte v3, off, s[4:7], s59
Lfl_59:
    s_mov_b64 exec, -1
    buffer_load_ubyte v4, v252, s[4:7], s44 offen sc1
    s_waitcnt vmcnt(0)
    v_cmp_gt_u32 vcc, 2, v4
    s_nop 0
    s_and_b64 vcc, vcc, s[54:55]
    s_cbranch_vccz Lspin_60_r
Lspin_60:
    buffer_load_ubyte v4, v252, s[4:7], s44 offen sc1
    s_sub_u32 s60, s60, 1
    s_cbranch_scc1 K1_fail
    s_waitcnt vmcnt(0)
    v_cmp_gt_u32 vcc, 2, v4
    s_nop 0
    s_and_b64 vcc, vcc, s[54:55]
    s_cbranch_vccnz Lspin_60
Lspin_60_r:
    s_cmp_eq_u32 s24, 0
    s_cbranch_scc1 Linv_62
Lok_61:
    buffer_load_dwordx4 v[8:11], v5, s[4:7], s56 offen offset:0 sc1
    buffer_load_dwordx4 v[12:15], v5, s[4:7], s56 offen offset:256 sc1
    buffer_load_dwordx4 v[16:19], v5, s[4:7], s56 offen offset:2048 sc1
    buffer_load_dwordx4 v[20:23], v5, s[4:7], s56 offen offset:2304 sc1
    s_add_u32 s56, s56, 4096
    buffer_load_dwordx4 v[24:27], v5, s[4:7], s56 offen offset:0 sc1
    buffer_load_dwordx4 v[28:31], v5, s[4:7], s56 offen offset:256 sc1
    s_waitcnt vmcnt(4)
    v_mfma_f32_16x16x32_bf16 v[136:139], a[0:3], v[8:11], 0
    buffer_load_dwordx4 v[32:35], v5, s[4:7], s56 offen offset:2048 sc1
    s_lshl_b32 s44, s27, 7
    v_mfma_f32_16x16x32_bf16 v[140:143], a[0:3], v[12:15], 0
    s_add_u32 s44, s44, 16515104
    s_lshl_b32 s72, s27, 15
    v_mfma_f32_16x16x32_bf16 v[152:155], a[8:11], v[8:11], 0
    buffer_load_dwordx4 v[36:39], v5, s[4:7], s56 offen offset:2304 sc1
    s_add_u32 s73, s72, 131072
    v_mfma_f32_16x16x32_bf16 v[156:159], a[8:11], v[12:15], 0
    s_mul_i32 s74, s26, 90112
    s_mul_i32 s31, s3, 22528
    v_mfma_f32_16x16x32_bf16 v[144:147], a[4:7], v[8:11], 0
    buffer_load_dwordx4 v[40:43], v5, s[4:7], s57 offen offset:0 sc1
    s_add_u32 s74, s74, s31
    v_mfma_f32_16x16x32_bf16 v[148:151], a[4:7], v[12:15], 0
    s_add_u32 s74, s74, 10485760
    s_add_u32 s75, s74, 360448
    v_mfma_f32_16x16x32_bf16 v[160:163], a[12:15], v[8:11], 0
    buffer_load_dwordx4 v[44:47], v5, s[4:7], s57 offen offset:256 sc1
    s_lshl_b32 s58, s26, 7
    v_mfma_f32_16x16x32_bf16 v[164:167], a[12:15], v[12:15], 0
    s_add_u32 s58, s58, 16515136
    s_mul_i32 s31, s3, 7
    s_waitcnt vmcnt(6)
    v_mfma_f32_16x16x32_bf16 v[136:139], a[16:19], v[16:19], v[136:139]
    buffer_load_dwordx4 v[48:51], v5, s[4:7], s57 offen offset:2048 sc1
    s_lshl_b32 s54, 0xff, s31
    v_mfma_f32_16x16x32_bf16 v[140:143], a[16:19], v[20:23], v[140:143]
    s_cmp_eq_u32 s3, 3
    s_cselect_b32 s54, 0x1fc00000, s54
    s_mov_b32 s55, -1
    v_mfma_f32_16x16x32_bf16 v[152:155], a[24:27], v[16:19], v[152:155]
    v_lshrrev_b32 v6, 9, v0
    v_mul_u32_u24 v6, 480, v6
    v_mfma_f32_16x16x32_bf16 v[156:159], a[24:27], v[20:23], v[156:159]
    v_add_u32 v6, v6, v3
    v_mfma_f32_16x16x32_bf16 v[144:147], a[20:23], v[16:19], v[144:147]
    buffer_load_dwordx4 v[52:55], v5, s[4:7], s57 offen offset:2304 sc1
    s_lshl_b32 s59, s26, 11
    v_mfma_f32_16x16x32_bf16 v[148:151], a[20:23], v[20:23], v[148:151]
    s_add_u32 s59, s59, 8257536
    s_lshl_b32 s31, s3, 7
    v_mfma_f32_16x16x32_bf16 v[160:163], a[28:31], v[16:19], v[160:163]
    s_add_u32 s59, s59, s31
    s_mul_i32 s47, s27, 90112
    v_mfma_f32_16x16x32_bf16 v[164:167], a[28:31], v[20:23], v[164:167]
    s_mul_i32 s31, s19, 3072
    s_waitcnt vmcnt(6)
    v_mfma_f32_16x16x32_bf16 v[136:139], a[32:35], v[24:27], v[136:139]
    s_add_u32 s57, s57, 4096
    buffer_load_dwordx4 v[56:59], v5, s[4:7], s57 offen offset:0 sc1
    v_mfma_f32_16x16x32_bf16 v[140:143], a[32:35], v[28:31], v[140:143]
    s_add_u32 s47, s47, s31
    s_add_u32 s47, s47, 10485760
    s_lshl_b32 s48, s27, 7
    v_mfma_f32_16x16x32_bf16 v[152:155], a[40:43], v[24:27], v[152:155]
    s_add_u32 s48, s48, s19
    s_add_u32 s48, s48, 16515136
    v_mfma_f32_16x16x32_bf16 v[156:159], a[40:43], v[28:31], v[156:159]
    v_lshrrev_b32 v1, 9, v0
    v_mfma_f32_16x16x32_bf16 v[144:147], a[36:39], v[24:27], v[144:147]
    buffer_load_dwordx4 v[60:63], v5, s[4:7], s57 offen offset:256 sc1
    v_mul_u32_u24 v1, 3072, v1
    v_mfma_f32_16x16x32_bf16 v[148:151], a[36:39], v[28:31], v[148:151]
    v_bfe_u32 v2, v0, 8, 1
    v_lshl_add_u32 v1, v2, 9, v1
    v_mfma_f32_16x16x32_bf16 v[160:163], a[44:47], v[24:27], v[160:163]
    v_bfe_u32 v2, v0, 6, 1
    v_lshl_add_u32 v1, v2, 7, v1
    v_mfma_f32_16x16x32_bf16 v[164:167], a[44:47], v[28:31], v[164:167]
    v_bfe_u32 v2, v0, 7, 1
    s_waitcnt vmcnt(6)
    v_mfma_f32_16x16x32_bf16 v[136:139], a[48:51], v[32:35], v[136:139]
    buffer_load_dwordx4 v[64:67], v5, s[4:7], s57 offen offset:2048 sc1
    v_lshl_add_u32 v1, v2, 6, v1
    v_mfma_f32_16x16x32_bf16 v[140:143], a[48:51], v[36:39], v[140:143]
    v_and_b32 v2, 0x30, v0
    v_add_u32 v1, v1, v2
    v_mfma_f32_16x16x32_bf16 v[152:155], a[56:59], v[32:35], v[152:155]
    v_add_u32 v2, 49152, v1
    v_mfma_f32_16x16x32_bf16 v[156:159], a[56:59], v[36:39], v[156:159]
    v_mfma_f32_16x16x32_bf16 v[144:147], a[52:55], v[32:35], v[144:147]
    buffer_load_dwordx4 v[68:71], v5, s[4:7], s57 offen offset:2304 sc1
    v_mfma_f32_16x16x32_bf16 v[148:151], a[52:55], v[36:39], v[148:151]
    v_mfma_f32_16x16x32_bf16 v[160:163], a[60:63], v[32:35], v[160:163]
    v_mfma_f32_16x16x32_bf16 v[164:167], a[60:63], v[36:39], v[164:167]
    s_waitcnt vmcnt(6)
    v_mfma_f32_16x16x32_bf16 v[168:171], a[0:3], v[40:43], 0
    ds_write_b128 v248, v[136:139] offset:0
    v_mfma_f32_16x16x32_bf16 v[172:175], a[0:3], v[44:47], 0
    v_mfma_f32_16x16x32_bf16 v[184:187], a[8:11], v[40:43], 0
    ds_write_b128 v248, v[140:143] offset:256
    v_mfma_f32_16x16x32_bf16 v[188:191], a[8:11], v[44:47], 0
    v_mfma_f32_16x16x32_bf16 v[176:179], a[4:7], v[40:43], 0
    ds_write_b128 v248, v[144:147] offset:2048
    v_mfma_f32_16x16x32_bf16 v[180:183], a[4:7], v[44:47], 0
    v_mfma_f32_16x16x32_bf16 v[192:195], a[12:15], v[40:43], 0
    ds_write_b128 v248, v[148:151] offset:2304
    v_mfma_f32_16x16x32_bf16 v[196:199], a[12:15], v[44:47], 0
    s_waitcnt vmcnt(4)
    v_mfma_f32_16x16x32_bf16 v[168:171], a[16:19], v[48:51], v[168:171]
    ds_write_b128 v248, v[152:155] offset:4096
    v_mfma_f32_16x16x32_bf16 v[172:175], a[16:19], v[52:55], v[172:175]
    v_mfma_f32_16x16x32_bf16 v[184:187], a[24:27], v[48:51], v[184:187]
    ds_write_b128 v248, v[156:159] offset:4352
    v_mfma_f32_16x16x32_bf16 v[188:191], a[24:27], v[52:55], v[188:191]
    v_mfma_f32_16x16x32_bf16 v[176:179], a[20:23], v[48:51], v[176:179]
    ds_write_b128 v248, v[160:163] offset:6144
    v_mfma_f32_16x16x32_bf16 v[180:183], a[20:23], v[52:55], v[180:183]
    v_mfma_f32_16x16x32_bf16 v[192:195], a[28:31], v[48:51], v[192:195]
    ds_write_b128 v248, v[164:167] offset:6400
    v_mfma_f32_16x16x32_bf16 v[196:199], a[28:31], v[52:55], v[196:199]
    s_waitcnt lgkmcnt(0)
    s_barrier
    ds_read_b128 v[72:75], v249 offset:0
    ds_read_b128 v[76:79], v249 offset:512
    ds_read_b128 v[80:83], v249 offset:8192
    ds_read_b128 v[84:87], v249 offset:8704
    ds_read_b128 v[88:91], v249 offset:16384
    ds_read_b128 v[92:95], v249 offset:16896
    ds_read_b128 v[96:99], v249 offset:24576
    ds_read_b128 v[100:103], v249 offset:25088
    s_waitcnt vmcnt(2)
    v_mfma_f32_16x16x32_bf16 v[168:171], a[32:35], v[56:59], v[168:171]
    v_mfma_f32_16x16x32_bf16 v[172:175], a[32:35], v[60:63], v[172:175]
    v_mfma_f32_16x16x32_bf16 v[184:187], a[40:43], v[56:59], v[184:187]
    v_mfma_f32_16x16x32_bf16 v[188:191], a[40:43], v[60:63], v[188:191]
    s_waitcnt lgkmcnt(4)
    v_pk_add_f32 v[72:73], v[72:73], v[80:81]
    v_pk_add_f32 v[74:75], v[74:75], v[82:83]
    v_pk_add_f32 v[76:77], v[76:77], v[84:85]
    v_pk_add_f32 v[78:79], v[78:79], v[86:87]
    v_pk_add_f32 v[104:105], v[104:105], v[72:73]
    v_pk_add_f32 v[106:107], v[106:107], v[74:75]
    v_pk_add_f32 v[108:109], v[108:109], v[76:77]
    v_pk_add_f32 v[110:111], v[110:111], v[78:79]
    s_waitcnt lgkmcnt(0)
    v_pk_add_f32 v[88:89], v[88:89], v[96:97]
    v_pk_add_f32 v[90:91], v[90:91], v[98:99]
    v_pk_add_f32 v[92:93], v[92:93], v[100:101]
    v_pk_add_f32 v[94:95], v[94:95], v[102:103]
    v_pk_add_f32 v[104:105], v[104:105], v[88:89]
    v_pk_add_f32 v[106:107], v[106:107], v[90:91]
    v_pk_add_f32 v[108:109], v[108:109], v[92:93]
    v_pk_add_f32 v[110:111], v[110:111], v[94:95]
    v_cvt_pk_bf16_f32 v72, v104, v105
    v_cvt_pk_bf16_f32 v73, v106, v107
    v_cvt_pk_bf16_f32 v74, v108, v109
    v_cvt_pk_bf16_f32 v75, v110, v111
    buffer_store_dwordx4 v[72:75], v250, s[12:15], s42 offen
    v_mfma_f32_16x16x32_bf16 v[176:179], a[36:39], v[56:59], v[176:179]
    v_mfma_f32_16x16x32_bf16 v[180:183], a[36:39], v[60:63], v[180:183]
    v_mfma_f32_16x16x32_bf16 v[192:195], a[44:47], v[56:59], v[192:195]
    v_mfma_f32_16x16x32_bf16 v[196:199], a[44:47], v[60:63], v[196:199]
    s_waitcnt vmcnt(1)
    v_mfma_f32_16x16x32_bf16 v[168:171], a[48:51], v[64:67], v[168:171]
    v_mfma_f32_16x16x32_bf16 v[172:175], a[48:51], v[68:71], v[172:175]
    v_mfma_f32_16x16x32_bf16 v[184:187], a[56:59], v[64:67], v[184:187]
    v_mfma_f32_16x16x32_bf16 v[188:191], a[56:59], v[68:71], v[188:191]
    v_mfma_f32_16x16x32_bf16 v[176:179], a[52:55], v[64:67], v[176:179]
    v_mfma_f32_16x16x32_bf16 v[180:183], a[52:55], v[68:71], v[180:183]
    v_mfma_f32_16x16x32_bf16 v[192:195], a[60:63], v[64:67], v[192:195]
    v_mfma_f32_16x16x32_bf16 v[196:199], a[60:63], v[68:71], v[196:199]
    s_nop 0
    ds_write_b128 v248, v[168:171] offset:32768
    ds_write_b128 v248, v[172:175] offset:33024
    s_waitcnt vmcnt(0)
    s_mov_b64 exec, 4
    s_cmp_eq_u32 s24, 0
    s_cbranch_scc1 Limp_63
    buffer_store_byte v3, off, s[4:7], s43
Lfl_64:
    s_mov_b64 exec, -1
    ds_write_b128 v248, v[176:179] offset:34816
    ds_write_b128 v248, v[180:183] offset:35072
    ds_write_b128 v248, v[184:187] offset:36864
    ds_write_b128 v248, v[188:191] offset:37120
    ds_write_b128 v248, v[192:195] offset:38912
    ds_write_b128 v248, v[196:199] offset:39168
    buffer_load_ubyte v4, v3, s[4:7], s44 offen sc1
    v_pk_add_f32 v[120:121], v[104:105], v[106:107]
    v_pk_mul_f32 v[122:123], v[104:105], v[104:105]
    v_pk_add_f32 v[120:121], v[120:121], v[108:109]
    v_pk_fma_f32 v[122:123], v[106:107], v[106:107], v[122:123]
    v_pk_add_f32 v[120:121], v[120:121], v[110:111]
    v_pk_fma_f32 v[122:123], v[108:109], v[108:109], v[122:123]
    v_add_f32 v120, v120, v121
    v_pk_fma_f32 v[122:123], v[110:111], v[110:111], v[122:123]
    v_add_f32 v122, v122, v123
    v_bfe_u32 v253, v0, 8, 1
    v_lshl_add_u32 v251, v253, 13, v251
    s_cmp_ge_u32 s19, 29
    s_cbranch_scc1 Lskip3_65
    s_waitcnt vmcnt(0)
    v_cmp_gt_u32 vcc, 2, v4
    s_nop 0
    s_cbranch_vccz Lspin_67_r
Lspin_67:
    buffer_load_ubyte v4, v3, s[4:7], s44 offen sc1
    s_sub_u32 s60, s60, 1
    s_cbranch_scc1 K1_fail
    s_waitcnt vmcnt(0)
    v_cmp_gt_u32 vcc, 2, v4
    s_nop 0
    s_cbranch_vccnz Lspin_67
Lspin_67_r:
    s_cmp_eq_u32 s24, 0
    s_cbranch_scc1 Linv_69
Lok_68:
    buffer_load_dwordx4 v[8:11], v5, s[12:15], s72 offen offset:0 sc1
    buffer_load_dwordx4 v[12:15], v5, s[12:15], s72 offen offset:256 sc1
    buffer_load_dwordx4 v[16:19], v5, s[12:15], s72 offen offset:2048 sc1
    buffer_load_dwordx4 v[20:23], v5, s[12:15], s72 offen offset:2304 sc1
    s_add_u32 s72, s72, 4096
    buffer_load_dwordx4 v[24:27], v5, s[12:15], s72 offen offset:0 sc1
    s_waitcnt lgkmcnt(0)
    s_barrier
    ds_read_b128 v[184:187], v249 offset:32768
    ds_read_b128 v[188:191], v249 offset:33280
    ds_read_b128 v[192:195], v249 offset:40960
    ds_read_b128 v[196:199], v249 offset:41472
    ds_read_b128 v[200:203], v249 offset:49152
    ds_read_b128 v[204:207], v249 offset:49664
    ds_read_b128 v[208:211], v249 offset:57344
    ds_read_b128 v[212:215], v249 offset:57856
    buffer_load_dwordx4 v[28:31], v5, s[12:15], s72 offen offset:256 sc1
    buffer_load_dwordx4 v[32:35], v5, s[12:15], s72 offen offset:2048 sc1
    s_add_u32 s42, s42, 131072
    s_add_u32 s45, s45, 8192
    s_add_u32 s43, s43, 512
    v_mov_b32 v216, v250
    v_mov_b32 v217, v251
    ds_read_b128 v[232:235], v1 offset:0
    ds_read_b128 v[236:239], v1 offset:256
    ds_read_b128 v[240:243], v1 offset:1024
    ds_read_b128 v[244:247], v1 offset:1280
    ds_read_b128 v[248:251], v1 offset:2048
    s_add_u32 s44, s44, 512
    s_waitcnt vmcnt(5) lgkmcnt(4)
    v_mfma_f32_16x16x32_bf16 v[136:139], v[232:235], v[8:11], 0
    ds_read_b128 v[252:255], v1 offset:2304
    buffer_load_dwordx4 v[36:39], v5, s[12:15], s72 offen offset:2304 sc1
    v_mfma_f32_16x16x32_bf16 v[140:143], v[232:235], v[12:15], 0
    v_add_f32 v184, v184, v192
    v_add_f32 v185, v185, v193
    s_waitcnt lgkmcnt(4)
    v_mfma_f32_16x16x32_bf16 v[144:147], v[236:239], v[8:11], 0
    ds_read_b128 v[232:235], v1 offset:6144
    v_add_f32 v186, v186, v194
    v_mfma_f32_16x16x32_bf16 v[148:151], v[236:239], v[12:15], 0
    v_add_f32 v187, v187, v195
    v_add_f32 v188, v188, v196
    s_waitcnt lgkmcnt(4)
    v_mfma_f32_16x16x32_bf16 v[152:155], v[240:243], v[8:11], 0
    ds_read_b128 v[236:239], v1 offset:6400
    s_add_u32 s72, s72, 4096
    buffer_load_dwordx4 v[40:43], v5, s[12:15], s72 offen offset:0 sc1
    v_mfma_f32_16x16x32_bf16 v[156:159], v[240:243], v[12:15], 0
    v_add_f32 v189, v189, v197
    v_add_f32 v190, v190, v198
    v_add_f32 v191, v191, v199
    s_waitcnt lgkmcnt(4)
    v_mfma_f32_16x16x32_bf16 v[160:163], v[244:247], v[8:11], 0
    ds_read_b128 v[240:243], v1 offset:7168
    buffer_load_dwordx4 v[44:47], v5, s[12:15], s72 offen offset:256 sc1
    v_mfma_f32_16x16x32_bf16 v[164:167], v[244:247], v[12:15], 0
    v_add_f32 v112, v112, v184
    v_add_f32 v113, v113, v185
    v_add_f32 v114, v114, v186
    s_waitcnt lgkmcnt(4)
    v_mfma_f32_16x16x32_bf16 v[168:171], v[248:251], v[8:11], 0
    ds_read_b128 v[244:247], v1 offset:7424
    v_add_f32 v115, v115, v187
    v_mfma_f32_16x16x32_bf16 v[172:175], v[248:251], v[12:15], 0
    v_add_f32 v116, v116, v188
    v_add_f32 v117, v117, v189
    s_waitcnt lgkmcnt(4)
    v_mfma_f32_16x16x32_bf16 v[176:179], v[252:255], v[8:11], 0
    ds_read_b128 v[248:251], v1 offset:8192
    buffer_load_dwordx4 v[48:51], v5, s[12:15], s72 offen offset:2048 sc1
    v_mfma_f32_16x16x32_bf16 v[180:183], v[252:255], v[12:15], 0
    v_add_f32 v118, v118, v190
    v_add_f32 v119, v119, v191
    s_waitcnt vmcnt(7) lgkmcnt(4)
    v_mfma_f32_16x16x32_bf16 v[136:139], v[232:235], v[16:19], v[136:139]
    ds_read_b128 v[252:255], v1 offset:8448
    v_add_f32 v200, v200, v208
    v_mfma_f32_16x16x32_bf16 v[140:143], v[232:235], v[20:23], v[140:143]
    v_add_f32 v201, v201, v209
    v_add_f32 v202, v202, v210
    s_waitcnt lgkmcnt(4)
    v_mfma_f32_16x16x32_bf16 v[144:147], v[236:239], v[16:19], v[144:147]
    ds_read_b128 v[232:235], v1 offset:12288
    v_add_f32 v203, v203, v211
    v_mfma_f32_16x16x32_bf16 v[148:151], v[236:239], v[20:23], v[148:151]
    v_add_f32 v204, v204, v212
    v_add_f32 v205, v205, v213
    s_waitcnt lgkmcnt(4)
    v_mfma_f32_16x16x32_bf16 v[152:155], v[240:243], v[16:19], v[152:155]
    ds_read_b128 v[236:239], v1 offset:12544
    buffer_load_dwordx4 v[52:55], v5, s[12:15], s72 offen offset:2304 sc1
    v_mfma_f32_16x16x32_bf16 v[156:159], v[240:243], v[20:23], v[156:159]
    v_add_f32 v206, v206, v214
    v_add_f32 v207, v207, v215
    v_add_f32 v112, v112, v200
    s_waitcnt lgkmcnt(4)
    v_mfma_f32_16x16x32_bf16 v[160:163], v[244:247], v[16:19], v[160:163]
    ds_read_b128 v[240:243], v1 offset:13312
    v_add_f32 v113, v113, v201
    v_mfma_f32_16x16x32_bf16 v[164:167], v[244:247], v[20:23], v[164:167]
    v_add_f32 v114, v114, v202
    v_add_f32 v115, v115, v203
    s_waitcnt lgkmcnt(4)
    v_mfma_f32_16x16x32_bf16 v[168:171], v[248:251], v[16:19], v[168:171]
    ds_read_b128 v[244:247], v1 offset:13568
    v_add_f32 v116, v116, v204
    v_mfma_f32_16x16x32_bf16 v[172:175], v[248:251], v[20:23], v[172:175]
    v_add_f32 v117, v117, v205
    v_add_f32 v118, v118, v206
    s_waitcnt lgkmcnt(4)
    v_mfma_f32_16x16x32_bf16 v[176:179], v[252:255], v[16:19], v[176:179]
    ds_read_b128 v[248:251], v1 offset:14336
    s_add_u32 s72, s72, 4096
    buffer_load_dwordx4 v[56:59], v5, s[12:15], s72 offen offset:0 sc1
    v_mfma_f32_16x16x32_bf16 v[180:183], v[252:255], v[20:23], v[180:183]
    v_add_f32 v119, v119, v207
    v_cvt_pk_bf16_f32 v184, v112, v113
    v_cvt_pk_bf16_f32 v185, v114, v115
    s_waitcnt vmcnt(7) lgkmcnt(4)
    v_mfma_f32_16x16x32_bf16 v[136:139], v[232:235], v[24:27], v[136:139]
    ds_read_b128 v[252:255], v1 offset:14592
    v_cvt_pk_bf16_f32 v186, v116, v117
    v_mfma_f32_16x16x32_bf16 v[140:143], v[232:235], v[28:31], v[140:143]
    v_cvt_pk_bf16_f32 v187, v118, v119
    buffer_store_dwordx4 v[184:187], v216, s[12:15], s42 offen
    s_waitcnt lgkmcnt(4)
    v_mfma_f32_16x16x32_bf16 v[144:147], v[236:239], v[24:27], v[144:147]
    ds_read_b128 v[232:235], v1 offset:18432
    v_add_f32 v124, v112, v114
    v_mfma_f32_16x16x32_bf16 v[148:151], v[236:239], v[28:31], v[148:151]
    v_add_f32 v125, v113, v115
    v_mul_f32 v126, v112, v112
    s_waitcnt lgkmcnt(4)
    v_mfma_f32_16x16x32_bf16 v[152:155], v[240:243], v[24:27], v[152:155]
    ds_read_b128 v[236:239], v1 offset:18688
    buffer_load_dwordx4 v[60:63], v5, s[12:15], s72 offen offset:256 sc1
    v_mfma_f32_16x16x32_bf16 v[156:159], v[240:243], v[28:31], v[156:159]
    v_mul_f32 v127, v113, v113
    v_add_f32 v124, v124, v116
    v_add_f32 v125, v125, v117
    s_waitcnt lgkmcnt(4)
    v_mfma_f32_16x16x32_bf16 v[160:163], v[244:247], v[24:27], v[160:163]
    ds_read_b128 v[240:243], v1 offset:19456
    v_fma_f32 v126, v114, v114, v126
    v_mfma_f32_16x16x32_bf16 v[164:167], v[244:247], v[28:31], v[164:167]
    v_fma_f32 v127, v115, v115, v127
    v_add_f32 v124, v124, v118
    s_waitcnt lgkmcnt(4)
    v_mfma_f32_16x16x32_bf16 v[168:171], v[248:251], v[24:27], v[168:171]
    ds_read_b128 v[244:247], v1 offset:19712
    v_add_f32 v125, v125, v119
    v_mfma_f32_16x16x32_bf16 v[172:175], v[248:251], v[28:31], v[172:175]
    v_fma_f32 v126, v116, v116, v126
    v_fma_f32 v127, v117, v117, v127
    s_waitcnt lgkmcnt(4)
    v_mfma_f32_16x16x32_bf16 v[176:179], v[252:255], v[24:27], v[176:179]
    ds_read_b128 v[248:251], v1 offset:20480
    buffer_load_dwordx4 v[64:67], v5, s[12:15], s72 offen offset:2048 sc1
    v_mfma_f32_16x16x32_bf16 v[180:183], v[252:255], v[28:31], v[180:183]
    v_add_f32 v124, v124, v125
    v_fma_f32 v126, v118, v118, v126
    v_fma_f32 v127, v119, v119, v127
    s_waitcnt vmcnt(8) lgkmcnt(4)
    v_mfma_f32_16x16x32_bf16 v[136:139], v[232:235], v[32:35], v[136:139]
    ds_read_b128 v[252:255], v1 offset:20736
    v_add_f32 v126, v126, v127
    v_mfma_f32_16x16x32_bf16 v[140:143], v[232:235], v[36:39], v[140:143]
    v_permlane32_swap_b32 v120, v122
    s_sub_u32 s45, s45, 8192
    s_waitcnt lgkmcnt(4)
    v_mfma_f32_16x16x32_bf16 v[144:147], v[236:239], v[32:35], v[144:147]
    ds_read_b128 v[232:235], v1 offset:24576
    v_permlane32_swap_b32 v124, v126
    v_mfma_f32_16x16x32_bf16 v[148:151], v[236:239], v[36:39], v[148:151]
    v_add_f32 v120, v120, v122
    v_add_f32 v124, v124, v126
    s_waitcnt lgkmcnt(4)
    v_mfma_f32_16x16x32_bf16 v[152:155], v[240:243], v[32:35], v[152:155]
    ds_read_b128 v[236:239], v1 offset:24832
    buffer_load_dwordx4 v[68:71], v5, s[12:15], s72 offen offset:2304 sc1
    v_mfma_f32_16x16x32_bf16 v[156:159], v[240:243], v[36:39], v[156:159]
    v_accvgpr_write_b32 a240, v104
    v_accvgpr_write_b32 a241, v105
    v_permlane16_swap_b32 v120, v124
    s_waitcnt lgkmcnt(4)
    v_mfma_f32_16x16x32_bf16 v[160:163], v[244:247], v[32:35], v[160:163]
    ds_read_b128 v[240:243], v1 offset:25600
    v_add_f32 v120, v120, v124
    v_mfma_f32_16x16x32_bf16 v[164:167], v[244:247], v[36:39], v[164:167]
    v_accvgpr_write_b32 a242, v106
    v_accvgpr_write_b32 a243, v107
    s_waitcnt lgkmcnt(4)
    v_mfma_f32_16x16x32_bf16 v[168:171], v[248:251], v[32:35], v[168:171]
    ds_read_b128 v[244:247], v1 offset:25856
    v_add_f32 v120, v120, v120 row_ror:8 row_mask:0xf bank_mask:0xf
    v_mfma_f32_16x16x32_bf16 v[172:175], v[248:251], v[36:39], v[172:175]
    s_mov_b32 exec_lo, 0x00ff00ff
    s_mov_b32 exec_hi, 0x00ff00ff
    buffer_store_dword v120, v217, s[4:7], s45 offen
    s_mov_b64 exec, -1
    v_accvgpr_write_b32 a244, v108
    s_waitcnt lgkmcnt(4)
    v_mfma_f32_16x16x32_bf16 v[176:179], v[252:255], v[32:35], v[176:179]
    ds_read_b128 v[248:251], v1 offset:26624
    s_add_u32 s72, s72, 4096
    buffer_load_dwordx4 v[72:75], v5, s[12:15], s72 offen offset:0 sc1
    v_mfma_f32_16x16x32_bf16 v[180:183], v[252:255], v[36:39], v[180:183]
    v_accvgpr_write_b32 a245, v109
    v_accvgpr_write_b32 a246, v110
    v_accvgpr_write_b32 a247, v111
    s_waitcnt vmcnt(9) lgkmcnt(4)
    v_mfma_f32_16x16x32_bf16 v[136:139], v[232:235], v[40:43], v[136:139]
    ds_read_b128 v[252:255], v1 offset:26880
    v_accvgpr_write_b32 a248, v112
    v_mfma_f32_16x16x32_bf16 v[140:143], v[232:235], v[44:47], v[140:143]
    v_accvgpr_write_b32 a249, v113
    v_accvgpr_write_b32 a250, v114
    s_waitcnt lgkmcnt(4)
    v_mfma_f32_16x16x32_bf16 v[144:147], v[236:239], v[40:43], v[144:147]
    ds_read_b128 v[232:235], v1 offset:30720
    v_accvgpr_write_b32 a251, v115
    v_mfma_f32_16x16x32_bf16 v[148:151], v[236:239], v[44:47], v[148:151]
    v_accvgpr_write_b32 a252, v116
    v_accvgpr_write_b32 a253, v117
    s_waitcnt lgkmcnt(4)
    v_mfma_f32_16x16x32_bf16 v[152:155], v[240:243], v[40:43], v[152:155]
    ds_read_b128 v[236:239], v1 offset:30976
    buffer_load_dwordx4 v[76:79], v5, s[12:15], s72 offen offset:256 sc1
    v_mfma_f32_16x16x32_bf16 v[156:159], v[240:243], v[44:47], v[156:159]
    v_accvgpr_write_b32 a254, v118
    v_accvgpr_write_b32 a255, v119
    s_waitcnt lgkmcnt(4)
    v_mfma_f32_16x16x32_bf16 v[160:163], v[244:247], v[40:43], v[160:163]
    ds_read_b128 v[240:243], v1 offset:31744
    v_mfma_f32_16x16x32_bf16 v[164:167], v[244:247], v[44:47], v[164:167]
    s_waitcnt lgkmcnt(4)
    v_mfma_f32_16x16x32_bf16 v[168:171], v[248:251], v[40:43], v[168:171]
    ds_read_b128 v[244:247], v1 offset:32000
    v_mfma_f32_16x16x32_bf16 v[172:175], v[248:251], v[44:47], v[172:175]
    s_waitcnt lgkmcnt(4)
    v_mfma_f32_16x16x32_bf16 v[176:179], v[252:255], v[40:43], v[176:179]
    ds_read_b128 v[248:251], v1 offset:32768
    buffer_load_dwordx4 v[80:83], v5, s[12:15], s72 offen offset:2048 sc1
    v_mfma_f32_16x16x32_bf16 v[180:183], v[252:255], v[44:47], v[180:183]
    s_waitcnt vmcnt(9) lgkmcnt(4)
    v_mfma_f32_16x16x32_bf16 v[136:139], v[232:235], v[48:51], v[136:139]
    ds_read_b128 v[252:255], v1 offset:33024
    v_mfma_f32_16x16x32_bf16 v[140:143], v[232:235], v[52:55], v[140:143]
    s_waitcnt lgkmcnt(4)
    v_mfma_f32_16x16x32_bf16 v[144:147], v[236:239], v[48:51], v[144:147]
    ds_read_b128 v[232:235], v1 offset:36864
    v_mfma_f32_16x16x32_bf16 v[148:151], v[236:239], v[52:55], v[148:151]
    s_waitcnt lgkmcnt(4)
    v_mfma_f32_16x16x32_bf16 v[152:155], v[240:243], v[48:51], v[152:155]
    ds_read_b128 v[236:239], v1 offset:37120
    buffer_load_dwordx4 v[84:87], v5, s[12:15], s72 offen offset:2304 sc1
    v_mfma_f32_16x16x32_bf16 v[156:159], v[240:243], v[52:55], v[156:159]
    s_waitcnt lgkmcnt(4)
    v_mfma_f32_16x16x32_bf16 v[160:163], v[244:247], v[48:51], v[160:163]
    ds_read_b128 v[240:243], v1 offset:37888
    v_mfma_f32_16x16x32_bf16 v[164:167], v[244:247], v[52:55], v[164:167]
    s_waitcnt lgkmcnt(4)
    v_mfma_f32_16x16x32_bf16 v[168:171], v[248:251], v[48:51], v[168:171]
    ds_read_b128 v[244:247], v1 offset:38144
    v_mfma_f32_16x16x32_bf16 v[172:175], v[248:251], v[52:55], v[172:175]
    s_waitcnt lgkmcnt(4)
    v_mfma_f32_16x16x32_bf16 v[176:179], v[252:255], v[48:51], v[176:179]
    ds_read_b128 v[248:251], v1 offset:38912
    s_add_u32 s72, s72, 4096
    buffer_load_dwordx4 v[88:91], v5, s[12:15], s72 offen offset:0 sc1
    v_mfma_f32_16x16x32_bf16 v[180:183], v[252:255], v[52:55], v[180:183]
    s_waitcnt vmcnt(8) lgkmcnt(4)
    v_mfma_f32_16x16x32_bf16 v[136:139], v[232:235], v[56:59], v[136:139]
    ds_read_b128 v[252:255], v1 offset:39168
    v_mfma_f32_16x16x32_bf16 v[140:143], v[232:235], v[60:63], v[140:143]
    s_waitcnt lgkmcnt(4)
    v_mfma_f32_16x16x32_bf16 v[144:147], v[236:239], v[56:59], v[144:147]
    ds_read_b128 v[232:235], v1 offset:43008
    v_mfma_f32_16x16x32_bf16 v[148:151], v[236:239], v[60:63], v[148:151]
    s_waitcnt lgkmcnt(4)
    v_mfma_f32_16x16x32_bf16 v[152:155], v[240:243], v[56:59], v[152:155]
    ds_read_b128 v[236:239], v1 offset:43264
    buffer_load_dwordx4 v[92:95], v5, s[12:15], s72 offen offset:256 sc1
    v_mfma_f32_16x16x32_bf16 v[156:159], v[240:243], v[60:63], v[156:159]
    s_waitcnt lgkmcnt(4)
    v_mfma_f32_16x16x32_bf16 v[160:163], v[244:247], v[56:59], v[160:163]
    ds_read_b128 v[240:243], v1 offset:44032
    v_mfma_f32_16x16x32_bf16 v[164:167], v[244:247], v[60:63], v[164:167]
    s_waitcnt lgkmcnt(4)
    v_mfma_f32_16x16x32_bf16 v[168:171], v[248:251], v[56:59], v[168:171]
    ds_read_b128 v[244:247], v1 offset:44288
    v_mfma_f32_16x16x32_bf16 v[172:175], v[248:251], v[60:63], v[172:175]
    s_waitcnt lgkmcnt(4)
    v_mfma_f32_16x16x32_bf16 v[176:179], v[252:255], v[56:59], v[176:179]
    ds_read_b128 v[248:251], v1 offset:45056
    buffer_load_dwordx4 v[96:99], v5, s[12:15], s72 offen offset:2048 sc1
    v_mfma_f32_16x16x32_bf16 v[180:183], v[252:255], v[60:63], v[180:183]
    s_waitcnt vmcnt(8) lgkmcnt(4)
    v_mfma_f32_16x16x32_bf16 v[136:139], v[232:235], v[64:67], v[136:139]
    ds_read_b128 v[252:255], v1 offset:45312
    v_mfma_f32_16x16x32_bf16 v[140:143], v[232:235], v[68:71], v[140:143]
    s_waitcnt lgkmcnt(4)
    v_mfma_f32_16x16x32_bf16 v[144:147], v[236:239], v[64:67], v[144:147]
    ds_read_b128 v[232:235], v2 offset:0
    s_waitcnt vmcnt(7)
    s_mov_b64 exec, 4
    s_cmp_eq_u32 s24, 0
    s_cbranch_scc1 Limp_70
    buffer_store_byte v3, off, s[4:7], s43
Lfl_71:
    s_mov_b64 exec, -1
    v_mfma_f32_16x16x32_bf16 v[148:151], v[236:239], v[68:71], v[148:151]
    s_waitcnt lgkmcnt(4)
    v_mfma_f32_16x16x32_bf16 v[152:155], v[240:243], v[64:67], v[152:155]
    ds_read_b128 v[236:239], v2 offset:256
    buffer_load_dwordx4 v[100:103], v5, s[12:15], s72 offen offset:2304 sc1
    v_mfma_f32_16x16x32_bf16 v[156:159], v[240:243], v[68:71], v[156:159]
    s_waitcnt lgkmcnt(4)
    v_mfma_f32_16x16x32_bf16 v[160:163], v[244:247], v[64:67], v[160:163]
    ds_read_b128 v[240:243], v2 offset:1024
    v_mfma_f32_16x16x32_bf16 v[164:167], v[244:247], v[68:71], v[164:167]
    s_waitcnt lgkmcnt(4)
    v_mfma_f32_16x16x32_bf16 v[168:171], v[248:251], v[64:67], v[168:171]
    ds_read_b128 v[244:247], v2 offset:1280
    v_mfma_f32_16x16x32_bf16 v[172:175], v[248:251], v[68:71], v[172:175]
    s_waitcnt lgkmcnt(4)
    v_mfma_f32_16x16x32_bf16 v[176:179], v[252:255], v[64:67], v[176:179]
    ds_read_b128 v[248:251], v2 offset:2048
    s_add_u32 s72, s72, 4096
    buffer_load_dwordx4 v[104:107], v5, s[12:15], s72 offen offset:0 sc1
    v_mfma_f32_16x16x32_bf16 v[180:183], v[252:255], v[68:71], v[180:183]
    s_waitcnt vmcnt(8) lgkmcnt(4)
    v_mfma_f32_16x16x32_bf16 v[136:139], v[232:235], v[72:75], v[136:139]
    ds_read_b128 v[252:255], v2 offset:2304
    v_mfma_f32_16x16x32_bf16 v[140:143], v[232:235], v[76:79], v[140:143]
    s_waitcnt lgkmcnt(4)
    v_mfma_f32_16x16x32_bf16 v[144:147], v[236:239], v[72:75], v[144:147]
    ds_read_b128 v[232:235], v2 offset:6144
    v_mfma_f32_16x16x32_bf16 v[148:151], v[236:239], v[76:79], v[148:151]
    s_waitcnt lgkmcnt(4)
    v_mfma_f32_16x16x32_bf16 v[152:155], v[240:243], v[72:75], v[152:155]
    ds_read_b128 v[236:239], v2 offset:6400
    buffer_load_dwordx4 v[108:111], v5, s[12:15], s72 offen offset:256 sc1
    v_mfma_f32_16x16x32_bf16 v[156:159], v[240:243], v[76:79], v[156:159]
    s_waitcnt lgkmcnt(4)
    v_mfma_f32_16x16x32_bf16 v[160:163], v[244:247], v[72:75], v[160:163]
    ds_read_b128 v[240:243], v2 offset:7168
IT_9:
    s_cbranch_execz IT_ret
    v_mfma_f32_16x16x32_bf16 v[164:167], v[244:247], v[76:79], v[164:167]
    s_waitcnt lgkmcnt(4)
    v_mfma_f32_16x16x32_bf16 v[168:171], v[248:251], v[72:75], v[168:171]
    ds_read_b128 v[244:247], v2 offset:7424
    v_mfma_f32_16x16x32_bf16 v[172:175], v[248:251], v[76:79], v[172:175]
    s_waitcnt lgkmcnt(4)
    v_mfma_f32_16x16x32_bf16 v[176:179], v[252:255], v[72:75], v[176:179]
    ds_read_b128 v[248:251], v2 offset:8192
    buffer_load_dwordx4 v[112:115], v5, s[12:15], s72 offen offset:2048 sc1
    v_mfma_f32_16x16x32_bf16 v[180:183], v[252:255], v[76:79], v[180:183]
    s_waitcnt vmcnt(8) lgkmcnt(4)
    v_mfma_f32_16x16x32_bf16 v[136:139], v[232:235], v[80:83], v[136:139]
    ds_read_b128 v[252:255], v2 offset:8448
    v_mfma_f32_16x16x32_bf16 v[140:143], v[232:235], v[84:87], v[140:143]
    s_waitcnt lgkmcnt(4)
    v_mfma_f32_16x16x32_bf16 v[144:147], v[236:239], v[80:83], v[144:147]
    ds_read_b128 v[232:235], v2 offset:12288
    v_mfma_f32_16x16x32_bf16 v[148:151], v[236:239], v[84:87], v[148:151]
    s_waitcnt lgkmcnt(4)
    v_mfma_f32_16x16x32_bf16 v[152:155], v[240:243], v[80:83], v[152:155]
    ds_read_b128 v[236:239], v2 offset:12544
    buffer_load_dwordx4 v[116:119], v5, s[12:15], s72 offen offset:2304 sc1
    v_mfma_f32_16x16x32_bf16 v[156:159], v[240:243], v[84:87], v[156:159]
    s_waitcnt lgkmcnt(4)
    v_mfma_f32_16x16x32_bf16 v[160:163], v[244:247], v[80:83], v[160:163]
    ds_read_b128 v[240:243], v2 offset:13312
    buffer_load_ubyte v4, v3, s[4:7], s44 offen sc1
    v_mfma_f32_16x16x32_bf16 v[164:167], v[244:247], v[84:87], v[164:167]
    s_waitcnt lgkmcnt(4)
    v_mfma_f32_16x16x32_bf16 v[168:171], v[248:251], v[80:83], v[168:171]
    ds_read_b128 v[244:247], v2 offset:13568
    v_mfma_f32_16x16x32_bf16 v[172:175], v[248:251], v[84:87], v[172:175]
    s_waitcnt lgkmcnt(4)
    v_mfma_f32_16x16x32_bf16 v[176:179], v[252:255], v[80:83], v[176:179]
    ds_read_b128 v[248:251], v2 offset:14336
    s_add_u32 s72, s72, 4096
    buffer_load_dwordx4 v[120:123], v5, s[12:15], s72 offen offset:0 sc1
    v_mfma_f32_16x16x32_bf16 v[180:183], v[252:255], v[84:87], v[180:183]
    s_waitcnt vmcnt(9) lgkmcnt(4)
    v_mfma_f32_16x16x32_bf16 v[136:139], v[232:235], v[88:91], v[136:139]
    ds_read_b128 v[252:255], v2 offset:14592
    v_mfma_f32_16x16x32_bf16 v[140:143], v[232:235], v[92:95], v[140:143]
    s_waitcnt lgkmcnt(4)
    v_mfma_f32_16x16x32_bf16 v[144:147], v[236:239], v[88:91], v[144:147]
    ds_read_b128 v[232:235], v2 offset:18432
    v_mfma_f32_16x16x32_bf16 v[148:151], v[236:239], v[92:95], v[148:151]
    s_waitcnt lgkmcnt(4)
    v_mfma_f32_16x16x32_bf16 v[152:155], v[240:243], v[88:91], v[152:155]
    ds_read_b128 v[236:239], v2 offset:18688
    buffer_load_dwordx4 v[124:127], v5, s[12:15], s72 offen offset:256 sc1
    v_mfma_f32_16x16x32_bf16 v[156:159], v[240:243], v[92:95], v[156:159]
    s_waitcnt lgkmcnt(4)
    v_mfma_f32_16x16x32_bf16 v[160:163], v[244:247], v[88:91], v[160:163]
    ds_read_b128 v[240:243], v2 offset:19456
    v_mfma_f32_16x16x32_bf16 v[164:167], v[244:247], v[92:95], v[164:167]
    s_waitcnt lgkmcnt(4)
    v_mfma_f32_16x16x32_bf16 v[168:171], v[248:251], v[88:91], v[168:171]
    ds_read_b128 v[244:247], v2 offset:19712
    v_mfma_f32_16x16x32_bf16 v[172:175], v[248:251], v[92:95], v[172:175]
    s_waitcnt lgkmcnt(4)
    v_mfma_f32_16x16x32_bf16 v[176:179], v[252:255], v[88:91], v[176:179]
    ds_read_b128 v[248:251], v2 offset:20480
    buffer_load_dwordx4 v[128:131], v5, s[12:15], s72 offen offset:2048 sc1
    v_mfma_f32_16x16x32_bf16 v[180:183], v[252:255], v[92:95], v[180:183]
    s_waitcnt vmcnt(8) lgkmcnt(4)
    v_mfma_f32_16x16x32_bf16 v[136:139], v[232:235], v[96:99], v[136:139]
    ds_read_b128 v[252:255], v2 offset:20736
    v_mfma_f32_16x16x32_bf16 v[140:143], v[232:235], v[100:103], v[140:143]
    s_waitcnt lgkmcnt(4)
    v_mfma_f32_16x16x32_bf16 v[144:147], v[236:239], v[96:99], v[144:147]
    ds_read_b128 v[232:235], v2 offset:24576
    s_waitcnt vmcnt(3)
    v_cmp_gt_u32 vcc, 2, v4
    s_nop 0
    s_cbranch_vccnz Lspin_72
Lspin_72_r:
    s_cmp_eq_u32 s24, 0
    s_cbranch_scc1 Linv_74
Lok_73:
    v_mfma_f32_16x16x32_bf16 v[148:151], v[236:239], v[100:103], v[148:151]
    s_waitcnt lgkmcnt(4)
    v_mfma_f32_16x16x32_bf16 v[152:155], v[240:243], v[96:99], v[152:155]
    ds_read_b128 v[236:239], v2 offset:24832
    buffer_load_dwordx4 v[132:135], v5, s[12:15], s72 offen offset:2304 sc1
    v_mfma_f32_16x16x32_bf16 v[156:159], v[240:243], v[100:103], v[156:159]
    s_waitcnt lgkmcnt(4)
    v_mfma_f32_16x16x32_bf16 v[160:163], v[244:247], v[96:99], v[160:163]
    ds_read_b128 v[240:243], v2 offset:25600
    v_mfma_f32_16x16x32_bf16 v[164:167], v[244:247], v[100:103], v[164:167]
    s_waitcnt lgkmcnt(4)
    v_mfma_f32_16x16x32_bf16 v[168:171], v[248:251], v[96:99], v[168:171]
    ds_read_b128 v[244:247], v2 offset:25856
    v_mfma_f32_16x16x32_bf16 v[172:175], v[248:251], v[100:103], v[172:175]
    s_waitcnt lgkmcnt(4)
    v_mfma_f32_16x16x32_bf16 v[176:179], v[252:255], v[96:99], v[176:179]
    ds_read_b128 v[248:251], v2 offset:26624
    buffer_load_dwordx4 v[8:11], v5, s[12:15], s73 offen offset:0 sc1
    v_mfma_f32_16x16x32_bf16 v[180:183], v[252:255], v[100:103], v[180:183]
    s_waitcnt lgkmcnt(4)
    v_mfma_f32_16x16x32_bf16 v[136:139], v[232:235], v[104:107], v[136:139]
    ds_read_b128 v[252:255], v2 offset:26880
    v_mfma_f32_16x16x32_bf16 v[140:143], v[232:235], v[108:111], v[140:143]
    s_waitcnt lgkmcnt(4)
    v_mfma_f32_16x16x32_bf16 v[144:147], v[236:239], v[104:107], v[144:147]
    ds_read_b128 v[232:235], v2 offset:30720
    v_mfma_f32_16x16x32_bf16 v[148:151], v[236:239], v[108:111], v[148:151]
    s_waitcnt lgkmcnt(4)
    v_mfma_f32_16x16x32_bf16 v[152:155], v[240:243], v[104:107], v[152:155]
    ds_read_b128 v[236:239], v2 offset:30976
    buffer_load_dwordx4 v[12:15], v5, s[12:15], s73 offen offset:256 sc1
    v_mfma_f32_16x16x32_bf16 v[156:159], v[240:243], v[108:111], v[156:159]
    s_waitcnt lgkmcnt(4)
    v_mfma_f32_16x16x32_bf16 v[160:163], v[244:247], v[104:107], v[160:163]
    ds_read_b128 v[240:243], v2 offset:31744
    v_mfma_f32_16x16x32_bf16 v[164:167], v[244:247], v[108:111], v[164:167]
    s_waitcnt lgkmcnt(4)
    v_mfma_f32_16x16x32_bf16 v[168:171], v[248:251], v[104:107], v[168:171]
    ds_read_b128 v[244:247], v2 offset:32000
    v_mfma_f32_16x16x32_bf16 v[172:175], v[248:251], v[108:111], v[172:175]
    s_waitcnt lgkmcnt(4)
    v_mfma_f32_16x16x32_bf16 v[176:179], v[252:255], v[104:107], v[176:179]
    ds_read_b128 v[248:251], v2 offset:32768
    buffer_load_dwordx4 v[16:19], v5, s[12:15], s73 offen offset:2048 sc1
    v_mfma_f32_16x16x32_bf16 v[180:183], v[252:255], v[108:111], v[180:183]
    s_waitcnt lgkmcnt(4)
    v_mfma_f32_16x16x32_bf16 v[136:139], v[232:235], v[112:115], v[136:139]
    ds_read_b128 v[252:255], v2 offset:33024
    v_mfma_f32_16x16x32_bf16 v[140:143], v[232:235], v[116:119], v[140:143]
    s_waitcnt lgkmcnt(4)
    v_mfma_f32_16x16x32_bf16 v[144:147], v[236:239], v[112:115], v[144:147]
    ds_read_b128 v[232:235], v2 offset:36864
    v_mfma_f32_16x16x32_bf16 v[148:151], v[236:239], v[116:119], v[148:151]
    s_waitcnt lgkmcnt(4)
    v_mfma_f32_16x16x32_bf16 v[152:155], v[240:243], v[112:115], v[152:155]
    ds_read_b128 v[236:239], v2 offset:37120
    buffer_load_dwordx4 v[20:23], v5, s[12:15], s73 offen offset:2304 sc1
    v_mfma_f32_16x16x32_bf16 v[156:159], v[240:243], v[116:119], v[156:159]
    s_waitcnt lgkmcnt(4)
    v_mfma_f32_16x16x32_bf16 v[160:163], v[244:247], v[112:115], v[160:163]
    ds_read_b128 v[240:243], v2 offset:37888
    v_mfma_f32_16x16x32_bf16 v[164:167], v[244:247], v[116:119], v[164:167]
    s_waitcnt lgkmcnt(4)
    v_mfma_f32_16x16x32_bf16 v[168:171], v[248:251], v[112:115], v[168:171]
    ds_read_b128 v[244:247], v2 offset:38144
    v_mfma_f32_16x16x32_bf16 v[172:175], v[248:251], v[116:119], v[172:175]
    s_waitcnt lgkmcnt(4)
    v_mfma_f32_16x16x32_bf16 v[176:179], v[252:255], v[112:115], v[176:179]
    ds_read_b128 v[248:251], v2 offset:38912
    s_add_u32 s73, s73, 4096
    buffer_load_dwordx4 v[24:27], v5, s[12:15], s73 offen offset:0 sc1
    v_mfma_f32_16x16x32_bf16 v[180:183], v[252:255], v[116:119], v[180:183]
    s_waitcnt vmcnt(7) lgkmcnt(4)
    v_mfma_f32_16x16x32_bf16 v[136:139], v[232:235], v[120:123], v[136:139]
    ds_read_b128 v[252:255], v2 offset:39168
    v_mfma_f32_16x16x32_bf16 v[140:143], v[232:235], v[124:127], v[140:143]
    s_waitcnt lgkmcnt(4)
    v_mfma_f32_16x16x32_bf16 v[144:147], v[236:239], v[120:123], v[144:147]
    ds_read_b128 v[232:235], v2 offset:43008
    v_mfma_f32_16x16x32_bf16 v[148:151], v[236:239], v[124:127], v[148:151]
    s_waitcnt lgkmcnt(4)
    v_mfma_f32_16x16x32_bf16 v[152:155], v[240:243], v[120:123], v[152:155]
    ds_read_b128 v[236:239], v2 offset:43264
    buffer_load_dwordx4 v[28:31], v5, s[12:15], s73 offen offset:256 sc1
    v_mfma_f32_16x16x32_bf16 v[156:159], v[240:243], v[124:127], v[156:159]
    s_waitcnt lgkmcnt(4)
    v_mfma_f32_16x16x32_bf16 v[160:163], v[244:247], v[120:123], v[160:163]
    ds_read_b128 v[240:243], v2 offset:44032
    v_mfma_f32_16x16x32_bf16 v[164:167], v[244:247], v[124:127], v[164:167]
    s_waitcnt lgkmcnt(4)
    v_mfma_f32_16x16x32_bf16 v[168:171], v[248:251], v[120:123], v[168:171]
    ds_read_b128 v[244:247], v2 offset:44288
    v_mfma_f32_16x16x32_bf16 v[172:175], v[248:251], v[124:127], v[172:175]
    s_waitcnt lgkmcnt(4)
    v_mfma_f32_16x16x32_bf16 v[176:179], v[252:255], v[120:123], v[176:179]
    ds_read_b128 v[248:251], v2 offset:45056
    buffer_load_dwordx4 v[32:35], v5, s[12:15], s73 offen offset:2048 sc1
    v_mfma_f32_16x16x32_bf16 v[180:183], v[252:255], v[124:127], v[180:183]
    s_waitcnt vmcnt(7) lgkmcnt(4)
    v_mfma_f32_16x16x32_bf16 v[136:139], v[232:235], v[128:131], v[136:139]
    ds_read_b128 v[252:255], v2 offset:45312
    v_mfma_f32_16x16x32_bf16 v[140:143], v[232:235], v[132:135], v[140:143]
    s_waitcnt lgkmcnt(4)
    v_mfma_f32_16x16x32_bf16 v[144:147], v[236:239], v[128:131], v[144:147]
    ds_read_b128 v[232:235], v1 offset:0
    v_mfma_f32_16x16x32_bf16 v[148:151], v[236:239], v[132:135], v[148:151]
    s_waitcnt lgkmcnt(4)
    v_mfma_f32_16x16x32_bf16 v[152:155], v[240:243], v[128:131], v[152:155]
    ds_read_b128 v[236:239], v1 offset:256
    buffer_load_dwordx4 v[36:39], v5, s[12:15], s73 offen offset:2304 sc1
    v_mfma_f32_16x16x32_bf16 v[156:159], v[240:243], v[132:135], v[156:159]
    s_waitcnt lgkmcnt(4)
    v_mfma_f32_16x16x32_bf16 v[160:163], v[244:247], v[128:131], v[160:163]
    ds_read_b128 v[240:243], v1 offset:1024
    v_mfma_f32_16x16x32_bf16 v[164:167], v[244:247], v[132:135], v[164:167]
    s_waitcnt lgkmcnt(4)
    v_mfma_f32_16x16x32_bf16 v[168:171], v[248:251], v[128:131], v[168:171]
    ds_read_b128 v[244:247], v1 offset:1280
    v_mfma_f32_16x16x32_bf16 v[172:175], v[248:251], v[132:135], v[172:175]
    s_waitcnt lgkmcnt(4)
    v_mfma_f32_16x16x32_bf16 v[176:179], v[252:255], v[128:131], v[176:179]
    ds_read_b128 v[248:251], v1 offset:2048
    s_add_u32 s73, s73, 4096
    buffer_load_dwordx4 v[40:43], v5, s[12:15], s73 offen offset:0 sc1
    v_mfma_f32_16x16x32_bf16 v[180:183], v[252:255], v[132:135], v[180:183]
    s_waitcnt vmcnt(7) lgkmcnt(4)
    v_mfma_f32_16x16x32_bf16 v[184:187], v[232:235], v[8:11], 0
    ds_read_b128 v[252:255], v1 offset:2304
    v_mfma_f32_16x16x32_bf16 v[188:191], v[232:235], v[12:15], 0
    s_waitcnt lgkmcnt(4)
    v_mfma_f32_16x16x32_bf16 v[192:195], v[236:239], v[8:11], 0
    ds_read_b128 v[232:235], v1 offset:6144
    v_mfma_f32_16x16x32_bf16 v[196:199], v[236:239], v[12:15], 0
    s_waitcnt lgkmcnt(4)
    v_mfma_f32_16x16x32_bf16 v[200:203], v[240:243], v[8:11], 0
    ds_read_b128 v[236:239], v1 offset:6400
    buffer_load_dwordx4 v[44:47], v5, s[12:15], s73 offen offset:256 sc1
    v_mfma_f32_16x16x32_bf16 v[204:207], v[240:243], v[12:15], 0
    s_waitcnt lgkmcnt(4)
    v_mfma_f32_16x16x32_bf16 v[208:211], v[244:247], v[8:11], 0
    ds_read_b128 v[240:243], v1 offset:7168
    v_max_f32 v136, 0, v136
    v_mfma_f32_16x16x32_bf16 v[212:215], v[244:247], v[12:15], 0
    v_max_f32 v137, 0, v137
    v_max_f32 v138, 0, v138
    s_waitcnt lgkmcnt(4)
    v_mfma_f32_16x16x32_bf16 v[216:219], v[248:251], v[8:11], 0
    ds_read_b128 v[244:247], v1 offset:7424
    v_max_f32 v139, 0, v139
    v_mfma_f32_16x16x32_bf16 v[220:223], v[248:251], v[12:15], 0
    v_max_f32 v140, 0, v140
    v_max_f32 v141, 0, v141
    s_waitcnt lgkmcnt(4)
    v_mfma_f32_16x16x32_bf16 v[224:227], v[252:255], v[8:11], 0
    ds_read_b128 v[248:251], v1 offset:8192
    buffer_load_dwordx4 v[48:51], v5, s[12:15], s73 offen offset:2048 sc1
    v_mfma_f32_16x16x32_bf16 v[228:231], v[252:255], v[12:15], 0
    v_max_f32 v142, 0, v142
    v_max_f32 v143, 0, v143
    v_mul_f32 v136, v136, v144
    s_waitcnt vmcnt(7) lgkmcnt(4)
    v_mfma_f32_16x16x32_bf16 v[184:187], v[232:235], v[16:19], v[184:187]
    ds_read_b128 v[252:255], v1 offset:8448
    v_mul_f32 v137, v137, v145
    v_mfma_f32_16x16x32_bf16 v[188:191], v[232:235], v[20:23], v[188:191]
    v_mul_f32 v138, v138, v146
    v_mul_f32 v139, v139, v147
    s_waitcnt lgkmcnt(4)
    v_mfma_f32_16x16x32_bf16 v[192:195], v[236:239], v[16:19], v[192:195]
    ds_read_b128 v[232:235], v1 offset:12288
    v_mul_f32 v140, v140, v148
    v_mfma_f32_16x16x32_bf16 v[196:199], v[236:239], v[20:23], v[196:199]
    v_mul_f32 v141, v141, v149
    v_mul_f32 v142, v142, v150
    s_waitcnt lgkmcnt(4)
    v_mfma_f32_16x16x32_bf16 v[200:203], v[240:243], v[16:19], v[200:203]
    ds_read_b128 v[236:239], v1 offset:12544
    buffer_load_dwordx4 v[52:55], v5, s[12:15], s73 offen offset:2304 sc1
    v_mfma_f32_16x16x32_bf16 v[204:207], v[240:243], v[20:23], v[204:207]
    v_mul_f32 v143, v143, v151
    v_cvt_pk_bf16_f32 v136, v136, v137
    v_cvt_pk_bf16_f32 v137, v138, v139
    s_waitcnt lgkmcnt(4)
    v_mfma_f32_16x16x32_bf16 v[208:211], v[244:247], v[16:19], v[208:211]
    ds_read_b128 v[240:243], v1 offset:13312
    v_cvt_pk_bf16_f32 v138, v140, v141
    v_mfma_f32_16x16x32_bf16 v[212:215], v[244:247], v[20:23], v[212:215]
    v_cvt_pk_bf16_f32 v139, v142, v143
    v_permlane16_swap_b32 v136, v138
    s_waitcnt lgkmcnt(4)
    v_mfma_f32_16x16x32_bf16 v[216:219], v[248:251], v[16:19], v[216:219]
    ds_read_b128 v[244:247], v1 offset:13568
    v_permlane16_swap_b32 v137, v139
    v_mfma_f32_16x16x32_bf16 v[220:223], v[248:251], v[20:23], v[220:223]
    buffer_store_dwordx4 v[136:139], v0, s[92:95], s47 offen offset:0
    v_max_f32 v152, 0, v152
    s_waitcnt lgkmcnt(4)
    v_mfma_f32_16x16x32_bf16 v[224:227], v[252:255], v[16:19], v[224:227]
    ds_read_b128 v[248:251], v1 offset:14336
    s_add_u32 s73, s73, 4096
    buffer_load_dwordx4 v[56:59], v5, s[12:15], s73 offen offset:0 sc1
    v_mfma_f32_16x16x32_bf16 v[228:231], v[252:255], v[20:23], v[228:231]
    v_max_f32 v153, 0, v153
    v_max_f32 v154, 0, v154
    v_max_f32 v155, 0, v155
    s_waitcnt vmcnt(8) lgkmcnt(4)
    v_mfma_f32_16x16x32_bf16 v[184:187], v[232:235], v[24:27], v[184:187]
    ds_read_b128 v[252:255], v1 offset:14592
    v_max_f32 v156, 0, v156
    v_mfma_f32_16x16x32_bf16 v[188:191], v[232:235], v[28:31], v[188:191]
    v_max_f32 v157, 0, v157
    v_max_f32 v158, 0, v158
    s_waitcnt lgkmcnt(4)
    v_mfma_f32_16x16x32_bf16 v[192:195], v[236:239], v[24:27], v[192:195]
    ds_read_b128 v[232:235], v1 offset:18432
    v_max_f32 v159, 0, v159
    v_mfma_f32_16x16x32_bf16 v[196:199], v[236:239], v[28:31], v[196:199]
    v_mul_f32 v152, v152, v160
    v_mul_f32 v153, v153, v161
    s_waitcnt lgkmcnt(4)
    v_mfma_f32_16x16x32_bf16 v[200:203], v[240:243], v[24:27], v[200:203]
    ds_read_b128 v[236:239], v1 offset:18688
    buffer_load_dwordx4 v[60:63], v5, s[12:15], s73 offen offset:256 sc1
    v_mfma_f32_16x16x32_bf16 v[204:207], v[240:243], v[28:31], v[204:207]
    v_mul_f32 v154, v154, v162
    v_mul_f32 v155, v155, v163
    v_mul_f32 v156, v156, v164
    s_waitcnt lgkmcnt(4)
    v_mfma_f32_16x16x32_bf16 v[208:211], v[244:247], v[24:27], v[208:211]
    ds_read_b128 v[240:243], v1 offset:19456
    v_mul_f32 v157, v157, v165
    v_mfma_f32_16x16x32_bf16 v[212:215], v[244:247], v[28:31], v[212:215]
    v_mul_f32 v158, v158, v166
    v_mul_f32 v159, v159, v167
    s_waitcnt lgkmcnt(4)
    v_mfma_f32_16x16x32_bf16 v[216:219], v[248:251], v[24:27], v[216:219]
    ds_read_b128 v[244:247], v1 offset:19712
    v_cvt_pk_bf16_f32 v152, v152, v153
    v_mfma_f32_16x16x32_bf16 v[220:223], v[248:251], v[28:31], v[220:223]
    v_cvt_pk_bf16_f32 v153, v154, v155
    v_cvt_pk_bf16_f32 v154, v156, v157
    s_waitcnt lgkmcnt(4)
    v_mfma_f32_16x16x32_bf16 v[224:227], v[252:255], v[24:27], v[224:227]
    ds_read_b128 v[248:251], v1 offset:20480
    buffer_load_dwordx4 v[64:67], v5, s[12:15], s73 offen offset:2048 sc1
    v_mfma_f32_16x16x32_bf16 v[228:231], v[252:255], v[28:31], v[228:231]
    v_cvt_pk_bf16_f32 v155, v158, v159
    v_permlane16_swap_b32 v152, v154
    s_nop 0
    v_permlane16_swap_b32 v153, v155
    s_waitcnt vmcnt(8) lgkmcnt(4)
    v_mfma_f32_16x16x32_bf16 v[184:187], v[232:235], v[32:35], v[184:187]
    ds_read_b128 v[252:255], v1 offset:20736
    buffer_store_dwordx4 v[152:155], v0, s[92:95], s47 offen offset:1024
    v_mfma_f32_16x16x32_bf16 v[188:191], v[232:235], v[36:39], v[188:191]
    v_max_f32 v168, 0, v168
    v_max_f32 v169, 0, v169
    s_waitcnt lgkmcnt(4)
    v_mfma_f32_16x16x32_bf16 v[192:195], v[236:239], v[32:35], v[192:195]
    ds_read_b128 v[232:235], v1 offset:24576
    v_max_f32 v170, 0, v170
    v_mfma_f32_16x16x32_bf16 v[196:199], v[236:239], v[36:39], v[196:199]
    v_max_f32 v171, 0, v171
    v_max_f32 v172, 0, v172
    s_waitcnt lgkmcnt(4)
    v_mfma_f32_16x16x32_bf16 v[200:203], v[240:243], v[32:35], v[200:203]
    ds_read_b128 v[236:239], v1 offset:24832
    buffer_load_dwordx4 v[68:71], v5, s[12:15], s73 offen offset:2304 sc1
    v_mfma_f32_16x16x32_bf16 v[204:207], v[240:243], v[36:39], v[204:207]
    v_max_f32 v173, 0, v173
    v_max_f32 v174, 0, v174
    v_max_f32 v175, 0, v175
    s_waitcnt lgkmcnt(4)
    v_mfma_f32_16x16x32_bf16 v[208:211], v[244:247], v[32:35], v[208:211]
    ds_read_b128 v[240:243], v1 offset:25600
    v_mul_f32 v168, v168, v176
    v_mfma_f32_16x16x32_bf16 v[212:215], v[244:247], v[36:39], v[212:215]
    v_mul_f32 v169, v169, v177
    v_mul_f32 v170, v170, v178
    s_waitcnt lgkmcnt(4)
    v_mfma_f32_16x16x32_bf16 v[216:219], v[248:251], v[32:35], v[216:219]
    ds_read_b128 v[244:247], v1 offset:25856
    v_mul_f32 v171, v171, v179
    v_mfma_f32_16x16x32_bf16 v[220:223], v[248:251], v[36:39], v[220:223]
    v_mul_f32 v172, v172, v180
    v_mul_f32 v173, v173, v181
    s_waitcnt lgkmcnt(4)
    v_mfma_f32_16x16x32_bf16 v[224:227], v[252:255], v[32:35], v[224:227]
    ds_read_b128 v[248:251], v1 offset:26624
    s_add_u32 s73, s73, 4096
    buffer_load_dwordx4 v[72:75], v5, s[12:15], s73 offen offset:0 sc1
    v_mfma_f32_16x16x32_bf16 v[228:231], v[252:255], v[36:39], v[228:231]
    v_mul_f32 v174, v174, v182
    v_mul_f32 v175, v175, v183
    v_cvt_pk_bf16_f32 v168, v168, v169
    s_waitcnt vmcnt(9) lgkmcnt(4)
    v_mfma_f32_16x16x32_bf16 v[184:187], v[232:235], v[40:43], v[184:187]
    ds_read_b128 v[252:255], v1 offset:26880
    v_cvt_pk_bf16_f32 v169, v170, v171
    v_mfma_f32_16x16x32_bf16 v[188:191], v[232:235], v[44:47], v[188:191]
    v_cvt_pk_bf16_f32 v170, v172, v173
    v_cvt_pk_bf16_f32 v171, v174, v175
    s_waitcnt lgkmcnt(4)
    v_mfma_f32_16x16x32_bf16 v[192:195], v[236:239], v[40:43], v[192:195]
    ds_read_b128 v[232:235], v1 offset:30720
    v_permlane16_swap_b32 v168, v170
    v_mfma_f32_16x16x32_bf16 v[196:199], v[236:239], v[44:47], v[196:199]
    v_permlane16_swap_b32 v169, v171
    buffer_store_dwordx4 v[168:171], v0, s[92:95], s47 offen offset:2048
    s_waitcnt lgkmcnt(4)
    v_mfma_f32_16x16x32_bf16 v[200:203], v[240:243], v[40:43], v[200:203]
    ds_read_b128 v[236:239], v1 offset:30976
    buffer_load_dwordx4 v[76:79], v5, s[12:15], s73 offen offset:256 sc1
    v_mfma_f32_16x16x32_bf16 v[204:207], v[240:243], v[44:47], v[204:207]
    s_waitcnt lgkmcnt(4)
    v_mfma_f32_16x16x32_bf16 v[208:211], v[244:247], v[40:43], v[208:211]
    ds_read_b128 v[240:243], v1 offset:31744
    v_mfma_f32_16x16x32_bf16 v[212:215], v[244:247], v[44:47], v[212:215]
    s_waitcnt lgkmcnt(4)
    v_mfma_f32_16x16x32_bf16 v[216:219], v[248:251], v[40:43], v[216:219]
    ds_read_b128 v[244:247], v1 offset:32000
    v_mfma_f32_16x16x32_bf16 v[220:223], v[248:251], v[44:47], v[220:223]
    s_waitcnt lgkmcnt(4)
    v_mfma_f32_16x16x32_bf16 v[224:227], v[252:255], v[40:43], v[224:227]
    ds_read_b128 v[248:251], v1 offset:32768
    buffer_load_dwordx4 v[80:83], v5, s[12:15], s73 offen offset:2048 sc1
    v_mfma_f32_16x16x32_bf16 v[228:231], v[252:255], v[44:47], v[228:231]
    s_waitcnt vmcnt(10) lgkmcnt(4)
    v_mfma_f32_16x16x32_bf16 v[184:187], v[232:235], v[48:51], v[184:187]
    ds_read_b128 v[252:255], v1 offset:33024
    v_mfma_f32_16x16x32_bf16 v[188:191], v[232:235], v[52:55], v[188:191]
    s_waitcnt lgkmcnt(4)
    v_mfma_f32_16x16x32_bf16 v[192:195], v[236:239], v[48:51], v[192:195]
    ds_read_b128 v[232:235], v1 offset:36864
    v_mfma_f32_16x16x32_bf16 v[196:199], v[236:239], v[52:55], v[196:199]
    s_waitcnt lgkmcnt(4)
    v_mfma_f32_16x16x32_bf16 v[200:203], v[240:243], v[48:51], v[200:203]
    ds_read_b128 v[236:239], v1 offset:37120
    buffer_load_dwordx4 v[84:87], v5, s[12:15], s73 offen offset:2304 sc1
    v_mfma_f32_16x16x32_bf16 v[204:207], v[240:243], v[52:55], v[204:207]
    s_waitcnt lgkmcnt(4)
    v_mfma_f32_16x16x32_bf16 v[208:211], v[244:247], v[48:51], v[208:211]
    ds_read_b128 v[240:243], v1 offset:37888
    v_mfma_f32_16x16x32_bf16 v[212:215], v[244:247], v[52:55], v[212:215]
    s_waitcnt lgkmcnt(4)
    v_mfma_f32_16x16x32_bf16 v[216:219], v[248:251], v[48:51], v[216:219]
    ds_read_b128 v[244:247], v1 offset:38144
    v_mfma_f32_16x16x32_bf16 v[220:223], v[248:251], v[52:55], v[220:223]
    s_waitcnt lgkmcnt(4)
    v_mfma_f32_16x16x32_bf16 v[224:227], v[252:255], v[48:51], v[224:227]
    ds_read_b128 v[248:251], v1 offset:38912
    s_add_u32 s73, s73, 4096
    buffer_load_dwordx4 v[88:91], v5, s[12:15], s73 offen offset:0 sc1
    v_mfma_f32_16x16x32_bf16 v[228:231], v[252:255], v[52:55], v[228:231]
    s_waitcnt vmcnt(9) lgkmcnt(4)
    v_mfma_f32_16x16x32_bf16 v[184:187], v[232:235], v[56:59], v[184:187]
    ds_read_b128 v[252:255], v1 offset:39168
    s_waitcnt vmcnt(4)
    s_mov_b64 exec, 4
    s_cmp_eq_u32 s24, 0
    s_cbranch_scc1 Limp_75
    buffer_store_byte v3, off, s[4:7], s48
Lfl_76:
    s_mov_b64 exec, -1
    v_mfma_f32_16x16x32_bf16 v[188:191], v[232:235], v[60:63], v[188:191]
    s_waitcnt lgkmcnt(4)
    v_mfma_f32_16x16x32_bf16 v[192:195], v[236:239], v[56:59], v[192:195]
    ds_read_b128 v[232:235], v1 offset:43008
    v_mfma_f32_16x16x32_bf16 v[196:199], v[236:239], v[60:63], v[196:199]
    s_waitcnt lgkmcnt(4)
    v_mfma_f32_16x16x32_bf16 v[200:203], v[240:243], v[56:59], v[200:203]
    ds_read_b128 v[236:239], v1 offset:43264
    buffer_load_dwordx4 v[92:95], v5, s[12:15], s73 offen offset:256 sc1
    v_mfma_f32_16x16x32_bf16 v[204:207], v[240:243], v[60:63], v[204:207]
    s_waitcnt lgkmcnt(4)
    v_mfma_f32_16x16x32_bf16 v[208:211], v[244:247], v[56:59], v[208:211]
    ds_read_b128 v[240:243], v1 offset:44032
    v_mfma_f32_16x16x32_bf16 v[212:215], v[244:247], v[60:63], v[212:215]
    s_waitcnt lgkmcnt(4)
    v_mfma_f32_16x16x32_bf16 v[216:219], v[248:251], v[56:59], v[216:219]
    ds_read_b128 v[244:247], v1 offset:44288
    v_mfma_f32_16x16x32_bf16 v[220:223], v[248:251], v[60:63], v[220:223]
    s_waitcnt lgkmcnt(4)
    v_mfma_f32_16x16x32_bf16 v[224:227], v[252:255], v[56:59], v[224:227]
    ds_read_b128 v[248:251], v1 offset:45056
    buffer_load_dwordx4 v[96:99], v5, s[12:15], s73 offen offset:2048 sc1
    v_mfma_f32_16x16x32_bf16 v[228:231], v[252:255], v[60:63], v[228:231]
    s_waitcnt lgkmcnt(4)
    v_mfma_f32_16x16x32_bf16 v[184:187], v[232:235], v[64:67], v[184:187]
    ds_read_b128 v[252:255], v1 offset:45312
    v_mfma_f32_16x16x32_bf16 v[188:191], v[232:235], v[68:71], v[188:191]
    s_waitcnt lgkmcnt(4)
    v_mfma_f32_16x16x32_bf16 v[192:195], v[236:239], v[64:67], v[192:195]
    ds_read_b128 v[232:235], v2 offset:0
    v_mfma_f32_16x16x32_bf16 v[196:199], v[236:239], v[68:71], v[196:199]
    s_waitcnt lgkmcnt(4)
    v_mfma_f32_16x16x32_bf16 v[200:203], v[240:243], v[64:67], v[200:203]
    ds_read_b128 v[236:239], v2 offset:256
    buffer_load_dwordx4 v[100:103], v5, s[12:15], s73 offen offset:2304 sc1
    v_mfma_f32_16x16x32_bf16 v[204:207], v[240:243], v[68:71], v[204:207]
    s_waitcnt lgkmcnt(4)
    v_mfma_f32_16x16x32_bf16 v[208:211], v[244:247], v[64:67], v[208:211]
    ds_read_b128 v[240:243], v2 offset:1024
    v_mfma_f32_16x16x32_bf16 v[212:215], v[244:247], v[68:71], v[212:215]
    s_waitcnt lgkmcnt(4)
    v_mfma_f32_16x16x32_bf16 v[216:219], v[248:251], v[64:67], v[216:219]
    ds_read_b128 v[244:247], v2 offset:1280
    v_mfma_f32_16x16x32_bf16 v[220:223], v[248:251], v[68:71], v[220:223]
    s_waitcnt lgkmcnt(4)
    v_mfma_f32_16x16x32_bf16 v[224:227], v[252:255], v[64:67], v[224:227]
    ds_read_b128 v[248:251], v2 offset:2048
    s_add_u32 s73, s73, 4096
    buffer_load_dwordx4 v[104:107], v5, s[12:15], s73 offen offset:0 sc1
    v_mfma_f32_16x16x32_bf16 v[228:231], v[252:255], v[68:71], v[228:231]
    s_waitcnt vmcnt(8) lgkmcnt(4)
    v_mfma_f32_16x16x32_bf16 v[184:187], v[232:235], v[72:75], v[184:187]
    ds_read_b128 v[252:255], v2 offset:2304
    v_mfma_f32_16x16x32_bf16 v[188:191], v[232:235], v[76:79], v[188:191]
    s_waitcnt lgkmcnt(4)
    v_mfma_f32_16x16x32_bf16 v[192:195], v[236:239], v[72:75], v[192:195]
    ds_read_b128 v[232:235], v2 offset:6144
    v_mfma_f32_16x16x32_bf16 v[196:199], v[236:239], v[76:79], v[196:199]
    s_waitcnt lgkmcnt(4)
    v_mfma_f32_16x16x32_bf16 v[200:203], v[240:243], v[72:75], v[200:203]
    ds_read_b128 v[236:239], v2 offset:6400
    buffer_load_dwordx4 v[108:111], v5, s[12:15], s73 offen offset:256 sc1
    v_mfma_f32_16x16x32_bf16 v[204:207], v[240:243], v[76:79], v[204:207]
    s_waitcnt lgkmcnt(4)
    v_mfma_f32_16x16x32_bf16 v[208:211], v[244:247], v[72:75], v[208:211]
    ds_read_b128 v[240:243], v2 offset:7168
    buffer_load_ubyte v4, v6, s[4:7], s58 offen sc1
    v_mfma_f32_16x16x32_bf16 v[212:215], v[244:247], v[76:79], v[212:215]
    s_waitcnt lgkmcnt(4)
    v_mfma_f32_16x16x32_bf16 v[216:219], v[248:251], v[72:75], v[216:219]
    ds_read_b128 v[244:247], v2 offset:7424
    v_mfma_f32_16x16x32_bf16 v[220:223], v[248:251], v[76:79], v[220:223]
    s_waitcnt lgkmcnt(4)
    v_mfma_f32_16x16x32_bf16 v[224:227], v[252:255], v[72:75], v[224:227]
    ds_read_b128 v[248:251], v2 offset:8192
    buffer_load_dwordx4 v[112:115], v5, s[12:15], s73 offen offset:2048 sc1
    v_mfma_f32_16x16x32_bf16 v[228:231], v[252:255], v[76:79], v[228:231]
    s_waitcnt vmcnt(9) lgkmcnt(4)
    v_mfma_f32_16x16x32_bf16 v[184:187], v[232:235], v[80:83], v[184:187]
    ds_read_b128 v[252:255], v2 offset:8448
    v_mfma_f32_16x16x32_bf16 v[188:191], v[232:235], v[84:87], v[188:191]
    s_waitcnt lgkmcnt(4)
    v_mfma_f32_16x16x32_bf16 v[192:195], v[236:239], v[80:83], v[192:195]
    ds_read_b128 v[232:235], v2 offset:12288
    v_mfma_f32_16x16x32_bf16 v[196:199], v[236:239], v[84:87], v[196:199]
    s_waitcnt lgkmcnt(4)
    v_mfma_f32_16x16x32_bf16 v[200:203], v[240:243], v[80:83], v[200:203]
    ds_read_b128 v[236:239], v2 offset:12544
    buffer_load_dwordx4 v[116:119], v5, s[12:15], s73 offen offset:2304 sc1
    v_mfma_f32_16x16x32_bf16 v[204:207], v[240:243], v[84:87], v[204:207]
    s_waitcnt lgkmcnt(4)
    v_mfma_f32_16x16x32_bf16 v[208:211], v[244:247], v[80:83], v[208:211]
    ds_read_b128 v[240:243], v2 offset:13312
    v_mfma_f32_16x16x32_bf16 v[212:215], v[244:247], v[84:87], v[212:215]
    s_waitcnt lgkmcnt(4)
    v_mfma_f32_16x16x32_bf16 v[216:219], v[248:251], v[80:83], v[216:219]
    ds_read_b128 v[244:247], v2 offset:13568
    v_mfma_f32_16x16x32_bf16 v[220:223], v[248:251], v[84:87], v[220:223]
    s_waitcnt lgkmcnt(4)
    v_mfma_f32_16x16x32_bf16 v[224:227], v[252:255], v[80:83], v[224:227]
    ds_read_b128 v[248:251], v2 offset:14336
    s_add_u32 s73, s73, 4096
    buffer_load_dwordx4 v[120:123], v5, s[12:15], s73 offen offset:0 sc1
    v_mfma_f32_16x16x32_bf16 v[228:231], v[252:255], v[84:87], v[228:231]
    s_waitcnt vmcnt(8) lgkmcnt(4)
    v_mfma_f32_16x16x32_bf16 v[184:187], v[232:235], v[88:91], v[184:187]
    ds_read_b128 v[252:255], v2 offset:14592
    v_mfma_f32_16x16x32_bf16 v[188:191], v[232:235], v[92:95], v[188:191]
    s_waitcnt lgkmcnt(4)
    v_mfma_f32_16x16x32_bf16 v[192:195], v[236:239], v[88:91], v[192:195]
    ds_read_b128 v[232:235], v2 offset:18432
    v_mfma_f32_16x16x32_bf16 v[196:199], v[236:239], v[92:95], v[196:199]
    s_waitcnt lgkmcnt(4)
    v_mfma_f32_16x16x32_bf16 v[200:203], v[240:243], v[88:91], v[200:203]
    ds_read_b128 v[236:239], v2 offset:18688
    buffer_load_dwordx4 v[124:127], v5, s[12:15], s73 offen offset:256 sc1
    v_mfma_f32_16x16x32_bf16 v[204:207], v[240:243], v[92:95], v[204:207]
    s_waitcnt lgkmcnt(4)
    v_mfma_f32_16x16x32_bf16 v[208:211], v[244:247], v[88:91], v[208:211]
    ds_read_b128 v[240:243], v2 offset:19456
    v_mfma_f32_16x16x32_bf16 v[212:215], v[244:247], v[92:95], v[212:215]
    s_waitcnt lgkmcnt(4)
    v_mfma_f32_16x16x32_bf16 v[216:219], v[248:251], v[88:91], v[216:219]
    ds_read_b128 v[244:247], v2 offset:19712
    v_mfma_f32_16x16x32_bf16 v[220:223], v[248:251], v[92:95], v[220:223]
    s_waitcnt lgkmcnt(4)
    v_mfma_f32_16x16x32_bf16 v[224:227], v[252:255], v[88:91], v[224:227]
    ds_read_b128 v[248:251], v2 offset:20480
    buffer_load_dwordx4 v[128:131], v5, s[12:15], s73 offen offset:2048 sc1
    v_mfma_f32_16x16x32_bf16 v[228:231], v[252:255], v[92:95], v[228:231]
    s_waitcnt vmcnt(8) lgkmcnt(4)
    v_mfma_f32_16x16x32_bf16 v[184:187], v[232:235], v[96:99], v[184:187]
    ds_read_b128 v[252:255], v2 offset:20736
    s_waitcnt vmcnt(5)
    v_cmp_gt_u32 vcc, 2, v4
    s_nop 0
    s_and_b64 vcc, vcc, s[54:55]
    s_cbranch_vccnz Lspin_77
Lspin_77_r:
    s_cmp_eq_u32 s24, 0
    s_cbranch_scc1 Linv_79
Lok_78:
    v_mfma_f32_16x16x32_bf16 v[188:191], v[232:235], v[100:103], v[188:191]
    s_waitcnt lgkmcnt(4)
    v_mfma_f32_16x16x32_bf16 v[192:195], v[236:239], v[96:99], v[192:195]
    ds_read_b128 v[232:235], v2 offset:24576
    v_mfma_f32_16x16x32_bf16 v[196:199], v[236:239], v[100:103], v[196:199]
    s_waitcnt lgkmcnt(4)
    v_mfma_f32_16x16x32_bf16 v[200:203], v[240:243], v[96:99], v[200:203]
    ds_read_b128 v[236:239], v2 offset:24832
    buffer_load_dwordx4 v[132:135], v5, s[12:15], s73 offen offset:2304 sc1
    v_mfma_f32_16x16x32_bf16 v[204:207], v[240:243], v[100:103], v[204:207]
    s_waitcnt lgkmcnt(4)
    v_mfma_f32_16x16x32_bf16 v[208:211], v[244:247], v[96:99], v[208:211]
    ds_read_b128 v[240:243], v2 offset:25600
    buffer_load_dwordx4 v[8:11], v5, s[4:7], s74 offen offset:0 sc1
    v_mfma_f32_16x16x32_bf16 v[212:215], v[244:247], v[100:103], v[212:215]
    s_waitcnt lgkmcnt(4)
    v_mfma_f32_16x16x32_bf16 v[216:219], v[248:251], v[96:99], v[216:219]
    ds_read_b128 v[244:247], v2 offset:25856
    v_mfma_f32_16x16x32_bf16 v[220:223], v[248:251], v[100:103], v[220:223]
    s_waitcnt lgkmcnt(4)
    v_mfma_f32_16x16x32_bf16 v[224:227], v[252:255], v[96:99], v[224:227]
    ds_read_b128 v[248:251], v2 offset:26624
    buffer_load_dwordx4 v[12:15], v5, s[4:7], s74 offen offset:256 sc1
    v_mfma_f32_16x16x32_bf16 v[228:231], v[252:255], v[100:103], v[228:231]
    s_waitcnt lgkmcnt(4)
    v_mfma_f32_16x16x32_bf16 v[184:187], v[232:235], v[104:107], v[184:187]
IT_10:
    s_cbranch_execz IT_ret
    ds_read_b128 v[252:255], v2 offset:26880
    v_mfma_f32_16x16x32_bf16 v[188:191], v[232:235], v[108:111], v[188:191]
    s_waitcnt lgkmcnt(4)
    v_mfma_f32_16x16x32_bf16 v[192:195], v[236:239], v[104:107], v[192:195]
    ds_read_b128 v[232:235], v2 offset:30720
    v_mfma_f32_16x16x32_bf16 v[196:199], v[236:239], v[108:111], v[196:199]
    s_waitcnt lgkmcnt(4)
    v_mfma_f32_16x16x32_bf16 v[200:203], v[240:243], v[104:107], v[200:203]
    ds_read_b128 v[236:239], v2 offset:30976
    buffer_load_dwordx4 v[16:19], v5, s[4:7], s74 offen offset:2048 sc1
    v_mfma_f32_16x16x32_bf16 v[204:207], v[240:243], v[108:111], v[204:207]
    s_waitcnt lgkmcnt(4)
    v_mfma_f32_16x16x32_bf16 v[208:211], v[244:247], v[104:107], v[208:211]
    ds_read_b128 v[240:243], v2 offset:31744
    buffer_load_dwordx4 v[20:23], v5, s[4:7], s74 offen offset:2304 sc1
    v_mfma_f32_16x16x32_bf16 v[212:215], v[244:247], v[108:111], v[212:215]
    s_waitcnt lgkmcnt(4)
    v_mfma_f32_16x16x32_bf16 v[216:219], v[248:251], v[104:107], v[216:219]
    ds_read_b128 v[244:247], v2 offset:32000
    v_mfma_f32_16x16x32_bf16 v[220:223], v[248:251], v[108:111], v[220:223]
    s_waitcnt lgkmcnt(4)
    v_mfma_f32_16x16x32_bf16 v[224:227], v[252:255], v[104:107], v[224:227]
    ds_read_b128 v[248:251], v2 offset:32768
    s_add_u32 s74, s74, 4096
    buffer_load_dwordx4 v[24:27], v5, s[4:7], s74 offen offset:0 sc1
    v_mfma_f32_16x16x32_bf16 v[228:231], v[252:255], v[108:111], v[228:231]
    s_waitcnt vmcnt(9) lgkmcnt(4)
    v_mfma_f32_16x16x32_bf16 v[184:187], v[232:235], v[112:115], v[184:187]
    ds_read_b128 v[252:255], v2 offset:33024
    v_mfma_f32_16x16x32_bf16 v[188:191], v[232:235], v[116:119], v[188:191]
    s_waitcnt lgkmcnt(4)
    v_mfma_f32_16x16x32_bf16 v[192:195], v[236:239], v[112:115], v[192:195]
    ds_read_b128 v[232:235], v2 offset:36864
    v_mfma_f32_16x16x32_bf16 v[196:199], v[236:239], v[116:119], v[196:199]
    s_waitcnt lgkmcnt(4)
    v_mfma_f32_16x16x32_bf16 v[200:203], v[240:243], v[112:115], v[200:203]
    ds_read_b128 v[236:239], v2 offset:37120
    buffer_load_dwordx4 v[28:31], v5, s[4:7], s74 offen offset:256 sc1
    v_mfma_f32_16x16x32_bf16 v[204:207], v[240:243], v[116:119], v[204:207]
    s_waitcnt lgkmcnt(4)
    v_mfma_f32_16x16x32_bf16 v[208:211], v[244:247], v[112:115], v[208:211]
    ds_read_b128 v[240:243], v2 offset:43008
    buffer_load_dwordx4 v[32:35], v5, s[4:7], s74 offen offset:2048 sc1
    v_mfma_f32_16x16x32_bf16 v[212:215], v[244:247], v[116:119], v[212:215]
    s_waitcnt lgkmcnt(4)
    v_mfma_f32_16x16x32_bf16 v[216:219], v[248:251], v[112:115], v[216:219]
    ds_read_b128 v[244:247], v2 offset:43264
    v_mfma_f32_16x16x32_bf16 v[220:223], v[248:251], v[116:119], v[220:223]
    s_waitcnt lgkmcnt(4)
    v_mfma_f32_16x16x32_bf16 v[224:227], v[252:255], v[112:115], v[224:227]
    ds_read_b128 v[248:251], v2 offset:37888
    buffer_load_dwordx4 v[36:39], v5, s[4:7], s74 offen offset:2304 sc1
    v_mfma_f32_16x16x32_bf16 v[228:231], v[252:255], v[116:119], v[228:231]
    s_waitcnt vmcnt(10) lgkmcnt(4)
    v_mfma_f32_16x16x32_bf16 v[184:187], v[232:235], v[120:123], v[184:187]
    ds_read_b128 v[252:255], v2 offset:38144
    v_mfma_f32_16x16x32_bf16 v[188:191], v[232:235], v[124:127], v[188:191]
    s_waitcnt lgkmcnt(4)
    v_mfma_f32_16x16x32_bf16 v[192:195], v[236:239], v[120:123], v[192:195]
    ds_read_b128 v[232:235], v2 offset:44032
    v_mfma_f32_16x16x32_bf16 v[196:199], v[236:239], v[124:127], v[196:199]
    s_waitcnt vmcnt(8) lgkmcnt(4)
    v_mfma_f32_16x16x32_bf16 v[184:187], v[240:243], v[128:131], v[184:187]
    ds_read_b128 v[236:239], v2 offset:44288
    v_and_b32 v136, 0x70, v0
    v_bfe_u32 v137, v0, 7, 1
    v_lshl_add_u32 v136, v137, 9, v136
    v_bfe_u32 v137, v0, 8, 1
    v_lshl_add_u32 v136, v137, 13, v136
    v_lshrrev_b32 v137, 9, v0
    v_lshl_add_u32 v136, v137, 10, v136
    buffer_load_dwordx4 v[168:171], v136, s[4:7], s59 offen sc1
    v_mfma_f32_16x16x32_bf16 v[188:191], v[240:243], v[132:135], v[188:191]
    s_waitcnt lgkmcnt(4)
    v_mfma_f32_16x16x32_bf16 v[192:195], v[244:247], v[128:131], v[192:195]
    ds_read_b128 v[240:243], v2 offset:38912
    s_add_u32 s47, s47, 360448
    v_mfma_f32_16x16x32_bf16 v[196:199], v[244:247], v[132:135], v[196:199]
    s_add_u32 s74, s74, 4096
    buffer_load_dwordx4 v[40:43], v5, s[4:7], s74 offen offset:0 sc1
    s_waitcnt lgkmcnt(4)
    v_mfma_f32_16x16x32_bf16 v[200:203], v[248:251], v[120:123], v[200:203]
    ds_read_b128 v[244:247], v2 offset:39168
    v_mfma_f32_16x16x32_bf16 v[204:207], v[248:251], v[124:127], v[204:207]
    s_waitcnt lgkmcnt(4)
    v_mfma_f32_16x16x32_bf16 v[208:211], v[252:255], v[120:123], v[208:211]
    ds_read_b128 v[248:251], v2 offset:45056
    buffer_load_dwordx4 v[44:47], v5, s[4:7], s74 offen offset:256 sc1
    v_mfma_f32_16x16x32_bf16 v[212:215], v[252:255], v[124:127], v[212:215]
    v_max_f32 v184, 0, v184
    v_max_f32 v185, 0, v185
    v_max_f32 v186, 0, v186
    v_max_f32 v187, 0, v187
    s_waitcnt lgkmcnt(4)
    v_mfma_f32_16x16x32_bf16 v[200:203], v[232:235], v[128:131], v[200:203]
    ds_read_b128 v[252:255], v2 offset:45312
    v_max_f32 v188, 0, v188
    v_mfma_f32_16x16x32_bf16 v[204:207], v[232:235], v[132:135], v[204:207]
    v_max_f32 v189, 0, v189
    v_max_f32 v190, 0, v190
    v_max_f32 v191, 0, v191
    s_waitcnt lgkmcnt(4)
    v_mfma_f32_16x16x32_bf16 v[208:211], v[236:239], v[128:131], v[208:211]
    v_mul_f32 v184, v184, v192
    v_mul_f32 v185, v185, v193
    v_mfma_f32_16x16x32_bf16 v[212:215], v[236:239], v[132:135], v[212:215]
    v_mul_f32 v186, v186, v194
    v_mul_f32 v187, v187, v195
    s_waitcnt lgkmcnt(3)
    v_mfma_f32_16x16x32_bf16 v[216:219], v[240:243], v[120:123], v[216:219]
    buffer_load_dwordx4 v[48:51], v5, s[4:7], s74 offen offset:2048 sc1
    v_mul_f32 v188, v188, v196
    v_mfma_f32_16x16x32_bf16 v[220:223], v[240:243], v[124:127], v[220:223]
    v_mul_f32 v189, v189, v197
    v_mul_f32 v190, v190, v198
    v_mul_f32 v191, v191, v199
    s_waitcnt lgkmcnt(2)
    v_mfma_f32_16x16x32_bf16 v[224:227], v[244:247], v[120:123], v[224:227]
    buffer_load_dwordx4 v[52:55], v5, s[4:7], s74 offen offset:2304 sc1
    v_cvt_pk_bf16_f32 v184, v184, v185
    v_mfma_f32_16x16x32_bf16 v[228:231], v[244:247], v[124:127], v[228:231]
    v_cvt_pk_bf16_f32 v185, v186, v187
    v_cvt_pk_bf16_f32 v186, v188, v189
    v_cvt_pk_bf16_f32 v187, v190, v191
    s_waitcnt lgkmcnt(1)
    v_mfma_f32_16x16x32_bf16 v[216:219], v[248:251], v[128:131], v[216:219]
    v_permlane16_swap_b32 v184, v186
    v_permlane16_swap_b32 v185, v187
    v_mfma_f32_16x16x32_bf16 v[220:223], v[248:251], v[132:135], v[220:223]
    buffer_store_dwordx4 v[184:187], v0, s[92:95], s47 offen offset:0
    v_max_f32 v200, 0, v200
    s_waitcnt lgkmcnt(0)
    v_mfma_f32_16x16x32_bf16 v[224:227], v[252:255], v[128:131], v[224:227]
    s_add_u32 s74, s74, 4096
    buffer_load_dwordx4 v[56:59], v5, s[4:7], s74 offen offset:0 sc1
    v_mfma_f32_16x16x32_bf16 v[228:231], v[252:255], v[132:135], v[228:231]
    v_max_f32 v201, 0, v201
    v_max_f32 v202, 0, v202
    v_max_f32 v203, 0, v203
    v_max_f32 v204, 0, v204
Lp4_66:
    s_add_u32 s48, s48, 512
    s_add_u32 s58, s58, 512
    s_mov_b32 s55, 0
    s_waitcnt vmcnt(13)
    v_mfma_f32_16x16x32_bf16 v[136:139], a[64:67], v[8:11], 0
    v_max_f32 v205, 0, v205
    v_max_f32 v206, 0, v206
    v_mfma_f32_16x16x32_bf16 v[140:143], a[64:67], v[12:15], 0
    v_max_f32 v207, 0, v207
    v_mul_f32 v200, v200, v208
    v_mfma_f32_16x16x32_bf16 v[152:155], a[72:75], v[8:11], 0
    v_mul_f32 v201, v201, v209
    v_mul_f32 v202, v202, v210
    v_mfma_f32_16x16x32_bf16 v[156:159], a[72:75], v[12:15], 0
    v_mul_f32 v203, v203, v211
    v_mul_f32 v204, v204, v212
    v_mfma_f32_16x16x32_bf16 v[144:147], a[68:71], v[8:11], 0
    v_mul_f32 v205, v205, v213
    v_mul_f32 v206, v206, v214
    v_mfma_f32_16x16x32_bf16 v[148:151], a[68:71], v[12:15], 0
    v_mul_f32 v207, v207, v215
    v_cvt_pk_bf16_f32 v200, v200, v201
    v_mfma_f32_16x16x32_bf16 v[160:163], a[76:79], v[8:11], 0
    v_cvt_pk_bf16_f32 v201, v202, v203
    v_cvt_pk_bf16_f32 v202, v204, v205
    v_mfma_f32_16x16x32_bf16 v[164:167], a[76:79], v[12:15], 0
    v_cvt_pk_bf16_f32 v203, v206, v207
    v_permlane16_swap_b32 v200, v202
    s_waitcnt vmcnt(11)
    v_mfma_f32_16x16x32_bf16 v[136:139], a[80:83], v[16:19], v[136:139]
    v_permlane16_swap_b32 v201, v203
    buffer_store_dwordx4 v[200:203], v0, s[92:95], s47 offen offset:1024
    v_mfma_f32_16x16x32_bf16 v[140:143], a[80:83], v[20:23], v[140:143]
    v_max_f32 v216, 0, v216
    v_max_f32 v217, 0, v217
    v_mfma_f32_16x16x32_bf16 v[152:155], a[88:91], v[16:19], v[152:155]
    v_max_f32 v218, 0, v218
    v_max_f32 v219, 0, v219
    v_mfma_f32_16x16x32_bf16 v[156:159], a[88:91], v[20:23], v[156:159]
    v_max_f32 v220, 0, v220
    v_max_f32 v221, 0, v221
    v_mfma_f32_16x16x32_bf16 v[144:147], a[84:87], v[16:19], v[144:147]
    v_max_f32 v222, 0, v222
    v_max_f32 v223, 0, v223
    v_mfma_f32_16x16x32_bf16 v[148:151], a[84:87], v[20:23], v[148:151]
    v_mul_f32 v216, v216, v224
    v_mul_f32 v217, v217, v225
    v_mfma_f32_16x16x32_bf16 v[160:163], a[92:95], v[16:19], v[160:163]
    v_mul_f32 v218, v218, v226
    v_mul_f32 v219, v219, v227
    v_mfma_f32_16x16x32_bf16 v[164:167], a[92:95], v[20:23], v[164:167]
    v_mul_f32 v220, v220, v228
    v_mul_f32 v221, v221, v229
    s_waitcnt vmcnt(10)
    v_mfma_f32_16x16x32_bf16 v[136:139], a[96:99], v[24:27], v[136:139]
    v_mul_f32 v222, v222, v230
    v_mul_f32 v223, v223, v231
    v_mfma_f32_16x16x32_bf16 v[140:143], a[96:99], v[28:31], v[140:143]
    v_cvt_pk_bf16_f32 v216, v216, v217
    v_cvt_pk_bf16_f32 v217, v218, v219
    v_mfma_f32_16x16x32_bf16 v[152:155], a[104:107], v[24:27], v[152:155]
    v_cvt_pk_bf16_f32 v218, v220, v221
    v_cvt_pk_bf16_f32 v219, v222, v223
    v_mfma_f32_16x16x32_bf16 v[156:159], a[104:107], v[28:31], v[156:159]
    v_permlane16_swap_b32 v216, v218
    v_permlane16_swap_b32 v217, v219
    v_mfma_f32_16x16x32_bf16 v[144:147], a[100:103], v[24:27], v[144:147]
    buffer_store_dwordx4 v[216:219], v0, s[92:95], s47 offen offset:2048
    v_mfma_f32_16x16x32_bf16 v[148:151], a[100:103], v[28:31], v[148:151]
    v_mfma_f32_16x16x32_bf16 v[160:163], a[108:111], v[24:27], v[160:163]
    v_bfe_u32 v253, v0, 8, 1
    v_and_b32 v248, 0xf0, v0
    v_mfma_f32_16x16x32_bf16 v[164:167], a[108:111], v[28:31], v[164:167]
    v_lshlrev_b32 v249, 7, v253
    s_waitcnt vmcnt(9)
    v_mfma_f32_16x16x32_bf16 v[136:139], a[112:115], v[32:35], v[136:139]
    buffer_load_dwordx4 v[60:63], v5, s[4:7], s74 offen offset:256 sc1
    v_xor_b32 v248, v248, v249
    v_mfma_f32_16x16x32_bf16 v[140:143], a[112:115], v[36:39], v[140:143]
    v_lshl_add_u32 v248, v253, 10, v248
    v_lshrrev_b32 v253, 9, v0
    v_mfma_f32_16x16x32_bf16 v[152:155], a[120:123], v[32:35], v[152:155]
    v_lshl_add_u32 v248, v253, 9, v248
    s_lshl_b32 s30, s3, 13
    v_mfma_f32_16x16x32_bf16 v[156:159], a[120:123], v[36:39], v[156:159]
    s_add_u32 s30, s30, 131072
    v_mfma_f32_16x16x32_bf16 v[144:147], a[116:119], v[32:35], v[144:147]
    buffer_load_dwordx4 v[64:67], v5, s[4:7], s74 offen offset:2048 sc1
    v_add_u32 v248, s30, v248
    v_mfma_f32_16x16x32_bf16 v[148:151], a[116:119], v[36:39], v[148:151]
    v_and_b32 v250, 0x70, v0
    s_lshl_b32 s30, s3, 7
    v_mfma_f32_16x16x32_bf16 v[160:163], a[124:127], v[32:35], v[160:163]
    v_add_u32 v250, s30, v250
    v_lshl_add_u32 v251, v253, 10, v250
    v_mfma_f32_16x16x32_bf16 v[164:167], a[124:127], v[36:39], v[164:167]
    v_and_b32 v249, 0x80, v0
    s_waitcnt vmcnt(8)
    v_mfma_f32_16x16x32_bf16 v[136:139], a[128:131], v[40:43], v[136:139]
    buffer_load_dwordx4 v[68:71], v5, s[4:7], s74 offen offset:2304 sc1
    v_xor_b32 v249, v249, v250
    v_mfma_f32_16x16x32_bf16 v[140:143], a[128:131], v[44:47], v[140:143]
    v_lshrrev_b32 v253, 7, v0
    v_lshl_add_u32 v249, v253, 10, v249
    v_mfma_f32_16x16x32_bf16 v[152:155], a[136:139], v[40:43], v[152:155]
    v_add_u32 v249, 131072, v249
    v_lshl_add_u32 v250, v253, 9, v250
    v_mfma_f32_16x16x32_bf16 v[156:159], a[136:139], v[44:47], v[156:159]
    s_waitcnt vmcnt(3)
    s_mov_b64 exec, 4
    s_cmp_eq_u32 s24, 0
    s_cbranch_scc1 Limp_86
    buffer_store_byte v3, off, s[4:7], s48
Lfl_87:
    s_mov_b64 exec, -1
    v_mfma_f32_16x16x32_bf16 v[144:147], a[132:135], v[40:43], v[144:147]
    s_add_u32 s74, s74, 4096
    buffer_load_dwordx4 v[72:75], v5, s[4:7], s74 offen offset:0 sc1
    v_mfma_f32_16x16x32_bf16 v[148:151], a[132:135], v[44:47], v[148:151]
    v_add_f32 v168, v168, v169
    v_add_f32 v170, v170, v171
    v_add_f32 v168, v168, v170
    v_mfma_f32_16x16x32_bf16 v[160:163], a[140:143], v[40:43], v[160:163]
    v_mul_f32 v168, 0x3b000000, v168
    s_nop 1
    v_add_f32 v168, v168, v168 row_ror:8 row_mask:0xf bank_mask:0xf
    v_mfma_f32_16x16x32_bf16 v[164:167], a[140:143], v[44:47], v[164:167]
    v_mov_b32 v169, v168
    v_mfma_f32_16x16x32_bf16 v[136:139], a[144:147], v[48:51], v[136:139]
    buffer_load_dwordx4 v[76:79], v5, s[4:7], s74 offen offset:256 sc1
    v_permlane32_swap_b32 v168, v169
    v_mfma_f32_16x16x32_bf16 v[140:143], a[144:147], v[52:55], v[140:143]
    v_fma_f32 v168, -v168, v168, v169
    v_max_f32 v168, 0, v168
    v_mfma_f32_16x16x32_bf16 v[152:155], a[152:155], v[48:51], v[152:155]
    v_add_f32 v168, 0x3727c5ac, v168
    v_rcp_f32 v254, v168
    v_mfma_f32_16x16x32_bf16 v[156:159], a[152:155], v[52:55], v[156:159]
    v_rcp_f32 v255, v168
    v_mfma_f32_16x16x32_bf16 v[144:147], a[148:151], v[48:51], v[144:147]
    buffer_load_dwordx4 v[80:83], v5, s[4:7], s74 offen offset:2048 sc1
    s_nop 0
    v_mfma_f32_16x16x32_bf16 v[148:151], a[148:151], v[52:55], v[148:151]
    v_permlane16_swap_b32 v254, v255
    s_lshl_b32 s42, s26, 15
    v_mfma_f32_16x16x32_bf16 v[160:163], a[156:159], v[48:51], v[160:163]
    s_lshl_b32 s31, s3, 13
    s_add_u32 s42, s42, s31
    v_mfma_f32_16x16x32_bf16 v[164:167], a[156:159], v[52:55], v[164:167]
    s_lshl_b32 s31, s23, 7
    s_waitcnt vmcnt(6)
    v_mfma_f32_16x16x32_bf16 v[136:139], a[160:163], v[56:59], v[136:139]
    buffer_load_dwordx4 v[84:87], v5, s[4:7], s74 offen offset:2304 sc1
    s_add_u32 s42, s42, s31
    v_mfma_f32_16x16x32_bf16 v[140:143], a[160:163], v[60:63], v[140:143]
    v_and_b32 v250, 0x70, v0
    v_lshlrev_b32 v250, 6, v250
    v_mfma_f32_16x16x32_bf16 v[152:155], a[168:171], v[56:59], v[152:155]
    v_lshrrev_b32 v253, 7, v0
    v_lshl_add_u32 v250, v253, 4, v250
    v_mfma_f32_16x16x32_bf16 v[156:159], a[168:171], v[60:63], v[156:159]
    buffer_load_ubyte v4, v3, s[4:7], s58 offen sc1
    v_mfma_f32_16x16x32_bf16 v[144:147], a[164:167], v[56:59], v[144:147]
    s_add_u32 s74, s74, 4096
    buffer_load_dwordx4 v[88:91], v5, s[4:7], s74 offen offset:0 sc1
    v_mfma_f32_16x16x32_bf16 v[148:151], a[164:167], v[60:63], v[148:151]
    v_mfma_f32_16x16x32_bf16 v[160:163], a[172:175], v[56:59], v[160:163]
    v_mfma_f32_16x16x32_bf16 v[164:167], a[172:175], v[60:63], v[164:167]
    s_waitcnt vmcnt(7)
    v_mfma_f32_16x16x32_bf16 v[136:139], a[176:179], v[64:67], v[136:139]
    buffer_load_dwordx4 v[92:95], v5, s[4:7], s74 offen offset:256 sc1
    v_mfma_f32_16x16x32_bf16 v[140:143], a[176:179], v[68:71], v[140:143]
    v_mfma_f32_16x16x32_bf16 v[152:155], a[184:187], v[64:67], v[152:155]
    v_mfma_f32_16x16x32_bf16 v[156:159], a[184:187], v[68:71], v[156:159]
    v_mfma_f32_16x16x32_bf16 v[144:147], a[180:183], v[64:67], v[144:147]
    v_mfma_f32_16x16x32_bf16 v[148:151], a[180:183], v[68:71], v[148:151]
    v_mfma_f32_16x16x32_bf16 v[160:163], a[188:191], v[64:67], v[160:163]
    v_mfma_f32_16x16x32_bf16 v[164:167], a[188:191], v[68:71], v[164:167]
    s_waitcnt vmcnt(5)
    v_mfma_f32_16x16x32_bf16 v[136:139], a[192:195], v[72:75], v[136:139]
    v_mfma_f32_16x16x32_bf16 v[140:143], a[192:195], v[76:79], v[140:143]
    v_mfma_f32_16x16x32_bf16 v[152:155], a[200:203], v[72:75], v[152:155]
    s_waitcnt vmcnt(2)
    v_cmp_gt_u32 vcc, 2, v4
    s_nop 0
    s_and_b64 vcc, vcc, s[54:55]
    s_cbranch_vccz Lspin_88_r
Lspin_88:
    buffer_load_ubyte v4, v3, s[4:7], s58 offen sc1
    s_sub_u32 s60, s60, 1
    s_cbranch_scc1 K1_fail
    s_waitcnt vmcnt(0)
    v_cmp_gt_u32 vcc, 2, v4
    s_nop 0
    s_and_b64 vcc, vcc, s[54:55]
    s_cbranch_vccnz Lspin_88
Lspin_88_r:
    s_cmp_eq_u32 s24, 0
    s_cbranch_scc1 Linv_90
Lok_89:
    buffer_load_dwordx4 v[96:99], v5, s[4:7], s75 offen offset:0 sc1
    buffer_load_dwordx4 v[100:103], v5, s[4:7], s75 offen offset:256 sc1
    buffer_load_dwordx4 v[104:107], v5, s[4:7], s75 offen offset:2048 sc1
    buffer_load_dwordx4 v[108:111], v5, s[4:7], s75 offen offset:2304 sc1
    v_mfma_f32_16x16x32_bf16 v[156:159], a[200:203], v[76:79], v[156:159]
    v_mfma_f32_16x16x32_bf16 v[144:147], a[196:199], v[72:75], v[144:147]
    s_add_u32 s75, s75, 4096
    buffer_load_dwordx4 v[112:115], v5, s[4:7], s75 offen offset:0 sc1
    v_mfma_f32_16x16x32_bf16 v[148:151], a[196:199], v[76:79], v[148:151]
    v_mfma_f32_16x16x32_bf16 v[160:163], a[204:207], v[72:75], v[160:163]
    v_mfma_f32_16x16x32_bf16 v[164:167], a[204:207], v[76:79], v[164:167]
    v_mfma_f32_16x16x32_bf16 v[136:139], a[208:211], v[80:83], v[136:139]
    buffer_load_dwordx4 v[116:119], v5, s[4:7], s75 offen offset:256 sc1
    v_mfma_f32_16x16x32_bf16 v[140:143], a[208:211], v[84:87], v[140:143]
    v_mfma_f32_16x16x32_bf16 v[152:155], a[216:219], v[80:83], v[152:155]
    v_mfma_f32_16x16x32_bf16 v[156:159], a[216:219], v[84:87], v[156:159]
    v_mfma_f32_16x16x32_bf16 v[144:147], a[212:215], v[80:83], v[144:147]
    buffer_load_dwordx4 v[120:123], v5, s[4:7], s75 offen offset:2048 sc1
    v_mfma_f32_16x16x32_bf16 v[148:151], a[212:215], v[84:87], v[148:151]
    v_mfma_f32_16x16x32_bf16 v[160:163], a[220:223], v[80:83], v[160:163]
    v_mfma_f32_16x16x32_bf16 v[164:167], a[220:223], v[84:87], v[164:167]
    s_cmp_eq_u32 s3, 3
    s_cbranch_scc1 Lk3_85
    s_waitcnt vmcnt(7)
    v_mfma_f32_16x16x32_bf16 v[152:155], a[232:235], v[88:91], v[152:155]
    v_mfma_f32_16x16x32_bf16 v[156:159], a[232:235], v[92:95], v[156:159]
    v_mfma_f32_16x16x32_bf16 v[136:139], a[224:227], v[88:91], v[136:139]
    v_mfma_f32_16x16x32_bf16 v[140:143], a[224:227], v[92:95], v[140:143]
    v_mfma_f32_16x16x32_bf16 v[160:163], a[236:239], v[88:91], v[160:163]
    v_mfma_f32_16x16x32_bf16 v[164:167], a[236:239], v[92:95], v[164:167]
    v_mfma_f32_16x16x32_bf16 v[144:147], a[228:231], v[88:91], v[144:147]
    v_mfma_f32_16x16x32_bf16 v[148:151], a[228:231], v[92:95], v[148:151]
Lk3_85:
    buffer_load_dwordx4 v[124:127], v5, s[4:7], s75 offen offset:2304 sc1
    s_add_u32 s75, s75, 4096
    buffer_load_dwordx4 v[128:131], v5, s[4:7], s75 offen offset:0 sc1
    s_barrier
    s_waitcnt vmcnt(7)
    v_mfma_f32_16x16x32_bf16 v[168:171], a[64:67], v[96:99], 0
    buffer_load_dwordx4 v[132:135], v5, s[4:7], s75 offen offset:256 sc1
    v_mfma_f32_16x16x32_bf16 v[172:175], a[64:67], v[100:103], 0
    v_mfma_f32_16x16x32_bf16 v[232:235], a[72:75], v[96:99], 0
    ds_write_b128 v248, v[136:139] offset:0
    v_accvgpr_read_b32 v72, a240
    v_mfma_f32_16x16x32_bf16 v[236:239], a[72:75], v[100:103], 0
    v_accvgpr_read_b32 v73, a241
    v_mfma_f32_16x16x32_bf16 v[176:179], a[68:71], v[96:99], 0
    buffer_load_dwordx4 v[184:187], v5, s[4:7], s75 offen offset:2048 sc1
    v_mfma_f32_16x16x32_bf16 v[180:183], a[68:71], v[100:103], 0
    v_mfma_f32_16x16x32_bf16 v[240:243], a[76:79], v[96:99], 0
    ds_write_b128 v248, v[140:143] offset:256
    v_accvgpr_read_b32 v74, a242
    v_mfma_f32_16x16x32_bf16 v[244:247], a[76:79], v[100:103], 0
    v_accvgpr_read_b32 v75, a243
    s_waitcnt vmcnt(7)
    v_mfma_f32_16x16x32_bf16 v[168:171], a[80:83], v[104:107], v[168:171]
    buffer_load_dwordx4 v[188:191], v5, s[4:7], s75 offen offset:2304 sc1
    v_mfma_f32_16x16x32_bf16 v[172:175], a[80:83], v[108:111], v[172:175]
    v_mfma_f32_16x16x32_bf16 v[232:235], a[88:91], v[104:107], v[232:235]
    ds_write_b128 v248, v[144:147] offset:2048
    v_accvgpr_read_b32 v76, a244
    v_mfma_f32_16x16x32_bf16 v[236:239], a[88:91], v[108:111], v[236:239]
    v_accvgpr_read_b32 v77, a245
    v_mfma_f32_16x16x32_bf16 v[176:179], a[84:87], v[104:107], v[176:179]
    s_add_u32 s75, s75, 4096
    buffer_load_dwordx4 v[192:195], v5, s[4:7], s75 offen offset:0 sc1
    v_mfma_f32_16x16x32_bf16 v[180:183], a[84:87], v[108:111], v[180:183]
    v_mfma_f32_16x16x32_bf16 v[240:243], a[92:95], v[104:107], v[240:243]
    ds_write_b128 v248, v[148:151] offset:2304
    v_accvgpr_read_b32 v78, a246
    v_mfma_f32_16x16x32_bf16 v[244:247], a[92:95], v[108:111], v[244:247]
    v_accvgpr_read_b32 v79, a247
    s_waitcnt vmcnt(7)
    v_mfma_f32_16x16x32_bf16 v[168:171], a[96:99], v[112:115], v[168:171]
    buffer_load_dwordx4 v[196:199], v5, s[4:7], s75 offen offset:256 sc1
    v_mfma_f32_16x16x32_bf16 v[172:175], a[96:99], v[116:119], v[172:175]
    v_mfma_f32_16x16x32_bf16 v[232:235], a[104:107], v[112:115], v[232:235]
    ds_write_b128 v248, v[152:155] offset:4096
    v_accvgpr_read_b32 v80, a248
    v_mfma_f32_16x16x32_bf16 v[236:239], a[104:107], v[116:119], v[236:239]
    v_accvgpr_read_b32 v81, a249
    v_mfma_f32_16x16x32_bf16 v[176:179], a[100:103], v[112:115], v[176:179]
    buffer_load_dwordx4 v[200:203], v5, s[4:7], s75 offen offset:2048 sc1
    v_mfma_f32_16x16x32_bf16 v[180:183], a[100:103], v[116:119], v[180:183]
    v_mfma_f32_16x16x32_bf16 v[240:243], a[108:111], v[112:115], v[240:243]
    ds_write_b128 v248, v[156:159] offset:4352
    v_accvgpr_read_b32 v82, a250
    v_mfma_f32_16x16x32_bf16 v[244:247], a[108:111], v[116:119], v[244:247]
    v_accvgpr_read_b32 v83, a251
    s_waitcnt vmcnt(7)
    v_mfma_f32_16x16x32_bf16 v[168:171], a[112:115], v[120:123], v[168:171]
    buffer_load_dwordx4 v[204:207], v5, s[4:7], s75 offen offset:2304 sc1
    v_mfma_f32_16x16x32_bf16 v[172:175], a[112:115], v[124:127], v[172:175]
    v_mfma_f32_16x16x32_bf16 v[232:235], a[120:123], v[120:123], v[232:235]
    ds_write_b128 v248, v[160:163] offset:6144
    v_accvgpr_read_b32 v84, a252
    v_mfma_f32_16x16x32_bf16 v[236:239], a[120:123], v[124:127], v[236:239]
    v_accvgpr_read_b32 v85, a253
    v_mfma_f32_16x16x32_bf16 v[176:179], a[116:119], v[120:123], v[176:179]
    s_add_u32 s75, s75, 4096
    buffer_load_dwordx4 v[208:211], v5, s[4:7], s75 offen offset:0 sc1
    v_mfma_f32_16x16x32_bf16 v[180:183], a[116:119], v[124:127], v[180:183]
    v_mfma_f32_16x16x32_bf16 v[240:243], a[124:127], v[120:123], v[240:243]
    ds_write_b128 v248, v[164:167] offset:6400
    v_accvgpr_read_b32 v86, a254
    v_mfma_f32_16x16x32_bf16 v[244:247], a[124:127], v[124:127], v[244:247]
    v_accvgpr_read_b32 v87, a255
    s_waitcnt vmcnt(7)
    v_mfma_f32_16x16x32_bf16 v[168:171], a[128:131], v[128:131], v[168:171]
    buffer_load_dwordx4 v[212:215], v5, s[4:7], s75 offen offset:256 sc1
    v_mfma_f32_16x16x32_bf16 v[172:175], a[128:131], v[132:135], v[172:175]
    v_mfma_f32_16x16x32_bf16 v[232:235], a[136:139], v[128:131], v[232:235]
    s_waitcnt lgkmcnt(0)
    s_barrier
    ds_read_b128 v[8:11], v249 offset:0
    ds_read_b128 v[12:15], v249 offset:512
    ds_read_b128 v[16:19], v249 offset:8192
    ds_read_b128 v[20:23], v249 offset:8704
    ds_read_b128 v[24:27], v249 offset:16384
    ds_read_b128 v[28:31], v249 offset:16896
    ds_read_b128 v[32:35], v249 offset:24576
    ds_read_b128 v[36:39], v249 offset:25088
    v_mfma_f32_16x16x32_bf16 v[236:239], a[136:139], v[132:135], v[236:239]
    v_mfma_f32_16x16x32_bf16 v[176:179], a[132:135], v[128:131], v[176:179]
    buffer_load_dwordx4 v[216:219], v5, s[4:7], s75 offen offset:2048 sc1
    v_mfma_f32_16x16x32_bf16 v[180:183], a[132:135], v[132:135], v[180:183]
    v_mfma_f32_16x16x32_bf16 v[240:243], a[140:143], v[128:131], v[240:243]
    v_mfma_f32_16x16x32_bf16 v[244:247], a[140:143], v[132:135], v[244:247]
    s_waitcnt vmcnt(7)
    v_mfma_f32_16x16x32_bf16 v[168:171], a[144:147], v[184:187], v[168:171]
    buffer_load_dwordx4 v[220:223], v5, s[4:7], s75 offen offset:2304 sc1
    s_waitcnt lgkmcnt(4)
    v_mfma_f32_16x16x32_bf16 v[172:175], a[144:147], v[188:191], v[172:175]
    v_add_f32 v8, v8, v16
    v_add_f32 v9, v9, v17
    v_mfma_f32_16x16x32_bf16 v[232:235], a[152:155], v[184:187], v[232:235]
    v_add_f32 v10, v10, v18
    v_add_f32 v11, v11, v19
    v_mfma_f32_16x16x32_bf16 v[236:239], a[152:155], v[188:191], v[236:239]
    v_add_f32 v12, v12, v20
    v_mfma_f32_16x16x32_bf16 v[176:179], a[148:151], v[184:187], v[176:179]
    s_add_u32 s75, s75, 4096
    buffer_load_dwordx4 v[224:227], v5, s[4:7], s75 offen offset:0 sc1
    v_mfma_f32_16x16x32_bf16 v[180:183], a[148:151], v[188:191], v[180:183]
    v_add_f32 v13, v13, v21
    v_add_f32 v14, v14, v22
    v_add_f32 v15, v15, v23
    v_mfma_f32_16x16x32_bf16 v[240:243], a[156:159], v[184:187], v[240:243]
    s_waitcnt lgkmcnt(0)
    v_add_f32 v24, v24, v32
    v_mfma_f32_16x16x32_bf16 v[244:247], a[156:159], v[188:191], v[244:247]
    v_add_f32 v25, v25, v33
    s_waitcnt vmcnt(7)
    v_mfma_f32_16x16x32_bf16 v[168:171], a[160:163], v[192:195], v[168:171]
    buffer_load_dwordx4 v[228:231], v5, s[4:7], s75 offen offset:256 sc1
    v_add_f32 v26, v26, v34
    v_mfma_f32_16x16x32_bf16 v[172:175], a[160:163], v[196:199], v[172:175]
    v_add_f32 v27, v27, v35
    v_add_f32 v28, v28, v36
    v_mfma_f32_16x16x32_bf16 v[232:235], a[168:171], v[192:195], v[232:235]
    v_add_f32 v29, v29, v37
    v_add_f32 v30, v30, v38
    v_mfma_f32_16x16x32_bf16 v[236:239], a[168:171], v[196:199], v[236:239]
    v_add_f32 v31, v31, v39
    v_mfma_f32_16x16x32_bf16 v[176:179], a[164:167], v[192:195], v[176:179]
    v_add_f32 v8, v8, v24
    v_add_f32 v9, v9, v25
    v_mfma_f32_16x16x32_bf16 v[180:183], a[164:167], v[196:199], v[180:183]
    v_add_f32 v10, v10, v26
    v_mfma_f32_16x16x32_bf16 v[240:243], a[172:175], v[192:195], v[240:243]
    v_add_f32 v11, v11, v27
    v_add_f32 v12, v12, v28
    v_mfma_f32_16x16x32_bf16 v[244:247], a[172:175], v[196:199], v[244:247]
    v_add_f32 v13, v13, v29
    s_waitcnt vmcnt(6)
    v_mfma_f32_16x16x32_bf16 v[168:171], a[176:179], v[200:203], v[168:171]
    v_add_f32 v14, v14, v30
    v_add_f32 v15, v15, v31
    v_mfma_f32_16x16x32_bf16 v[172:175], a[176:179], v[204:207], v[172:175]
    v_fma_f32 v72, v8, v254, v72
    v_mfma_f32_16x16x32_bf16 v[232:235], a[184:187], v[200:203], v[232:235]
    v_fma_f32 v73, v9, v254, v73
    v_fma_f32 v74, v10, v254, v74
    v_mfma_f32_16x16x32_bf16 v[236:239], a[184:187], v[204:207], v[236:239]
    v_fma_f32 v75, v11, v254, v75
    v_mfma_f32_16x16x32_bf16 v[176:179], a[180:183], v[200:203], v[176:179]
    v_fma_f32 v76, v12, v254, v76
    v_fma_f32 v77, v13, v254, v77
    v_mfma_f32_16x16x32_bf16 v[180:183], a[180:183], v[204:207], v[180:183]
    v_fma_f32 v78, v14, v254, v78
    v_mfma_f32_16x16x32_bf16 v[240:243], a[188:191], v[200:203], v[240:243]
    v_fma_f32 v79, v15, v254, v79
    v_cvt_pk_bf16_f32 v8, v72, v73
    v_mfma_f32_16x16x32_bf16 v[244:247], a[188:191], v[204:207], v[244:247]
    v_cvt_pk_bf16_f32 v9, v74, v75
    s_waitcnt vmcnt(4)
    v_mfma_f32_16x16x32_bf16 v[168:171], a[192:195], v[208:211], v[168:171]
    v_cvt_pk_bf16_f32 v10, v76, v77
    v_cvt_pk_bf16_f32 v11, v78, v79
    v_mfma_f32_16x16x32_bf16 v[172:175], a[192:195], v[212:215], v[172:175]
    s_barrier
    v_mfma_f32_16x16x32_bf16 v[176:179], a[196:199], v[208:211], v[176:179]
    v_mfma_f32_16x16x32_bf16 v[180:183], a[196:199], v[212:215], v[180:183]
    s_waitcnt vmcnt(2)
    v_mfma_f32_16x16x32_bf16 v[168:171], a[208:211], v[216:219], v[168:171]
    v_mfma_f32_16x16x32_bf16 v[172:175], a[208:211], v[220:223], v[172:175]
    v_mfma_f32_16x16x32_bf16 v[176:179], a[212:215], v[216:219], v[176:179]
    v_mfma_f32_16x16x32_bf16 v[180:183], a[212:215], v[220:223], v[180:183]
    buffer_store_dwordx4 v[8:11], v250, s[12:15], s42 offen
    s_cmp_eq_u32 s3, 3
    s_cbranch_scc1 Lk3_91
    s_waitcnt vmcnt(1)
    v_mfma_f32_16x16x32_bf16 v[232:235], a[232:235], v[224:227], v[232:235]
    v_mfma_f32_16x16x32_bf16 v[236:239], a[232:235], v[228:231], v[236:239]
    v_mfma_f32_16x16x32_bf16 v[168:171], a[224:227], v[224:227], v[168:171]
    v_mfma_f32_16x16x32_bf16 v[172:175], a[224:227], v[228:231], v[172:175]
    v_mfma_f32_16x16x32_bf16 v[240:243], a[236:239], v[224:227], v[240:243]
    v_mfma_f32_16x16x32_bf16 v[244:247], a[236:239], v[228:231], v[244:247]
    v_mfma_f32_16x16x32_bf16 v[176:179], a[228:231], v[224:227], v[176:179]
    v_mfma_f32_16x16x32_bf16 v[180:183], a[228:231], v[228:231], v[180:183]
Lk3_91:
    v_mfma_f32_16x16x32_bf16 v[232:235], a[200:203], v[208:211], v[232:235]
    s_add_u32 s42, s42, 131072
    s_add_u32 s45, s45, 8192
    v_mfma_f32_16x16x32_bf16 v[236:239], a[200:203], v[212:215], v[236:239]
    v_mfma_f32_16x16x32_bf16 v[240:243], a[204:207], v[208:211], v[240:243]
    s_add_u32 s43, s43, 512
    ds_write_b128 v248, v[168:171] offset:0
    v_mfma_f32_16x16x32_bf16 v[244:247], a[204:207], v[212:215], v[244:247]
    v_mfma_f32_16x16x32_bf16 v[232:235], a[216:219], v[216:219], v[232:235]
    ds_write_b128 v248, v[172:175] offset:256
    v_mfma_f32_16x16x32_bf16 v[236:239], a[216:219], v[220:223], v[236:239]
    v_mfma_f32_16x16x32_bf16 v[240:243], a[220:223], v[216:219], v[240:243]
    ds_write_b128 v248, v[176:179] offset:2048
    v_mfma_f32_16x16x32_bf16 v[244:247], a[220:223], v[220:223], v[244:247]
    ds_write_b128 v248, v[180:183] offset:2304
    s_nop 1
    ds_write_b128 v248, v[232:235] offset:4096
    s_nop 0
    ds_write_b128 v248, v[236:239] offset:4352
    ds_write_b128 v248, v[240:243] offset:6144
    s_nop 0
    ds_write_b128 v248, v[244:247] offset:6400
    s_waitcnt lgkmcnt(0)
    s_barrier
    ds_read_b128 v[8:11], v249 offset:0
    ds_read_b128 v[12:15], v249 offset:512
    ds_read_b128 v[16:19], v249 offset:8192
    ds_read_b128 v[20:23], v249 offset:8704
    ds_read_b128 v[24:27], v249 offset:16384
    ds_read_b128 v[28:31], v249 offset:16896
    ds_read_b128 v[32:35], v249 offset:24576
    ds_read_b128 v[36:39], v249 offset:25088
    s_waitcnt lgkmcnt(4)
    v_pk_add_f32 v[8:9], v[8:9], v[16:17]
    v_pk_add_f32 v[10:11], v[10:11], v[18:19]
    v_pk_add_f32 v[12:13], v[12:13], v[20:21]
    v_pk_add_f32 v[14:15], v[14:15], v[22:23]
    s_waitcnt lgkmcnt(0)
    v_pk_add_f32 v[24:25], v[24:25], v[32:33]
    v_pk_add_f32 v[26:27], v[26:27], v[34:35]
    v_pk_add_f32 v[28:29], v[28:29], v[36:37]
    v_pk_add_f32 v[30:31], v[30:31], v[38:39]
    v_pk_add_f32 v[8:9], v[8:9], v[24:25]
    v_pk_add_f32 v[10:11], v[10:11], v[26:27]
    v_pk_add_f32 v[12:13], v[12:13], v[28:29]
    v_pk_add_f32 v[14:15], v[14:15], v[30:31]
    v_pk_fma_f32 v[80:81], v[8:9], v[254:255], v[80:81] op_sel:[0,1,0] op_sel_hi:[1,1,1]
    v_pk_fma_f32 v[82:83], v[10:11], v[254:255], v[82:83] op_sel:[0,1,0] op_sel_hi:[1,1,1]
    v_pk_fma_f32 v[84:85], v[12:13], v[254:255], v[84:85] op_sel:[0,1,0] op_sel_hi:[1,1,1]
    v_pk_fma_f32 v[86:87], v[14:15], v[254:255], v[86:87] op_sel:[0,1,0] op_sel_hi:[1,1,1]
IT_11:
    s_cbranch_execz IT_ret
    v_cvt_pk_bf16_f32 v8, v80, v81
    v_cvt_pk_bf16_f32 v9, v82, v83
    v_cvt_pk_bf16_f32 v10, v84, v85
    v_cvt_pk_bf16_f32 v11, v86, v87
    buffer_store_dwordx4 v[8:11], v250, s[12:15], s42 offen
K1_end:
    s_endpgm
HS_spin:
    v_lshlrev_b32 v40, 10, v3
    s_lshl_b32 s30, s18, 7
    s_add_u32 s30, s30, 16547840
HS_l:
    s_nop 0
    buffer_load_dword v4, v6, s[4:7], s52 offen sc1
    s_sub_u32 s60, s60, 1
    s_cbranch_scc1 K1_fail
    s_waitcnt vmcnt(0)
    v_cmp_ne_u32 vcc, s29, v4
    s_nop 0
    s_cbranch_vccz HS_ok
    s_and_b32 s31, s60, 63
    s_cbranch_scc1 HS_l
    buffer_load_dword v4, v40, s[4:7], s30 offen sc1
    s_waitcnt vmcnt(0)
    v_xor_b32 v41, s80, v4
    v_cmp_gt_u32 vcc, 16, v41
    v_cmp_ne_u32 s[68:69], s29, v4
    s_nop 0
    s_and_b64 vcc, vcc, s[68:69]
    s_cbranch_vccz HS_l
HS_imp:
    s_mov_b32 s24, 0
    v_lshlrev_b32 v40, 10, v3
    s_lshl_b32 s30, s18, 7
    s_add_u32 s30, s30, 16547840
    v_mov_b32 v41, s80
    buffer_wbl2 sc1
    s_waitcnt vmcnt(0)
    s_mov_b64 exec, 1
    buffer_store_dword v41, off, s[4:7], s51 offset:4 sc1
    s_mov_b64 exec, -1
HS_l2:
    s_sleep 8
    buffer_load_dword v4, v40, s[4:7], s30 offen offset:4 sc1
    s_sub_u32 s60, s60, 1
    s_cbranch_scc1 K1_fail
    s_waitcnt vmcnt(0)
    v_cmp_ne_u32 vcc, s80, v4
    s_nop 0
    s_cbranch_vccnz HS_l2
    buffer_inv sc1
    s_waitcnt vmcnt(0)
    s_branch HS_ok
Lspin_1:
    s_sleep 1
    buffer_load_dword v208, v209, s[4:7], s59 offen sc1
    s_sub_u32 s60, s60, 1
    s_cbranch_scc1 K1_fail
    s_waitcnt vmcnt(0)
    v_xor_b32 v208, s80, v208
    v_cmp_lt_u32 vcc, 15, v208
    s_nop 0
    s_cbranch_vccnz Lspin_1
    s_branch Lspin_1_r
Lchk_5:
    v_max3_u32 v120, v8, v9, v10
    v_max_u32 v120, v120, v11
    v_max3_u32 v120, v120, v136, v137
    v_max3_u32 v120, v120, v138, v139
    v_max3_u32 v120, v120, v140, v141
    v_max3_u32 v120, v120, v142, v143
    v_max3_u32 v120, v120, v144, v145
    v_max3_u32 v120, v120, v146, v147
    v_max3_u32 v120, v120, v148, v149
    v_max3_u32 v120, v120, v150, v151
    v_max3_u32 v120, v120, v152, v153
    v_max3_u32 v120, v120, v154, v155
    v_max3_u32 v120, v120, v156, v157
    v_max3_u32 v120, v120, v158, v159
    v_max3_u32 v120, v120, v160, v161
    v_max3_u32 v120, v120, v162, v163
    v_max3_u32 v120, v120, v164, v165
    v_max3_u32 v120, v120, v166, v167
    v_cmp_eq_u32 vcc, -1, v120
    s_nop 0
    s_cbranch_vccz Lgo_6
    s_add_u32 s61, s61, 1
    s_sub_u32 s60, s60, 1
    s_cbranch_scc1 K1_fail
    s_add_u32 s47, s98, 4096
    buffer_load_dwordx4 v[136:139], v0, s[4:7], s98 offen offset:0 sc1
    buffer_load_dwordx4 v[140:143], v0, s[4:7], s98 offen offset:1024 sc1
    buffer_load_dwordx4 v[144:147], v0, s[4:7], s98 offen offset:2048 sc1
    buffer_load_dwordx4 v[148:151], v0, s[4:7], s98 offen offset:3072 sc1
    buffer_load_dwordx4 v[8:11], v216, s[4:7], s101 offen sc1
    buffer_load_dwordx4 v[152:155], v0, s[4:7], s47 offen offset:0 sc1
    buffer_load_dwordx4 v[156:159], v0, s[4:7], s47 offen offset:1024 sc1
    buffer_load_dwordx4 v[160:163], v0, s[4:7], s47 offen offset:2048 sc1
    buffer_load_dwordx4 v[164:167], v0, s[4:7], s47 offen offset:3072 sc1
    s_waitcnt vmcnt(0)
    s_branch Lre_4
Limp_7:
    buffer_wbl2 sc1
    s_waitcnt vmcnt(0)
    buffer_store_byte v3, off, s[4:7], s59 sc1
    s_branch Lfl_8
Linv_14:
    buffer_inv sc1
    s_waitcnt vmcnt(0)
    s_branch Lok_13
Limp_15:
    buffer_wbl2 sc1
    s_waitcnt vmcnt(0)
    buffer_store_byte v3, off, s[4:7], s43 sc1
    s_branch Lfl_16
Lspin_17:
    s_sleep 1
    buffer_load_dword v128, v129, s[4:7], s70 offen sc1
    s_sub_u32 s60, s60, 1
    s_cbranch_scc1 K1_fail
    s_waitcnt vmcnt(0)
    v_cmp_ne_u32 vcc, s80, v128
    s_nop 0
    s_and_b64 vcc, vcc, 0xffff
    s_cbranch_vccnz Lspin_17
    s_branch Lspin_17_r
Linv_24:
    buffer_inv sc1
    s_waitcnt vmcnt(0)
    s_branch Lok_23
Limp_25:
    buffer_wbl2 sc1
    s_waitcnt vmcnt(0)
    buffer_store_byte v3, off, s[4:7], s43 sc1
    s_branch Lfl_26
Lspin_27:
    buffer_load_ubyte v4, v3, s[4:7], s44 offen sc1
    s_sub_u32 s60, s60, 1
    s_cbranch_scc1 K1_fail
    s_waitcnt vmcnt(0)
    v_cmp_gt_u32 vcc, 1, v4
    s_nop 0
    s_cbranch_vccnz Lspin_27
    s_branch Lspin_27_r
Linv_29:
    buffer_inv sc1
    s_waitcnt vmcnt(0)
    s_branch Lok_28
Limp_30:
    buffer_wbl2 sc1
    s_waitcnt vmcnt(0)
    buffer_store_byte v3, off, s[4:7], s48 sc1
    s_branch Lfl_31
Lspin_32:
    buffer_load_ubyte v4, v6, s[4:7], s58 offen sc1
    s_sub_u32 s60, s60, 1
    s_cbranch_scc1 K1_fail
    s_waitcnt vmcnt(0)
    v_cmp_gt_u32 vcc, 1, v4
    s_nop 0
    s_and_b64 vcc, vcc, s[54:55]
    s_cbranch_vccnz Lspin_32
    s_branch Lspin_32_r
Linv_34:
    buffer_inv sc1
    s_waitcnt vmcnt(0)
    s_branch Lok_33
Limp_35:
    buffer_wbl2 sc1
    s_waitcnt vmcnt(0)
    buffer_store_byte v3, off, s[4:7], s43 sc1
    s_branch Lfl_36
Lspin_38:
    s_sleep 4
    buffer_load_ubyte v4, v6, s[4:7], s58 offen sc1
    s_sub_u32 s60, s60, 1
    s_cbranch_scc1 K1_fail
    s_waitcnt vmcnt(0)
    v_cmp_gt_u32 vcc, 1, v4
    s_nop 0
    s_and_b64 vcc, vcc, s[54:55]
    s_cbranch_vccnz Lspin_38
    s_branch Lspin_38_r
Linv_40:
    buffer_inv sc1
    s_waitcnt vmcnt(0)
    s_branch Lok_39
Lskip3_20:
    buffer_store_dwordx4 v[72:75], v250, s[12:15], s42 offen
    v_pk_add_f32 v[124:125], v[112:113], v[114:115]
    v_pk_mul_f32 v[126:127], v[112:113], v[112:113]
    v_pk_add_f32 v[124:125], v[124:125], v[116:117]
    v_pk_fma_f32 v[126:127], v[114:115], v[114:115], v[126:127]
    v_pk_add_f32 v[124:125], v[124:125], v[118:119]
    v_pk_fma_f32 v[126:127], v[116:117], v[116:117], v[126:127]
    v_add_f32 v124, v124, v125
    v_pk_fma_f32 v[126:127], v[118:119], v[118:119], v[126:127]
    v_add_f32 v126, v126, v127
    v_permlane32_swap_b32 v120, v122
    s_sub_u32 s45, s45, 8192
    v_permlane32_swap_b32 v124, v126
    v_add_f32 v120, v120, v122
    v_add_f32 v124, v124, v126
    v_accvgpr_write_b32 a240, v104
    v_accvgpr_write_b32 a241, v105
    v_permlane16_swap_b32 v120, v124
    v_add_f32 v120, v120, v124
    v_accvgpr_write_b32 a242, v106
    v_accvgpr_write_b32 a243, v107
    v_add_f32 v120, v120, v120 row_ror:8 row_mask:0xf bank_mask:0xf
    s_mov_b32 exec_lo, 0x00ff00ff
    s_mov_b32 exec_hi, 0x00ff00ff
    buffer_store_dword v120, v251, s[4:7], s45 offen
    s_mov_b64 exec, -1
    v_accvgpr_write_b32 a244, v108
    v_accvgpr_write_b32 a245, v109
    v_accvgpr_write_b32 a246, v110
    v_accvgpr_write_b32 a247, v111
    v_accvgpr_write_b32 a248, v112
    v_accvgpr_write_b32 a249, v113
    v_accvgpr_write_b32 a250, v114
    v_accvgpr_write_b32 a251, v115
    v_accvgpr_write_b32 a252, v116
    v_accvgpr_write_b32 a253, v117
    v_accvgpr_write_b32 a254, v118
    v_accvgpr_write_b32 a255, v119
    s_waitcnt vmcnt(0)
    s_mov_b64 exec, 2
    s_cmp_eq_u32 s24, 0
    s_cbranch_scc1 Limp_35
    buffer_store_byte v3, off, s[4:7], s43
Lfl_36:
    s_mov_b64 exec, -1
    s_sub_u32 s32, s19, 29
    s_lshl_b32 s32, s32, 2
    s_add_u32 s32, s32, s3
    s_add_u32 s32, s32, 0
    v_lshlrev_b32 v8, 3, v0
    s_mul_i32 s30, s18, 720896
    s_add_u32 s30, s30, 10518528
    s_cmp_ge_u32 s32, 56
    s_cbranch_scc1 Lph_37_e
Lph_37:
    s_mul_i32 s31, s32, 9363
    s_lshr_b32 s31, s31, 16
    s_lshl_b32 s31, s31, 15
    s_lshl_b32 s33, s32, 13
    s_add_u32 s33, s33, s31
    s_add_u32 s33, s33, s30
    buffer_load_dword v9, v8, s[4:7], s33 offen
    s_add_u32 s32, s32, 12
    s_cmp_lt_u32 s32, 56
    s_waitcnt vmcnt(1)
    s_cbranch_scc1 Lph_37
Lph_37_e:
    buffer_load_dwordx4 a[64:67], v5, s[4:7], s77 offen offset:0 sc1
    buffer_load_dwordx4 a[68:71], v5, s[4:7], s77 offen offset:256 sc1
    buffer_load_dwordx4 a[72:75], v5, s[4:7], s77 offen offset:2048 sc1
    buffer_load_dwordx4 a[76:79], v5, s[4:7], s77 offen offset:2304 sc1
    s_add_u32 s77, s77, 4096
    buffer_load_dwordx4 a[80:83], v5, s[4:7], s77 offen offset:0 sc1
    buffer_load_dwordx4 a[84:87], v5, s[4:7], s77 offen offset:256 sc1
    buffer_load_dwordx4 a[88:91], v5, s[4:7], s77 offen offset:2048 sc1
    buffer_load_dwordx4 a[92:95], v5, s[4:7], s77 offen offset:2304 sc1
    s_add_u32 s77, s77, 4096
    buffer_load_dwordx4 a[96:99], v5, s[4:7], s77 offen offset:0 sc1
    buffer_load_dwordx4 a[100:103], v5, s[4:7], s77 offen offset:256 sc1
    buffer_load_dwordx4 a[104:107], v5, s[4:7], s77 offen offset:2048 sc1
    buffer_load_dwordx4 a[108:111], v5, s[4:7], s77 offen offset:2304 sc1
    s_add_u32 s77, s77, 4096
    buffer_load_dwordx4 a[112:115], v5, s[4:7], s77 offen offset:0 sc1
    buffer_load_dwordx4 a[116:119], v5, s[4:7], s77 offen offset:256 sc1
    buffer_load_dwordx4 a[120:123], v5, s[4:7], s77 offen offset:2048 sc1
    buffer_load_dwordx4 a[124:127], v5, s[4:7], s77 offen offset:2304 sc1
    s_add_u32 s77, s77, 4096
    buffer_load_dwordx4 a[128:131], v5, s[4:7], s77 offen offset:0 sc1
    buffer_load_dwordx4 a[132:135], v5, s[4:7], s77 offen offset:256 sc1
    buffer_load_dwordx4 a[136:139], v5, s[4:7], s77 offen offset:2048 sc1
    buffer_load_dwordx4 a[140:143], v5, s[4:7], s77 offen offset:2304 sc1
    s_add_u32 s77, s77, 4096
    buffer_load_dwordx4 a[144:147], v5, s[4:7], s77 offen offset:0 sc1
    buffer_load_dwordx4 a[148:151], v5, s[4:7], s77 offen offset:256 sc1
    buffer_load_dwordx4 a[152:155], v5, s[4:7], s77 offen offset:2048 sc1
    buffer_load_dwordx4 a[156:159], v5, s[4:7], s77 offen offset:2304 sc1
    s_add_u32 s77, s77, 4096
    buffer_load_dwordx4 a[160:163], v5, s[4:7], s77 offen offset:0 sc1
    buffer_load_dwordx4 a[164:167], v5, s[4:7], s77 offen offset:256 sc1
    buffer_load_dwordx4 a[168:171], v5, s[4:7], s77 offen offset:2048 sc1
    buffer_load_dwordx4 a[172:175], v5, s[4:7], s77 offen offset:2304 sc1
    s_add_u32 s77, s77, 4096
    buffer_load_dwordx4 a[176:179], v5, s[4:7], s77 offen offset:0 sc1
    buffer_load_dwordx4 a[180:183], v5, s[4:7], s77 offen offset:256 sc1
    buffer_load_dwordx4 a[184:187], v5, s[4:7], s77 offen offset:2048 sc1
    buffer_load_dwordx4 a[188:191], v5, s[4:7], s77 offen offset:2304 sc1
    s_add_u32 s77, s77, 4096
    buffer_load_dwordx4 a[192:195], v5, s[4:7], s77 offen offset:0 sc1
    buffer_load_dwordx4 a[196:199], v5, s[4:7], s77 offen offset:256 sc1
    buffer_load_dwordx4 a[200:203], v5, s[4:7], s77 offen offset:2048 sc1
    buffer_load_dwordx4 a[204:207], v5, s[4:7], s77 offen offset:2304 sc1
    s_add_u32 s77, s77, 4096
    buffer_load_dwordx4 a[208:211], v5, s[4:7], s77 offen offset:0 sc1
    buffer_load_dwordx4 a[212:215], v5, s[4:7], s77 offen offset:256 sc1
    buffer_load_dwordx4 a[216:219], v5, s[4:7], s77 offen offset:2048 sc1
    buffer_load_dwordx4 a[220:223], v5, s[4:7], s77 offen offset:2304 sc1
    s_add_u32 s77, s77, 4096
    buffer_load_dwordx4 a[224:227], v5, s[4:7], s77 offen offset:0 sc1
    buffer_load_dwordx4 a[228:231], v5, s[4:7], s77 offen offset:256 sc1
    buffer_load_dwordx4 a[232:235], v5, s[4:7], s77 offen offset:2048 sc1
    buffer_load_ubyte v4, v6, s[4:7], s58 offen sc1
    s_waitcnt vmcnt(0)
    v_cmp_gt_u32 vcc, 1, v4
    s_nop 0
    s_and_b64 vcc, vcc, s[54:55]
    s_cbranch_vccnz Lspin_38
Lspin_38_r:
    s_cmp_eq_u32 s24, 0
    s_cbranch_scc1 Linv_40
Lok_39:
    buffer_load_dwordx4 v[8:11], v5, s[4:7], s74 offen offset:0 sc1
    buffer_load_dwordx4 v[12:15], v5, s[4:7], s74 offen offset:256 sc1
    buffer_load_dwordx4 v[16:19], v5, s[4:7], s74 offen offset:2048 sc1
    buffer_load_dwordx4 v[20:23], v5, s[4:7], s74 offen offset:2304 sc1
    s_add_u32 s74, s74, 4096
    buffer_load_dwordx4 v[24:27], v5, s[4:7], s74 offen offset:0 sc1
    buffer_load_dwordx4 v[28:31], v5, s[4:7], s74 offen offset:256 sc1
    buffer_load_dwordx4 v[32:35], v5, s[4:7], s74 offen offset:2048 sc1
    buffer_load_dwordx4 v[36:39], v5, s[4:7], s74 offen offset:2304 sc1
    s_add_u32 s74, s74, 4096
    buffer_load_dwordx4 v[40:43], v5, s[4:7], s74 offen offset:0 sc1
    buffer_load_dwordx4 v[44:47], v5, s[4:7], s74 offen offset:256 sc1
    buffer_load_dwordx4 v[48:51], v5, s[4:7], s74 offen offset:2048 sc1
    buffer_load_dwordx4 v[52:55], v5, s[4:7], s74 offen offset:2304 sc1
    s_add_u32 s74, s74, 4096
    buffer_load_dwordx4 v[56:59], v5, s[4:7], s74 offen offset:0 sc1
    buffer_load_dwordx4 v[60:63], v5, s[4:7], s74 offen offset:256 sc1
    buffer_load_dwordx4 v[64:67], v5, s[4:7], s74 offen offset:2048 sc1
    buffer_load_dwordx4 v[68:71], v5, s[4:7], s74 offen offset:2304 sc1
    s_add_u32 s74, s74, 4096
    buffer_load_dwordx4 v[72:75], v5, s[4:7], s74 offen offset:0 sc1
    v_and_b32 v136, 0x70, v0
    v_bfe_u32 v137, v0, 7, 1
    v_lshl_add_u32 v136, v137, 9, v136
    v_bfe_u32 v137, v0, 8, 1
    v_lshl_add_u32 v136, v137, 13, v136
    v_lshrrev_b32 v137, 9, v0
    v_lshl_add_u32 v136, v137, 10, v136
    buffer_load_dwordx4 v[168:171], v136, s[4:7], s59 offen sc1
    s_waitcnt vmcnt(0)
    s_branch Lp4_21
Limp_42:
    buffer_wbl2 sc1
    s_waitcnt vmcnt(0)
    buffer_store_byte v3, off, s[4:7], s48 sc1
    s_branch Lfl_43
Linv_46:
    buffer_inv sc1
    s_waitcnt vmcnt(0)
    s_branch Lok_45
Limp_48:
    buffer_wbl2 sc1
    s_waitcnt vmcnt(0)
    buffer_store_byte v3, off, s[4:7], s43 sc1
    s_branch Lfl_49
Limp_50:
    buffer_wbl2 sc1
    s_waitcnt vmcnt(0)
    buffer_store_byte v3, off, s[4:7], s43 sc1
    s_branch Lfl_51
Linv_54:
    buffer_inv sc1
    s_waitcnt vmcnt(0)
    s_branch Lok_53
Lchk_56:
    v_max3_u32 v120, v8, v9, v10
    v_max_u32 v120, v120, v11
    v_max3_u32 v120, v120, v136, v137
    v_max3_u32 v120, v120, v138, v139
    v_max3_u32 v120, v120, v140, v141
    v_max3_u32 v120, v120, v142, v143
    v_max3_u32 v120, v120, v144, v145
    v_max3_u32 v120, v120, v146, v147
    v_max3_u32 v120, v120, v148, v149
    v_max3_u32 v120, v120, v150, v151
    v_max3_u32 v120, v120, v152, v153
    v_max3_u32 v120, v120, v154, v155
    v_max3_u32 v120, v120, v156, v157
    v_max3_u32 v120, v120, v158, v159
    v_max3_u32 v120, v120, v160, v161
    v_max3_u32 v120, v120, v162, v163
    v_max3_u32 v120, v120, v164, v165
    v_max3_u32 v120, v120, v166, v167
    v_cmp_eq_u32 vcc, -1, v120
    s_nop 0
    s_cbranch_vccz Lgo_57
    s_branch Lre_55_l
Limp_58:
    buffer_wbl2 sc1
    s_waitcnt vmcnt(0)
    buffer_store_byte v3, off, s[4:7], s59 sc1
    s_branch Lfl_59
Linv_62:
    buffer_inv sc1
    s_waitcnt vmcnt(0)
    s_branch Lok_61
Limp_63:
    buffer_wbl2 sc1
    s_waitcnt vmcnt(0)
    buffer_store_byte v3, off, s[4:7], s43 sc1
    s_branch Lfl_64
Linv_69:
    buffer_inv sc1
    s_waitcnt vmcnt(0)
    s_branch Lok_68
Limp_70:
    buffer_wbl2 sc1
    s_waitcnt vmcnt(0)
    buffer_store_byte v3, off, s[4:7], s43 sc1
    s_branch Lfl_71
Lspin_72:
    buffer_load_ubyte v4, v3, s[4:7], s44 offen sc1
    s_sub_u32 s60, s60, 1
    s_cbranch_scc1 K1_fail
    s_waitcnt vmcnt(0)
    v_cmp_gt_u32 vcc, 2, v4
    s_nop 0
    s_cbranch_vccnz Lspin_72
    s_branch Lspin_72_r
Linv_74:
    buffer_inv sc1
    s_waitcnt vmcnt(0)
    s_branch Lok_73
Limp_75:
    buffer_wbl2 sc1
    s_waitcnt vmcnt(0)
    buffer_store_byte v3, off, s[4:7], s48 sc1
    s_branch Lfl_76
Lspin_77:
    buffer_load_ubyte v4, v6, s[4:7], s58 offen sc1
    s_sub_u32 s60, s60, 1
    s_cbranch_scc1 K1_fail
    s_waitcnt vmcnt(0)
    v_cmp_gt_u32 vcc, 2, v4
    s_nop 0
    s_and_b64 vcc, vcc, s[54:55]
    s_cbranch_vccnz Lspin_77
    s_branch Lspin_77_r
Linv_79:
    buffer_inv sc1
    s_waitcnt vmcnt(0)
    s_branch Lok_78
Limp_80:
    buffer_wbl2 sc1
    s_waitcnt vmcnt(0)
    buffer_store_byte v3, off, s[4:7], s43 sc1
    s_branch Lfl_81
Lspin_82:
    s_sleep 4
    buffer_load_ubyte v4, v6, s[4:7], s58 offen sc1
    s_sub_u32 s60, s60, 1
    s_cbranch_scc1 K1_fail
    s_waitcnt vmcnt(0)
    v_cmp_gt_u32 vcc, 2, v4
    s_nop 0
    s_and_b64 vcc, vcc, s[54:55]
    s_cbranch_vccnz Lspin_82
    s_branch Lspin_82_r
Linv_84:
    buffer_inv sc1
    s_waitcnt vmcnt(0)
    s_branch Lok_83
Lskip3_65:
    s_waitcnt lgkmcnt(0)
    s_barrier
    ds_read_b128 v[184:187], v249 offset:32768
    ds_read_b128 v[188:191], v249 offset:33280
    ds_read_b128 v[192:195], v249 offset:40960
    ds_read_b128 v[196:199], v249 offset:41472
    ds_read_b128 v[200:203], v249 offset:49152
    ds_read_b128 v[204:207], v249 offset:49664
    ds_read_b128 v[208:211], v249 offset:57344
    ds_read_b128 v[212:215], v249 offset:57856
    s_add_u32 s42, s42, 131072
    s_add_u32 s45, s45, 8192
    s_add_u32 s43, s43, 512
    v_mov_b32 v216, v250
    v_mov_b32 v217, v251
    s_waitcnt lgkmcnt(4)
    v_pk_add_f32 v[184:185], v[184:185], v[192:193]
    v_pk_add_f32 v[186:187], v[186:187], v[194:195]
    v_pk_add_f32 v[188:189], v[188:189], v[196:197]
    v_pk_add_f32 v[190:191], v[190:191], v[198:199]
    v_pk_add_f32 v[112:113], v[112:113], v[184:185]
    v_pk_add_f32 v[114:115], v[114:115], v[186:187]
    v_pk_add_f32 v[116:117], v[116:117], v[188:189]
    v_pk_add_f32 v[118:119], v[118:119], v[190:191]
    s_waitcnt lgkmcnt(0)
    v_pk_add_f32 v[200:201], v[200:201], v[208:209]
    v_pk_add_f32 v[202:203], v[202:203], v[210:211]
    v_pk_add_f32 v[204:205], v[204:205], v[212:213]
    v_pk_add_f32 v[206:207], v[206:207], v[214:215]
    v_pk_add_f32 v[112:113], v[112:113], v[200:201]
    v_pk_add_f32 v[114:115], v[114:115], v[202:203]
    v_pk_add_f32 v[116:117], v[116:117], v[204:205]
    v_pk_add_f32 v[118:119], v[118:119], v[206:207]
    v_cvt_pk_bf16_f32 v184, v112, v113
    v_cvt_pk_bf16_f32 v185, v114, v115
    v_cvt_pk_bf16_f32 v186, v116, v117
    v_cvt_pk_bf16_f32 v187, v118, v119
    buffer_store_dwordx4 v[184:187], v216, s[12:15], s42 offen
    v_pk_add_f32 v[124:125], v[112:113], v[114:115]
    v_pk_mul_f32 v[126:127], v[112:113], v[112:113]
    v_pk_add_f32 v[124:125], v[124:125], v[116:117]
    v_pk_fma_f32 v[126:127], v[114:115], v[114:115], v[126:127]
    v_pk_add_f32 v[124:125], v[124:125], v[118:119]
    v_pk_fma_f32 v[126:127], v[116:117], v[116:117], v[126:127]
    v_add_f32 v124, v124, v125
    v_pk_fma_f32 v[126:127], v[118:119], v[118:119], v[126:127]
    v_add_f32 v126, v126, v127
    v_permlane32_swap_b32 v120, v122
    s_sub_u32 s45, s45, 8192
    v_permlane32_swap_b32 v124, v126
    v_add_f32 v120, v120, v122
    v_add_f32 v124, v124, v126
    v_accvgpr_write_b32 a240, v104
    v_accvgpr_write_b32 a241, v105
    v_permlane16_swap_b32 v120, v124
    v_add_f32 v120, v120, v124
    v_accvgpr_write_b32 a242, v106
    v_accvgpr_write_b32 a243, v107
    v_add_f32 v120, v120, v120 row_ror:8 row_mask:0xf bank_mask:0xf
    s_mov_b32 exec_lo, 0x00ff00ff
    s_mov_b32 exec_hi, 0x00ff00ff
    buffer_store_dword v120, v217, s[4:7], s45 offen
    s_mov_b64 exec, -1
    v_accvgpr_write_b32 a244, v108
    v_accvgpr_write_b32 a245, v109
    v_accvgpr_write_b32 a246, v110
    v_accvgpr_write_b32 a247, v111
    v_accvgpr_write_b32 a248, v112
    v_accvgpr_write_b32 a249, v113
    v_accvgpr_write_b32 a250, v114
    v_accvgpr_write_b32 a251, v115
    v_accvgpr_write_b32 a252, v116
    v_accvgpr_write_b32 a253, v117
    v_accvgpr_write_b32 a254, v118
    v_accvgpr_write_b32 a255, v119
    s_waitcnt vmcnt(0)
    s_mov_b64 exec, 4
    s_cmp_eq_u32 s24, 0
    s_cbranch_scc1 Limp_80
    buffer_store_byte v3, off, s[4:7], s43
Lfl_81:
    s_mov_b64 exec, -1
    v_mov_b32 v8, s80
    s_mov_b32 s31, 16646144
    s_lshl_b32 s30, s2, 2
    s_add_u32 s30, s30, s3
    s_cmp_eq_u32 s30, 1023
    s_cselect_b64 exec, 1, 0
    buffer_store_dword v8, off, s[4:7], s31 sc1
    s_mov_b64 exec, -1
    buffer_load_ubyte v4, v6, s[4:7], s58 offen sc1
    s_waitcnt vmcnt(0)
    v_cmp_gt_u32 vcc, 2, v4
    s_nop 0
    s_and_b64 vcc, vcc, s[54:55]
    s_cbranch_vccnz Lspin_82
Lspin_82_r:
    s_cmp_eq_u32 s24, 0
    s_cbranch_scc1 Linv_84
Lok_83:
    buffer_load_dwordx4 v[8:11], v5, s[4:7], s74 offen offset:0 sc1
    buffer_load_dwordx4 v[12:15], v5, s[4:7], s74 offen offset:256 sc1
    buffer_load_dwordx4 v[16:19], v5, s[4:7], s74 offen offset:2048 sc1
    buffer_load_dwordx4 v[20:23], v5, s[4:7], s74 offen offset:2304 sc1
    s_add_u32 s74, s74, 4096
    buffer_load_dwordx4 v[24:27], v5, s[4:7], s74 offen offset:0 sc1
    buffer_load_dwordx4 v[28:31], v5, s[4:7], s74 offen offset:256 sc1
    buffer_load_dwordx4 v[32:35], v5, s[4:7], s74 offen offset:2048 sc1
    buffer_load_dwordx4 v[36:39], v5, s[4:7], s74 offen offset:2304 sc1
    s_add_u32 s74, s74, 4096
    buffer_load_dwordx4 v[40:43], v5, s[4:7], s74 offen offset:0 sc1
    buffer_load_dwordx4 v[44:47], v5, s[4:7], s74 offen offset:256 sc1
    buffer_load_dwordx4 v[48:51], v5, s[4:7], s74 offen offset:2048 sc1
    buffer_load_dwordx4 v[52:55], v5, s[4:7], s74 offen offset:2304 sc1
    s_add_u32 s74, s74, 4096
    buffer_load_dwordx4 v[56:59], v5, s[4:7], s74 offen offset:0 sc1
    v_and_b32 v136, 0x70, v0
    v_bfe_u32 v137, v0, 7, 1
    v_lshl_add_u32 v136, v137, 9, v136
    v_bfe_u32 v137, v0, 8, 1
    v_lshl_add_u32 v136, v137, 13, v136
    v_lshrrev_b32 v137, 9, v0
    v_lshl_add_u32 v136, v137, 10, v136
    buffer_load_dwordx4 v[168:171], v136, s[4:7], s59 offen sc1
    s_waitcnt vmcnt(0)
    s_branch Lp4_66
Limp_86:
    buffer_wbl2 sc1
    s_waitcnt vmcnt(0)
    buffer_store_byte v3, off, s[4:7], s48 sc1
    s_branch Lfl_87
Linv_90:
    buffer_inv sc1
    s_waitcnt vmcnt(0)
    s_branch Lok_89
K1_fail:
    v_mov_b32 v4, 0
    v_mov_b32 v6, 0xdead
    global_store_dword v4, v6, s[16:17]
    s_endpgm
.section .rodata,"a"
.p2align 6
.amdhsa_kernel interleave_layers__linear_kernel_hedgehog__glu_gated_reglu__prompt_kernel
  .amdhsa_next_free_vgpr 512
  .amdhsa_next_free_sgpr 102
  .amdhsa_accum_offset 256
  .amdhsa_group_segment_fixed_size 0
  .amdhsa_kernarg_size 88
  .amdhsa_user_sgpr_count 2
  .amdhsa_user_sgpr_kernarg_segment_ptr 1
  .amdhsa_system_sgpr_workgroup_id_x 1
.end_amdhsa_kernel
```
